```python
import torch

def _softmax(x, axis=-1):
    return torch.softmax(x, dim=axis)
def _gelu(x):
    return torch.nn.functional.gelu(x, approximate="tanh")
def _silu(x):
    return torch.nn.functional.silu(x)
def _sigmoid(x):
    return torch.sigmoid(x)
def _layernorm(x, axis=-1, eps=1e-5):
    m = x.mean(dim=axis, keepdim=True)
    v = x.var(dim=axis, keepdim=True, unbiased=False)
    return (x - m) / torch.sqrt(v + eps)
def _scatter_add(tgt, idx, src, axis=0):
    return tgt.clone().index_add_(axis, idx, src)
def _segment_sum(src, seg, n):
    out = torch.zeros((n,) + src.shape[1:], dtype=src.dtype)
    return out.index_add_(0, seg, src)
def _pad(x, pw):
    flat = tuple(v for pair in reversed(pw) for v in pair)
    return torch.nn.functional.pad(x, flat)

kernel_name = 'concat_heads__mha_block_cached__mha_block_cached__near_ridge'

def setup_inputs():

    _w = (lambda a: (lambda t: t.to(torch.bfloat16) if t.is_floating_point() else t)(torch.as_tensor(a)))
    def _A_setup():
        B, Sq, D = 8, 256, 576
        H, Sk, Dh = 32, 1024, 128
        return {
            "x": _w((lambda *s: torch.randn(*s, dtype=torch.bfloat16) * 0.8)(B, Sq, D)),
            "k_cache": _w((lambda *s: torch.randn(*s, dtype=torch.bfloat16) * 0.8)(B, H, Sk, Dh)),
            "v_cache": _w((lambda *s: torch.randn(*s, dtype=torch.bfloat16) * 0.05)(B, H, Sk, Dh)),
            "wq": _w((lambda *s: torch.randn(*s, dtype=torch.bfloat16) * 0.8)(D, H * Dh) * (D ** -0.5)),
            "wo": _w((lambda *s: torch.randn(*s, dtype=torch.bfloat16) * 0.05)(H * Dh, D) * ((H * Dh) ** -0.5)),
        }
    _A_in = _A_setup()

    def _B_setup():
        B, Sq, D = 8, 256, 576
        H, Sk, Dh = 32, 1024, 128
        return {
            "x": _w((lambda *s: torch.randn(*s, dtype=torch.bfloat16) * 0.8)(B, Sq, D)),
            "k_cache": _w((lambda *s: torch.randn(*s, dtype=torch.bfloat16) * 0.8)(B, H, Sk, Dh)),
            "v_cache": _w((lambda *s: torch.randn(*s, dtype=torch.bfloat16) * 0.05)(B, H, Sk, Dh)),
            "wq": _w((lambda *s: torch.randn(*s, dtype=torch.bfloat16) * 0.8)(D, H * Dh) * (D ** -0.5)),
            "wo": _w((lambda *s: torch.randn(*s, dtype=torch.bfloat16) * 0.05)(H * Dh, D) * ((H * Dh) ** -0.5)),
        }
    _B_in = _B_setup()

    return {
        "A_x": _A_in["x"],
        "A_k_cache": _A_in["k_cache"],
        "A_v_cache": _A_in["v_cache"],
        "A_wq": _A_in["wq"],
        "A_wo": _A_in["wo"],
        "B_x": _B_in["x"],
        "B_k_cache": _B_in["k_cache"],
        "B_v_cache": _B_in["v_cache"],
        "B_wq": _B_in["wq"],
        "B_wo": _B_in["wo"],
    }

def reference(A_x, A_k_cache, A_v_cache, A_wq, A_wo, B_x, B_k_cache, B_v_cache, B_wq, B_wo):
    def _A_ref(x, k_cache, v_cache, wq, wo):
        B, Sq, D = x.shape
        H, Dh = 32, 128
        q = (lambda x, *d: x.permute(*d))((x @ wq).reshape(B, Sq, H, Dh), 0, 2, 1, 3)
        scores = torch.einsum("bhqd,bhkd->bhqk", q, k_cache) * (Dh ** -0.5)
        p = _softmax(scores, axis=-1)
        o = torch.einsum("bhqk,bhkd->bhqd", p, v_cache)
        return (lambda x, *d: x.permute(*d))(o, 0, 2, 1, 3).reshape(B, Sq, H * Dh) @ wo

    def _B_ref(x, k_cache, v_cache, wq, wo):
        B, Sq, D = x.shape
        H, Dh = 32, 128
        q = (lambda x, *d: x.permute(*d))((x @ wq).reshape(B, Sq, H, Dh), 0, 2, 1, 3)
        scores = torch.einsum("bhqd,bhkd->bhqk", q, k_cache) * (Dh ** -0.5)
        p = _softmax(scores, axis=-1)
        o = torch.einsum("bhqk,bhkd->bhqd", p, v_cache)
        return (lambda x, *d: x.permute(*d))(o, 0, 2, 1, 3).reshape(B, Sq, H * Dh) @ wo

    a = _A_ref(A_x, A_k_cache, A_v_cache, A_wq, A_wo)
    b = _B_ref(B_x, B_k_cache, B_v_cache, B_wq, B_wo)
    return torch.concatenate([a, b], axis=-1)
```

```asm
; @launch grid=(256,1,1) block=(256,1,1) lds=163840
.amdgcn_target "amdgcn-amd-amdhsa--gfx950"
.text

.macro MV d,a,b,c
v_mfma_f32_16x16x32_bf16 v[\d:\d+3],v[\a:\a+3],a[\b:\b+3],v[\c:\c+3]
.endm
.macro MA d,a,b
v_mfma_f32_16x16x32_bf16 a[\d:\d+3],v[\a:\a+3],v[\b:\b+3],a[\d:\d+3]
.endm
.macro MQV d,a,b
v_mfma_f32_16x16x32_bf16 v[\d:\d+3],a[\a:\a+3],a[\b:\b+3],v[\d:\d+3]
.endm
.macro MQA d,a,b
v_mfma_f32_16x16x32_bf16 a[\d:\d+3],a[\a:\a+3],a[\b:\b+3],a[\d:\d+3]
.endm
.macro MXV d,a,b
v_mfma_f32_16x16x32_bf16 v[\d:\d+3],a[\a:\a+3],v[\b:\b+3],v[\d:\d+3]
.endm
.macro MXA d,a,b
v_mfma_f32_16x16x32_bf16 a[\d:\d+3],a[\a:\a+3],v[\b:\b+3],a[\d:\d+3]
.endm
.macro TR d,a,o
ds_read_b64_tr_b16 v[\d:\d+1],v\a offset:\o
.endm
.macro TRA d,a,o
ds_read_b64_tr_b16 a[\d:\d+1],v\a offset:\o
.endm
.macro RD d,a,o
ds_read_b128 v[\d:\d+3],v\a offset:\o
.endm
.macro CV d,a,b
v_cvt_pk_bf16_f32 v\d,v\a,v\b
.endm
.globl concat_heads__mha_block_cached__mha_block_cached__near_ridge_kernel
.p2align 8
.type concat_heads__mha_block_cached__mha_block_cached__near_ridge_kernel,@function
concat_heads__mha_block_cached__mha_block_cached__near_ridge_kernel:
s_cmp_ge_u32 s2,256
s_cbranch_scc1 L_end
s_bfe_u32 s48,s2,0x10002
s_mul_i32 s50,s48,40
s_add_u32 s52,s0,s50
s_addc_u32 s53,s1,0
s_load_dwordx2 s[12:13],s[52:53],0
s_load_dwordx2 s[16:17],s[52:53],24
s_lshr_b32 s51,s2,7
s_mul_i32 s51,s51,40
s_add_u32 s54,s0,s51
s_addc_u32 s55,s1,0
s_load_dwordx2 s[4:5],s[52:53],8
s_load_dwordx2 s[8:9],s[52:53],16
s_load_dwordx2 s[24:25],s[54:55],32
s_load_dwordx2 s[20:21],s[0:1],96
s_load_dwordx4 s[92:95],s[0:1],80
s_getpc_b64 s[50:51]
L_pcx:
s_sub_u32 s50,s50,L_pcx-concat_heads__mha_block_cached__mha_block_cached__near_ridge_kernel
s_subb_u32 s51,s51,0
s_lshr_b32 s48,s2,3
s_cmp_ge_u32 s48,3
s_cbranch_scc1 L_nopf
s_lshl_b32 s48,s48,15
v_lshlrev_b32 v100,7,v0
v_add_u32 v100,s48,v100
v_min_u32 v100,L_code_end-concat_heads__mha_block_cached__mha_block_cached__near_ridge_kernel-4,v100
global_load_dword v252,v100,s[50:51]
L_nopf:
s_and_b32 s46,s2,6
s_lshl_b32 s46,s46,1
s_lshr_b32 s48,s2,6
s_add_u32 s46,s46,s48
s_and_b32 s47,s2,1
s_lshl_b32 s47,s47,3
s_bfe_u32 s48,s2,0x30003
s_add_u32 s47,s47,s48
s_and_b32 s49,s46,7
v_lshrrev_b32 v1,6,v0
v_and_b32 v2,63,v0
v_readfirstlane_b32 s32,v1
v_lshrrev_b32 v97,4,v2
v_lshrrev_b32 v100,3,v2
v_lshl_add_u32 v100,v1,6,v100
v_mul_u32_u24 v100,1152,v100
s_lshl_b32 s34,s32,12
v_and_b32 v101,7,v2
v_xor_b32 v101,v101,v97
v_lshl_add_u32 v88,v101,4,v100
v_xor_b32 v101,4,v101
v_lshl_add_u32 v102,v101,4,v100
v_add_u32 v89,8192,v102
v_add_u32 v90,16384,v88
v_add_u32 v91,24576,v102
v_lshrrev_b32 v100,5,v2
v_and_b32 v101,31,v2
v_lshl_add_u32 v103,v1,3,v100
v_lshlrev_b32 v103,13,v103
v_lshlrev_b32 v104,2,v100
v_xor_b32 v104,v104,v101
v_lshl_add_u32 v84,v104,4,v103
v_xor_b32 v104,128,v84
v_add_u32 v85,15360,v104
v_add_u32 v86,30720,v84
v_add_u32 v87,46080,v104
s_mul_i32 s50,s49,294912
s_lshl_b32 s51,s47,9
s_mov_b32 s14,294912
s_mov_b32 s15,0x20000
s_sub_u32 s18,4718592,s51
s_mov_b32 s19,0x20000
s_waitcnt lgkmcnt(0)
s_add_u32 s12,s12,s50
s_addc_u32 s13,s13,0
s_add_u32 s16,s16,s51
s_addc_u32 s17,s17,0
s_mov_b32 s45,0
s_add_u32 m0,s34,65536
s_nop 0
buffer_load_dwordx4 v84,s[16:19],s45 offen offset:0 nt lds
buffer_load_dwordx4 v85,s[16:19],s45 offen offset:1024 nt lds
buffer_load_dwordx4 v86,s[16:19],s45 offen offset:2048 nt lds
buffer_load_dwordx4 v87,s[16:19],s45 offen offset:3072 nt lds
s_mov_b32 s41,0
s_add_u32 m0,s34,32768
s_nop 0
buffer_load_dwordx4 v88,s[12:15],s41 offen offset:0 lds
buffer_load_dwordx4 v89,s[12:15],s41 offen offset:1024 lds
buffer_load_dwordx4 v90,s[12:15],s41 offen offset:2048 lds
buffer_load_dwordx4 v91,s[12:15],s41 offen offset:3072 lds
s_mov_b32 s41,36864
s_add_u32 m0,s34,81920
s_nop 0
buffer_load_dwordx4 v88,s[12:15],s41 offen offset:0 lds
buffer_load_dwordx4 v89,s[12:15],s41 offen offset:1024 lds
buffer_load_dwordx4 v90,s[12:15],s41 offen offset:2048 lds
buffer_load_dwordx4 v91,s[12:15],s41 offen offset:3072 lds
s_mov_b32 s45,262144
s_add_u32 m0,s34,16384
s_nop 0
buffer_load_dwordx4 v84,s[16:19],s45 offen offset:0 nt lds
buffer_load_dwordx4 v85,s[16:19],s45 offen offset:1024 nt lds
buffer_load_dwordx4 v86,s[16:19],s45 offen offset:2048 nt lds
buffer_load_dwordx4 v87,s[16:19],s45 offen offset:3072 nt lds
v_and_b32 v96,15,v2
v_and_b32 v98,3,v2
v_bfe_u32 v99,v2,2,2
v_lshl_add_u32 v100,v97,3,v99
v_lshlrev_b32 v101,6,v99
v_lshl_add_u32 v101,v100,9,v101
v_lshl_add_u32 v101,v98,4,v101
v_add_u32 v64,16384,v101
v_xor_b32 v65,64,v64
v_xor_b32 v66,128,v64
v_xor_b32 v67,192,v64
v_lshrrev_b32 v100,1,v96
v_xor_b32 v100,v100,v97
v_lshlrev_b32 v100,4,v100
v_lshl_add_u32 v100,v96,7,v100
v_lshl_add_u32 v100,v1,12,v100
v_add_u32 v80,32768,v100
v_xor_b32 v81,64,v80
v_add_u32 v82,65536,v80
v_add_u32 v83,65536,v81
s_mov_b32 s41,128
s_add_u32 m0,s34,98304
s_nop 0
buffer_load_dwordx4 v88,s[12:15],s41 offen offset:0 lds
buffer_load_dwordx4 v89,s[12:15],s41 offen offset:1024 lds
buffer_load_dwordx4 v90,s[12:15],s41 offen offset:2048 lds
buffer_load_dwordx4 v91,s[12:15],s41 offen offset:3072 lds
s_mov_b32 s45,524288
s_add_u32 m0,s34,114688
s_nop 0
buffer_load_dwordx4 v84,s[16:19],s45 offen offset:0 nt lds
buffer_load_dwordx4 v85,s[16:19],s45 offen offset:1024 nt lds
buffer_load_dwordx4 v86,s[16:19],s45 offen offset:2048 nt lds
buffer_load_dwordx4 v87,s[16:19],s45 offen offset:3072 nt lds
s_mov_b32 s45,786432
s_add_u32 m0,s34,49152
s_nop 0
buffer_load_dwordx4 v84,s[16:19],s45 offen offset:0 nt lds
buffer_load_dwordx4 v85,s[16:19],s45 offen offset:1024 nt lds
buffer_load_dwordx4 v86,s[16:19],s45 offen offset:2048 nt lds
buffer_load_dwordx4 v87,s[16:19],s45 offen offset:3072 nt lds
s_waitcnt vmcnt(12)
s_barrier
RD 96,80,0
RD 112,81,0
TRA 128,64,49152
TRA 130,64,51200
TRA 132,64,0
TRA 134,64,2048
RD 100,80,2048
RD 116,81,2048
RD 104,80,49152
RD 108,80,51200
RD 120,81,49152
RD 124,81,51200
TRA 136,64,49160
TRA 138,64,51208
TRA 140,64,8
TRA 142,64,2056
TRA 144,65,49152
TRA 146,65,51200
TRA 148,65,0
TRA 150,65,2048
s_waitcnt lgkmcnt(14)
v_mfma_f32_16x16x32_bf16 a[0:3],a[128:131],v[96:99],0
s_waitcnt vmcnt(8)
RD 28,82,0
v_add_u32 v68,98304,v64
MXA 0,132,112
s_waitcnt lgkmcnt(13)
RD 32,82,2048
v_add_u32 v69,98304,v65
v_mfma_f32_16x16x32_bf16 a[4:7],a[132:135],v[116:119],0
s_waitcnt lgkmcnt(10)
RD 44,83,0
v_add_u32 v70,98304,v66
MXA 4,128,100
s_mov_b32 s41,36992
RD 48,83,2048
v_add_u32 v71,98304,v67
v_mfma_f32_16x16x32_bf16 a[8:11],a[128:131],v[104:107],0
s_add_u32 m0,s34,32768
TRA 152,65,49160
v_lshlrev_b32 v60,4,v2
MXA 8,132,120
buffer_load_dwordx4 v88,s[12:15],s41 offen offset:0 lds
v_and_b32 v61,15,v2
v_mfma_f32_16x16x32_bf16 a[12:15],a[132:135],v[124:127],0
TRA 154,65,51208
v_lshrrev_b32 v62,4,v2
MXA 12,128,108
s_waitcnt lgkmcnt(12)
TRA 156,65,8
v_lshlrev_b32 v92,11,v1
v_mfma_f32_16x16x32_bf16 a[28:31],a[136:139],v[108:111],0
s_waitcnt lgkmcnt(11)
buffer_load_dwordx4 v89,s[12:15],s41 offen offset:1024 lds
v_lshl_add_u32 v92,v62,8,v92
MXA 28,140,124
TRA 158,65,2056
v_lshl_add_u32 v93,v1,3,v62
v_mfma_f32_16x16x32_bf16 a[24:27],a[140:143],v[120:123],0
TRA 160,66,49152
MXA 24,136,104
buffer_load_dwordx4 v90,s[12:15],s41 offen offset:2048 lds
v_add_u32 v94,0,v93
v_mfma_f32_16x16x32_bf16 a[20:23],a[136:139],v[100:103],0
TRA 162,66,51200
v_and_b32 v95,15,v94
MXA 20,140,116
TRA 164,66,0
v_xor_b32 v95,v95,v61
v_mfma_f32_16x16x32_bf16 a[16:19],a[140:143],v[112:115],0
buffer_load_dwordx4 v91,s[12:15],s41 offen offset:3072 lds
v_lshl_add_u32 v16,v95,4,v92
MXA 16,136,96
s_waitcnt lgkmcnt(13)
TRA 166,66,2048
v_and_b32 v95,7,v94
v_mfma_f32_16x16x32_bf16 a[32:35],a[144:147],v[96:99],0
s_mov_b32 s41,256
TRA 168,66,49160
v_lshlrev_b32 v95,1,v95
s_waitcnt lgkmcnt(13)
MXA 32,148,112
s_add_u32 m0,s34,81920
TRA 170,66,51208
v_xor_b32 v95,v95,v61
v_mfma_f32_16x16x32_bf16 a[36:39],a[148:151],v[116:119],0
buffer_load_dwordx4 v88,s[12:15],s41 offen offset:0 lds
v_lshl_add_u32 v18,v95,4,v92
MXA 36,144,100
TRA 172,66,8
v_add_u32 v94,4,v93
v_mfma_f32_16x16x32_bf16 a[40:43],a[144:147],v[104:107],0
TRA 174,66,2056
MXA 40,148,120
TRA 176,67,49152
v_and_b32 v95,15,v94
v_mfma_f32_16x16x32_bf16 a[44:47],a[148:151],v[124:127],0
buffer_load_dwordx4 v89,s[12:15],s41 offen offset:1024 lds
v_xor_b32 v95,v95,v61
MXA 44,144,108
s_waitcnt lgkmcnt(11)
TRA 178,67,51200
v_lshl_add_u32 v17,v95,4,v92
v_mfma_f32_16x16x32_bf16 a[60:63],a[152:155],v[108:111],0
s_waitcnt lgkmcnt(10)
TRA 180,67,0
v_and_b32 v95,7,v94
MXA 60,156,124
TRA 182,67,2048
v_lshlrev_b32 v95,1,v95
v_mfma_f32_16x16x32_bf16 a[56:59],a[156:159],v[120:123],0
buffer_load_dwordx4 v90,s[12:15],s41 offen offset:2048 lds
v_xor_b32 v95,v95,v61
MXA 56,152,104
TRA 184,67,49160
v_lshl_add_u32 v19,v95,4,v92
v_mfma_f32_16x16x32_bf16 a[52:55],a[152:155],v[100:103],0
TRA 186,67,51208
v_lshlrev_b32 v92,12,v1
MXA 52,156,116
TRA 188,67,8
v_lshl_add_u32 v92,v62,8,v92
v_mfma_f32_16x16x32_bf16 a[48:51],a[156:159],v[112:115],0
buffer_load_dwordx4 v91,s[12:15],s41 offen offset:3072 lds
MXA 48,152,96
s_waitcnt lgkmcnt(13)
TRA 190,67,2056
v_add_u32 v94,0,v62
v_mfma_f32_16x16x32_bf16 a[64:67],a[160:163],v[96:99],0
s_mov_b32 s45,1048576
TRA 192,64,49408
v_xor_b32 v95,v94,v61
s_waitcnt lgkmcnt(13)
MXA 64,164,112
s_add_u32 m0,s34,131072
TRA 194,64,51456
v_lshl_add_u32 v24,v95,4,v92
v_mfma_f32_16x16x32_bf16 a[68:71],a[164:167],v[116:119],0
s_and_b32 s50,s2,127
buffer_load_dwordx4 v84,s[16:19],s45 offen offset:0 nt lds
v_and_b32 v95,7,v94
MXA 68,160,100
s_mul_i32 s50,s50,36864
TRA 196,64,256
v_lshlrev_b32 v95,1,v95
v_mfma_f32_16x16x32_bf16 a[72:75],a[160:163],v[104:107],0
s_add_u32 s24,s24,s50
s_addc_u32 s25,s25,0
TRA 198,64,2304
v_xor_b32 v95,v95,v61
MXA 72,164,120
s_mov_b32 s26,36864
TRA 200,64,49416
v_lshl_add_u32 v20,v95,4,v92
v_mfma_f32_16x16x32_bf16 a[76:79],a[164:167],v[124:127],0
buffer_load_dwordx4 v85,s[16:19],s45 offen offset:1024 nt lds
v_add_u32 v94,4,v62
MXA 76,160,108
s_waitcnt lgkmcnt(14)
TRA 202,64,51464
v_xor_b32 v95,v94,v61
v_mfma_f32_16x16x32_bf16 a[92:95],a[168:171],v[108:111],0
s_mov_b32 s27,0x20000
TRA 204,64,264
v_lshl_add_u32 v25,v95,4,v92
s_waitcnt lgkmcnt(14)
MXA 92,172,124
s_lshl_b32 s33,s32,11
TRA 206,64,2312
v_mfma_f32_16x16x32_bf16 a[88:91],a[172:175],v[120:123],0
s_lshl_b32 s50,s49,23
buffer_load_dwordx4 v86,s[16:19],s45 offen offset:2048 nt lds
v_and_b32 v95,7,v94
MXA 88,168,104
s_lshl_b32 s51,s47,19
TRA 208,65,49408
v_lshlrev_b32 v95,1,v95
v_mfma_f32_16x16x32_bf16 a[84:87],a[168:171],v[100:103],0
s_add_u32 s50,s50,s51
TRA 210,65,51456
v_xor_b32 v95,v95,v61
MXA 84,172,116
s_add_u32 s4,s4,s50
s_addc_u32 s5,s5,0
TRA 212,65,256
v_lshl_add_u32 v21,v95,4,v92
v_mfma_f32_16x16x32_bf16 a[80:83],a[172:175],v[112:115],0
buffer_load_dwordx4 v87,s[16:19],s45 offen offset:3072 nt lds
v_add_u32 v94,8,v62
MXA 80,168,96
s_waitcnt lgkmcnt(14)
TRA 214,65,2304
v_xor_b32 v95,v94,v61
v_mfma_f32_16x16x32_bf16 a[96:99],a[176:179],v[96:99],0
TRA 216,65,49416
v_lshl_add_u32 v26,v95,4,v92
MXA 96,180,112
s_mov_b32 s41,37120
TRA 218,65,51464
v_and_b32 v95,7,v94
v_mfma_f32_16x16x32_bf16 a[100:103],a[180:183],v[116:119],0
s_add_u32 m0,s34,98304
TRA 220,65,264
v_lshlrev_b32 v95,1,v95
MXA 100,176,100
s_mov_b32 s6,0x80000
buffer_load_dwordx4 v88,s[12:15],s41 offen offset:0 lds
v_mfma_f32_16x16x32_bf16 a[104:107],a[176:179],v[104:107],0
s_mov_b32 s7,0x20000
TRA 222,65,2312
v_xor_b32 v95,v95,v61
MXA 104,180,120
s_add_u32 s8,s8,s50
s_addc_u32 s9,s9,0
TRA 128,66,49408
v_lshl_add_u32 v22,v95,4,v92
v_mfma_f32_16x16x32_bf16 a[108:111],a[180:183],v[124:127],0
buffer_load_dwordx4 v89,s[12:15],s41 offen offset:1024 lds
v_add_u32 v94,12,v62
MXA 108,176,108
s_waitcnt lgkmcnt(14)
TRA 130,66,51456
v_xor_b32 v95,v94,v61
v_mfma_f32_16x16x32_bf16 a[124:127],a[184:187],v[108:111],0
s_mov_b32 s10,0x80000
TRA 132,66,256
v_lshl_add_u32 v27,v95,4,v92
MXA 124,188,124
s_mov_b32 s11,0x20000
buffer_load_dwordx4 v90,s[12:15],s41 offen offset:2048 lds
v_and_b32 v95,7,v94
v_mfma_f32_16x16x32_bf16 a[120:123],a[188:191],v[120:123],0
s_mov_b32 s52,s20
TRA 134,66,2304
v_lshlrev_b32 v95,1,v95
MXA 120,184,104
s_mov_b32 s53,s21
TRA 136,66,49416
v_xor_b32 v95,v95,v61
v_mfma_f32_16x16x32_bf16 a[116:119],a[184:187],v[100:103],0
s_mov_b32 s54,s92
buffer_load_dwordx4 v91,s[12:15],s41 offen offset:3072 lds
v_lshl_add_u32 v23,v95,4,v92
MXA 116,188,116
s_mov_b32 s55,s93
TRA 138,66,51464
v_mfma_f32_16x16x32_bf16 a[112:115],a[188:191],v[112:115],0
TRA 140,66,264
MXA 112,184,96
TRA 142,66,2312
v_mfma_f32_16x16x32_bf16 v[128:131],a[192:195],v[96:99],0
s_mov_b32 s45,1310720
s_waitcnt vmcnt(12)
RD 36,80,0
v_xor_b32 v92,v62,v61
s_waitcnt lgkmcnt(14)
MXV 128,196,112
s_add_u32 m0,s34,147456
RD 40,80,2048
v_lshlrev_b32 v92,4,v92
v_mfma_f32_16x16x32_bf16 v[132:135],a[196:199],v[116:119],0
s_lshr_b32 s50,s2,7
buffer_load_dwordx4 v84,s[16:19],s45 offen offset:0 nt lds
v_lshl_add_u32 v4,v61,8,v92
MXV 132,192,100
s_lshl_b32 s50,s50,9
RD 52,81,0
v_xor_b32 v5,64,v4
v_mfma_f32_16x16x32_bf16 v[136:139],a[192:195],v[104:107],0
s_and_b32 s51,s2,64
RD 56,81,2048
v_xor_b32 v6,128,v4
MXV 136,196,120
s_add_u32 s50,s50,s51
TRA 144,67,49408
v_xor_b32 v7,192,v4
v_mfma_f32_16x16x32_bf16 v[140:143],a[196:199],v[124:127],0
TRA 146,67,51456
MXV 140,192,108
buffer_load_dwordx4 v85,s[16:19],s45 offen offset:1024 nt lds
v_lshrrev_b32 v92,2,v2
v_mfma_f32_16x16x32_bf16 v[156:159],a[200:203],v[108:111],0
s_bfe_u32 s51,s2,0x10002
TRA 148,67,256
v_and_b32 v93,7,v92
MXV 156,204,124
s_lshl_b32 s51,s51,5
TRA 150,67,2304
v_lshlrev_b32 v93,5,v93
v_mfma_f32_16x16x32_bf16 v[152:155],a[204:207],v[120:123],0
s_add_u32 s50,s50,s51
TRA 152,67,49416
v_lshl_add_u32 v93,v92,8,v93
MXV 152,200,104
s_bfe_u32 s51,s2,0x30003
TRA 154,67,51464
v_and_b32 v94,3,v2
v_mfma_f32_16x16x32_bf16 v[148:151],a[200:203],v[100:103],0
s_lshl_b32 s51,s51,2
buffer_load_dwordx4 v86,s[16:19],s45 offen offset:2048 nt lds
MXV 148,204,116
s_add_u32 s50,s50,s51
TRA 156,67,264
v_lshl_add_u32 v93,v94,3,v93
v_mfma_f32_16x16x32_bf16 v[144:147],a[204:207],v[112:115],0
TRA 158,67,2312
v_add_u32 v8,0x10000,v93
MXV 144,200,96
v_mul_u32_u24 v92,384,v92
v_mfma_f32_16x16x32_bf16 v[160:163],a[208:211],v[96:99],0
s_and_b32 s51,s2,3
v_lshl_add_u32 v92,v94,3,v92
s_waitcnt lgkmcnt(14)
MXV 160,212,112
s_add_u32 s50,s50,s51
buffer_load_dwordx4 v87,s[16:19],s45 offen offset:3072 nt lds
v_mul_u32_u24 v93,96,v1
v_mfma_f32_16x16x32_bf16 v[164:167],a[212:215],v[116:119],0
s_mul_i32 s50,s50,9216
MXV 164,208,100
s_add_u32 s50,s50,33554432
v_add_u32 v3,v92,v93
v_mfma_f32_16x16x32_bf16 v[168:171],a[208:211],v[104:107],0
s_add_u32 s28,s20,s50
s_addc_u32 s29,s21,0
v_xor_b32 v9,32,v8
MXV 168,212,120
s_mov_b32 s30,3548160
v_xor_b32 v10,64,v8
v_mfma_f32_16x16x32_bf16 v[172:175],a[212:215],v[124:127],0
v_xor_b32 v11,96,v8
MXV 172,208,108
v_xor_b32 v12,128,v8
v_mfma_f32_16x16x32_bf16 v[188:191],a[216:219],v[108:111],0
s_waitcnt lgkmcnt(0)
s_barrier
TRA 160,68,0
MXV 188,220,124
TRA 162,68,2048
v_xor_b32 v13,160,v8
v_mfma_f32_16x16x32_bf16 v[184:187],a[220:223],v[120:123],0
s_mov_b32 s41,384
v_xor_b32 v14,192,v8
MXV 184,216,104
s_add_u32 m0,s34,32768
TRA 164,64,32768
v_xor_b32 v15,224,v8
v_mfma_f32_16x16x32_bf16 v[180:183],a[216:219],v[100:103],0
s_mov_b32 s31,0x20000
buffer_load_dwordx4 v88,s[12:15],s41 offen offset:0 lds
v_add_u32 v95,0,v2
MXV 180,220,116
s_lshl_b32 s50,s2,7
TRA 166,64,34816
v_mul_u32_u24 v92,2731,v95
v_mfma_f32_16x16x32_bf16 v[176:179],a[220:223],v[112:115],0
TRA 168,68,8
MXV 176,216,96
TRA 170,68,2056
v_lshrrev_b32 v92,16,v92
v_mfma_f32_16x16x32_bf16 v[192:195],a[128:131],v[96:99],0
s_lshl_b32 s51,s32,2
v_mul_u32_u24 v62,24,v92
MXV 192,132,112
s_add_u32 s50,s50,s51
buffer_load_dwordx4 v89,s[12:15],s41 offen offset:1024 lds
v_sub_u32 v95,v95,v62
v_mfma_f32_16x16x32_bf16 v[196:199],a[132:135],v[116:119],0
s_add_u32 s50,s50,58720256
TRA 172,64,32776
v_lshl_add_u32 v92,v1,3,v92
MXV 196,128,100
s_add_u32 s88,s20,s50
s_addc_u32 s89,s21,0
TRA 174,64,34824
v_mul_u32_u24 v92,1152,v92
v_mfma_f32_16x16x32_bf16 v[200:203],a[128:131],v[104:107],0
s_mov_b32 s90,68
TRA 176,69,0
v_lshl_add_u32 v92,v95,4,v92
MXV 200,132,120
s_mov_b32 s91,0x20000
TRA 178,69,2048
v_mfma_f32_16x16x32_bf16 v[204:207],a[132:135],v[124:127],0
buffer_load_dwordx4 v90,s[12:15],s41 offen offset:2048 lds
v_subrev_u32 v92,0,v92
MXV 204,128,108
TRA 180,65,32768
v_add_u32 v95,64,v2
v_mfma_f32_16x16x32_bf16 v[220:223],a[136:139],v[108:111],0
s_lshl_b32 s50,s46,2
TRA 182,65,34816
v_mul_u32_u24 v93,2731,v95
MXV 220,140,124
s_add_u32 s50,s50,s32
v_lshrrev_b32 v93,16,v93
v_mfma_f32_16x16x32_bf16 v[216:219],a[140:143],v[120:123],0
s_lshl_b32 s50,s50,19
TRA 184,69,8
v_mul_u32_u24 v62,24,v93
MXV 216,136,104
s_lshl_b32 s51,s47,15
buffer_load_dwordx4 v91,s[12:15],s41 offen offset:3072 lds
v_mfma_f32_16x16x32_bf16 v[212:215],a[136:139],v[100:103],0
s_add_u32 s50,s50,s51
TRA 186,69,2056
v_sub_u32 v95,v95,v62
MXV 212,140,116
s_add_u32 s20,s20,s50
s_addc_u32 s21,s21,0
TRA 188,65,32776
v_lshl_add_u32 v93,v1,3,v93
v_mfma_f32_16x16x32_bf16 v[208:211],a[140:143],v[112:115],0
s_mov_b32 s45,1572864
TRA 190,65,34824
v_mul_u32_u24 v93,1152,v93
MXV 208,136,96
s_add_u32 m0,s34,65536
v_lshl_add_u32 v93,v95,4,v93
v_mfma_f32_16x16x32_bf16 v[224:227],a[144:147],v[96:99],0
s_mov_b32 s22,32768
buffer_load_dwordx4 v84,s[16:19],s45 offen offset:0 nt lds
v_subrev_u32 v93,1024,v93
MXV 224,148,112
s_mov_b32 s23,0x20000
TRA 192,70,0
v_mfma_f32_16x16x32_bf16 v[228:231],a[148:151],v[116:119],0
s_mov_b32 s38,0x3e0293ee
TRA 194,70,2048
v_add_u32 v95,128,v2
MXV 228,144,100
s_mov_b32 s40,0x4b800000
TRA 196,66,32768
v_mul_u32_u24 v94,2731,v95
v_mfma_f32_16x16x32_bf16 v[232:235],a[144:147],v[104:107],0
s_mov_b32 s39,0x2f800000
buffer_load_dwordx4 v85,s[16:19],s45 offen offset:1024 nt lds
v_lshrrev_b32 v94,16,v94
MXV 232,148,120
s_mov_b32 s96,0
TRA 198,66,34816
v_mul_u32_u24 v62,24,v94
v_mfma_f32_16x16x32_bf16 v[236:239],a[148:151],v[124:127],0
TRA 200,70,8
v_sub_u32 v95,v95,v62
MXV 236,144,108
TRA 202,70,2056
v_mfma_f32_16x16x32_bf16 v[252:255],a[152:155],v[108:111],0
s_mov_b32 s46,s94
buffer_load_dwordx4 v86,s[16:19],s45 offen offset:2048 nt lds
v_lshl_add_u32 v94,v1,3,v94
MXV 252,156,124
s_mov_b32 s47,s95
TRA 204,66,32776
v_mul_u32_u24 v94,1152,v94
v_mfma_f32_16x16x32_bf16 v[248:251],a[156:159],v[120:123],0
s_mov_b32 s36,65536
TRA 206,66,34824
v_lshl_add_u32 v94,v95,4,v94
MXV 248,152,104
s_mov_b32 s37,49152
v_subrev_u32 v94,2048,v94
v_mfma_f32_16x16x32_bf16 v[244:247],a[152:155],v[100:103],0
s_mov_b32 s94,3
buffer_load_dwordx4 v87,s[16:19],s45 offen offset:3072 nt lds
v_mov_b32 v63,0
MXV 244,156,116
s_mov_b32 s95,0
TRA 208,71,0
v_mfma_f32_16x16x32_bf16 v[240:243],a[156:159],v[112:115],0
TRA 210,71,2048
MXV 240,152,96
s_waitcnt lgkmcnt(14)
TRA 212,67,32768
MXA 0,160,28
s_mov_b32 s45,0
s_waitcnt vmcnt(20)
RD 96,80,49152
MXA 0,164,44
s_mul_i32 m0,s32,3072
RD 100,80,51200
MXA 4,164,48
buffer_load_dwordx4 v92,s[24:27],s45 offen offset:0 nt lds
MXA 4,160,32
RD 112,81,49152
MXA 8,160,36
RD 116,81,51200
MXA 8,164,52
TRA 214,67,34816
MXA 12,164,56
TRA 216,71,8
MXA 12,160,40
buffer_load_dwordx4 v93,s[24:27],s45 offen offset:1024 nt lds
MXA 28,168,40
TRA 218,71,2056
MXA 28,172,56
TRA 220,67,32776
MXA 24,172,52
TRA 222,67,34824
MXA 24,168,36
TRA 128,68,256
MXA 20,168,32
buffer_load_dwordx4 v94,s[24:27],s45 offen offset:2048 nt lds
MXA 20,172,48
TRA 130,68,2304
MXA 16,172,44
TRA 132,64,33024
MXA 16,168,28
TRA 134,64,35072
MXA 32,176,28
s_mov_b32 s45,1835008
TRA 136,68,264
MXA 32,180,44
s_add_u32 m0,s34,16384
TRA 138,68,2312
MXA 36,180,48
buffer_load_dwordx4 v84,s[16:19],s45 offen offset:0 nt lds
MXA 36,176,32
TRA 140,64,33032
MXA 40,176,36
TRA 142,64,35080
MXA 40,180,52
TRA 144,69,256
MXA 44,180,56
TRA 146,69,2304
MXA 44,176,40
s_waitcnt lgkmcnt(14)
TRA 148,65,33024
MXA 60,184,40
buffer_load_dwordx4 v85,s[16:19],s45 offen offset:1024 nt lds
MXA 60,188,56
TRA 150,65,35072
MXA 56,188,52
TRA 152,69,264
MXA 56,184,36
TRA 154,69,2312
MXA 52,184,32
MXA 52,188,48
TRA 156,65,33032
MXA 48,188,44
buffer_load_dwordx4 v86,s[16:19],s45 offen offset:2048 nt lds
MXA 48,184,28
TRA 158,65,35080
MXA 64,192,28
TRA 160,70,256
MXA 64,196,44
TRA 162,70,2304
MXA 68,196,48
MXA 68,192,32
TRA 164,66,33024
MXA 72,192,36
buffer_load_dwordx4 v87,s[16:19],s45 offen offset:3072 nt lds
MXA 72,196,52
TRA 166,66,35072
MXA 76,196,56
TRA 168,70,264
MXA 76,192,40
TRA 170,70,2312
MXA 92,200,40
s_mov_b32 s41,37248
MXA 92,204,56
s_add_u32 m0,s34,81920
TRA 172,66,33032
MXA 88,204,52
buffer_load_dwordx4 v88,s[12:15],s41 offen offset:0 lds
MXA 88,200,36
TRA 174,66,35080
MXA 84,200,32
TRA 176,71,256
MXA 84,204,48
TRA 178,71,2304
MXA 80,204,44
MXA 80,200,28
TRA 180,67,33024
MXA 96,208,28
buffer_load_dwordx4 v89,s[12:15],s41 offen offset:1024 lds
MXA 96,212,44
TRA 182,67,35072
MXA 100,212,48
TRA 184,71,264
MXA 100,208,32
TRA 186,71,2312
MXA 104,208,36
MXA 104,212,52
TRA 188,67,33032
MXA 108,212,56
buffer_load_dwordx4 v90,s[12:15],s41 offen offset:2048 lds
MXA 108,208,40
s_waitcnt lgkmcnt(14)
TRA 190,67,35080
MXA 124,216,40
MXA 124,220,56
MXA 120,220,52
MXA 120,216,36
MXA 116,216,32
buffer_load_dwordx4 v91,s[12:15],s41 offen offset:3072 lds
MXA 116,220,48
MXA 112,220,44
MXA 112,216,28
MXV 128,128,28
s_waitcnt vmcnt(23)
RD 104,82,0
MXV 128,132,44
RD 108,82,2048
MXV 132,132,48
RD 120,83,0
MXV 132,128,32
RD 124,83,2048
MXV 136,128,36
MXV 136,132,52
MXV 140,132,56
MXV 140,128,40
s_waitcnt lgkmcnt(0)
MXV 156,136,40
s_mov_b32 s41,512
MXV 156,140,56
s_add_u32 m0,s34,98304
MXV 152,140,52
buffer_load_dwordx4 v88,s[12:15],s41 offen offset:0 lds
MXV 152,136,36
MXV 148,136,32
MXV 148,140,48
MXV 144,140,44
MXV 144,136,28
MXV 160,144,28
buffer_load_dwordx4 v89,s[12:15],s41 offen offset:1024 lds
MXV 160,148,44
MXV 164,148,48
MXV 164,144,32
MXV 168,144,36
MXV 168,148,52
MXV 172,148,56
buffer_load_dwordx4 v90,s[12:15],s41 offen offset:2048 lds
MXV 172,144,40
MXV 188,152,40
s_waitcnt vmcnt(11)
s_barrier
TRA 192,68,16384
MXV 188,156,56
TRA 194,68,18432
MXV 184,156,52
TRA 224,3,0
MXV 184,152,36
TRA 196,68,32768
MXV 180,152,32
TRA 198,68,34816
MXV 180,156,48
buffer_load_dwordx4 v91,s[12:15],s41 offen offset:3072 lds
MXV 176,156,44
TRA 200,68,16392
MXV 176,152,28
TRA 202,68,18440
MXV 192,160,28
TRA 226,3,6144
MXV 192,164,44
TRA 204,68,32776
MXV 196,164,48
s_mov_b32 s45,2097152
TRA 206,68,34824
MXV 196,160,32
s_add_u32 m0,s34,114688
TRA 228,3,32
MXV 200,160,36
buffer_load_dwordx4 v84,s[16:19],s45 offen offset:0 nt lds
MXV 200,164,52
TRA 208,69,16384
MXV 204,164,56
TRA 210,69,18432
MXV 204,160,40
TRA 212,69,32768
MXV 220,168,40
TRA 214,69,34816
MXV 220,172,56
TRA 230,3,6176
MXV 216,172,52
TRA 216,69,16392
MXV 216,168,36
TRA 218,69,18440
MXV 212,168,32
buffer_load_dwordx4 v85,s[16:19],s45 offen offset:1024 nt lds
MXV 212,172,48
TRA 220,69,32776
MXV 208,172,44
TRA 222,69,34824
MXV 208,168,28
TRA 232,3,64
MXV 224,176,28
TRA 128,70,16384
MXV 224,180,44
TRA 130,70,18432
MXV 228,180,48
TRA 234,3,6208
MXV 228,176,32
TRA 132,70,32768
MXV 232,176,36
buffer_load_dwordx4 v86,s[16:19],s45 offen offset:2048 nt lds
MXV 232,180,52
TRA 134,70,34816
MXV 236,180,56
TRA 136,70,16392
MXV 236,176,40
TRA 138,70,18440
MXV 252,184,40
MXV 252,188,56
TRA 140,70,32776
MXV 248,188,52
TRA 142,70,34824
MXV 248,184,36
MXV 244,184,32
buffer_load_dwordx4 v87,s[16:19],s45 offen offset:3072 nt lds
MXV 244,188,48
TRA 144,71,16384
MXV 240,188,44
TRA 146,71,18432
MXV 240,184,28
s_waitcnt lgkmcnt(14)
TRA 148,71,32768
MXA 0,192,96
s_mov_b32 s45,2359296
RD 28,80,0
MXA 0,196,112
s_add_u32 m0,s34,49152
RD 32,80,2048
MXA 4,196,116
buffer_load_dwordx4 v84,s[16:19],s45 offen offset:0 nt lds
MXA 4,192,100
RD 44,81,0
MXA 8,192,104
RD 48,81,2048
MXA 8,196,120
TRA 150,71,34816
MXA 12,196,124
TRA 152,71,16392
MXA 12,192,108
TRA 154,71,18440
MXA 28,200,108
TRA 156,71,32776
MXA 28,204,124
TRA 158,71,34824
MXA 24,204,120
buffer_load_dwordx4 v85,s[16:19],s45 offen offset:1024 nt lds
MXA 24,200,104
TRA 160,68,16640
MXA 20,200,100
TRA 162,68,18688
MXA 20,204,116
TRA 164,68,33024
MXA 16,204,112
TRA 166,68,35072
MXA 16,200,96
TRA 168,68,16648
MXA 32,208,96
TRA 170,68,18696
MXA 32,212,112
TRA 172,68,33032
MXA 36,212,116
buffer_load_dwordx4 v86,s[16:19],s45 offen offset:2048 nt lds
MXA 36,208,100
TRA 174,68,35080
MXA 40,208,104
TRA 176,69,16640
MXA 40,212,120
TRA 178,69,18688
MXA 44,212,124
MXA 44,208,108
TRA 180,69,33024
MXA 60,216,108
s_waitcnt lgkmcnt(14)
TRA 182,69,35072
MXA 60,220,124
s_add_u32 s35,s32,0
MXA 56,220,120
s_mul_i32 s44,s35,43
buffer_load_dwordx4 v87,s[16:19],s45 offen offset:3072 nt lds
MXA 56,216,104
s_lshr_b32 s44,s44,7
TRA 184,69,16648
MXA 52,216,100
s_mul_i32 s44,s44,1170432
TRA 186,69,18696
MXA 52,220,116
s_mul_i32 s35,s35,3072
TRA 188,69,33032
MXA 48,220,112
s_add_u32 s48,s35,s44
TRA 190,69,35080
MXA 48,216,96
buffer_store_dwordx4 a[224:227],v60,s[28:31],s48 offen offset:0 sc1
MXA 64,128,96
s_mov_b32 s41,37376
TRA 192,70,16640
MXA 64,132,112
s_add_u32 m0,s34,32768
TRA 194,70,18688
MXA 68,132,116
buffer_load_dwordx4 v88,s[12:15],s41 offen offset:0 lds
MXA 68,128,100
TRA 196,70,33024
MXA 72,128,104
TRA 198,70,35072
MXA 72,132,120
MXA 76,132,124
TRA 200,70,16648
MXA 76,128,108
TRA 202,70,18696
MXA 92,136,108
MXA 92,140,124
TRA 204,70,33032
MXA 88,140,120
buffer_load_dwordx4 v89,s[12:15],s41 offen offset:1024 lds
MXA 88,136,104
TRA 206,70,35080
MXA 84,136,100
TRA 208,71,16640
MXA 84,140,116
TRA 210,71,18688
MXA 80,140,112
MXA 80,136,96
TRA 212,71,33024
MXA 96,144,96
TRA 214,71,35072
MXA 96,148,112
MXA 100,148,116
buffer_load_dwordx4 v90,s[12:15],s41 offen offset:2048 lds
MXA 100,144,100
TRA 216,71,16648
MXA 104,144,104
TRA 218,71,18696
MXA 104,148,120
TRA 220,71,33032
MXA 108,148,124
TRA 222,71,35080
MXA 108,144,108
s_waitcnt lgkmcnt(14)
MXA 124,152,108
MXA 124,156,124
MXA 120,156,120
buffer_load_dwordx4 v91,s[12:15],s41 offen offset:3072 lds
MXA 120,152,104
MXA 116,152,100
MXA 116,156,116
MXA 112,156,112
MXA 112,152,96
MXV 128,160,96
s_waitcnt vmcnt(17)
RD 36,80,49152
MXV 128,164,112
RD 40,80,51200
MXV 132,164,116
RD 52,81,49152
MXV 132,160,100
RD 56,81,51200
MXV 136,160,104
MXV 136,164,120
buffer_store_dwordx4 a[228:231],v60,s[28:31],s48 offen offset:1024 sc1
MXV 140,164,124
MXV 140,160,108
s_waitcnt lgkmcnt(0)
MXV 156,168,108
s_mov_b32 s41,640
MXV 156,172,124
s_add_u32 m0,s34,81920
MXV 152,172,120
buffer_load_dwordx4 v88,s[12:15],s41 offen offset:0 lds
MXV 152,168,104
MXV 148,168,100
MXV 148,172,116
MXV 144,172,112
buffer_load_dwordx4 v89,s[12:15],s41 offen offset:1024 lds
MXV 144,168,96
MXV 160,176,96
MXV 160,180,112
MXV 164,180,116
buffer_load_dwordx4 v90,s[12:15],s41 offen offset:2048 lds
MXV 164,176,100
MXV 168,176,104
MXV 168,180,120
MXV 172,180,124
buffer_load_dwordx4 v91,s[12:15],s41 offen offset:3072 lds
MXV 172,176,108
MXV 188,184,108
s_barrier
TRA 128,64,49152
MXV 188,188,124
TRA 130,64,51200
MXV 184,188,120
s_mov_b32 s45,384
MXV 184,184,104
s_mul_i32 m0,s32,3072
TRA 132,64,0
MXV 180,184,100
buffer_load_dwordx4 v92,s[24:27],s45 offen offset:0 nt lds
MXV 180,188,116
TRA 134,64,2048
MXV 176,188,112
TRA 136,64,49160
MXV 176,184,96
TRA 138,64,51208
MXV 192,192,96
MXV 192,196,112
buffer_load_dwordx4 v93,s[24:27],s45 offen offset:1024 nt lds
MXV 196,196,116
TRA 140,64,8
MXV 196,192,100
TRA 142,64,2056
MXV 200,192,104
TRA 144,65,49152
MXV 200,196,120
TRA 146,65,51200
MXV 204,196,124
buffer_load_dwordx4 v94,s[24:27],s45 offen offset:2048 nt lds
MXV 204,192,108
TRA 148,65,0
MXV 220,200,108
TRA 150,65,2048
MXV 220,204,124
MXV 216,204,120
s_mov_b32 s45,2621440
TRA 152,65,49160
MXV 216,200,104
s_add_u32 m0,s34,131072
TRA 154,65,51208
MXV 212,200,100
buffer_load_dwordx4 v84,s[16:19],s45 offen offset:0 nt lds
MXV 212,204,116
TRA 156,65,8
MXV 208,204,112
TRA 158,65,2056
MXV 208,200,96
MXV 224,208,96
TRA 160,66,49152
MXV 224,212,112
TRA 162,66,51200
MXV 228,212,116
buffer_load_dwordx4 v85,s[16:19],s45 offen offset:1024 nt lds
MXV 228,208,100
TRA 164,66,0
MXV 232,208,104
TRA 166,66,2048
MXV 232,212,120
MXV 236,212,124
TRA 168,66,49160
MXV 236,208,108
buffer_load_dwordx4 v86,s[16:19],s45 offen offset:2048 nt lds
MXV 252,216,108
TRA 170,66,51208
MXV 252,220,124
TRA 172,66,8
MXV 248,220,120
TRA 174,66,2056
MXV 248,216,104
MXV 244,216,100
buffer_load_dwordx4 v87,s[16:19],s45 offen offset:3072 nt lds
MXV 244,220,116
TRA 176,67,49152
MXV 240,220,112
TRA 178,67,51200
MXV 240,216,96
s_waitcnt lgkmcnt(14)
TRA 180,67,0
MXA 0,128,28
s_mov_b32 s45,2883584
s_waitcnt vmcnt(25)
RD 96,82,0
MXA 0,132,44
s_add_u32 m0,s34,147456
RD 100,82,2048
MXA 4,132,48
buffer_load_dwordx4 v84,s[16:19],s45 offen offset:0 nt lds
MXA 4,128,32
RD 112,83,0
MXA 8,128,36
RD 116,83,2048
MXA 8,132,52
TRA 182,67,2048
MXA 12,132,56
TRA 184,67,49160
MXA 12,128,40
TRA 186,67,51208
MXA 28,136,40
TRA 188,67,8
MXA 28,140,56
TRA 190,67,2056
MXA 24,140,52
buffer_load_dwordx4 v85,s[16:19],s45 offen offset:1024 nt lds
MXA 24,136,36
TRA 192,64,49408
MXA 20,136,32
TRA 194,64,51456
MXA 20,140,48
TRA 196,64,256
MXA 16,140,44
TRA 198,64,2304
MXA 16,136,28
TRA 200,64,49416
MXA 32,144,28
TRA 202,64,51464
MXA 32,148,44
TRA 204,64,264
MXA 36,148,48
buffer_load_dwordx4 v86,s[16:19],s45 offen offset:2048 nt lds
MXA 36,144,32
TRA 206,64,2312
MXA 40,144,36
TRA 208,65,49408
MXA 40,148,52
TRA 210,65,51456
MXA 44,148,56
MXA 44,144,40
s_waitcnt lgkmcnt(14)
TRA 212,65,256
MXA 60,152,40
TRA 214,65,2304
MXA 60,156,56
MXA 56,156,52
buffer_load_dwordx4 v87,s[16:19],s45 offen offset:3072 nt lds
MXA 56,152,36
TRA 216,65,49416
MXA 52,152,32
TRA 218,65,51464
MXA 52,156,48
TRA 220,65,264
MXA 48,156,44
buffer_store_dwordx4 a[232:235],v60,s[28:31],s48 offen offset:2048 sc1
MXA 48,152,28
TRA 222,65,2312
MXA 64,160,28
s_mov_b32 s41,37504
TRA 128,66,49408
MXA 64,164,44
s_add_u32 m0,s34,98304
TRA 130,66,51456
MXA 68,164,48
buffer_load_dwordx4 v88,s[12:15],s41 offen offset:0 lds
MXA 68,160,32
TRA 132,66,256
MXA 72,160,36
TRA 134,66,2304
MXA 72,164,52
MXA 76,164,56
TRA 136,66,49416
MXA 76,160,40
TRA 138,66,51464
MXA 92,168,40
MXA 92,172,56
TRA 140,66,264
MXA 88,172,52
buffer_load_dwordx4 v89,s[12:15],s41 offen offset:1024 lds
MXA 88,168,36
TRA 142,66,2312
MXA 84,168,32
TRA 144,67,49408
MXA 84,172,48
TRA 146,67,51456
MXA 80,172,44
MXA 80,168,28
TRA 148,67,256
MXA 96,176,28
TRA 150,67,2304
MXA 96,180,44
MXA 100,180,48
buffer_load_dwordx4 v90,s[12:15],s41 offen offset:2048 lds
MXA 100,176,32
TRA 152,67,49416
MXA 104,176,36
TRA 154,67,51464
MXA 104,180,52
TRA 156,67,264
MXA 108,180,56
TRA 158,67,2312
MXA 108,176,40
s_waitcnt lgkmcnt(14)
MXA 124,184,40
MXA 124,188,56
MXA 120,188,52
buffer_load_dwordx4 v91,s[12:15],s41 offen offset:3072 lds
MXA 120,184,36
MXA 116,184,32
MXA 116,188,48
MXA 112,188,44
MXA 112,184,28
MXV 128,192,28
s_waitcnt vmcnt(21)
RD 104,80,0
MXV 128,196,44
RD 108,80,2048
MXV 132,196,48
RD 120,81,0
MXV 132,192,32
RD 124,81,2048
MXV 136,192,36
MXV 136,196,52
MXV 140,196,56
MXV 140,192,40
s_waitcnt lgkmcnt(0)
MXV 156,200,40
s_mov_b32 s41,768
MXV 156,204,56
s_add_u32 m0,s34,32768
MXV 152,204,52
buffer_load_dwordx4 v88,s[12:15],s41 offen offset:0 lds
MXV 152,200,36
MXV 148,200,32
MXV 148,204,48
MXV 144,204,44
MXV 144,200,28
MXV 160,208,28
buffer_load_dwordx4 v89,s[12:15],s41 offen offset:1024 lds
MXV 160,212,44
MXV 164,212,48
MXV 164,208,32
MXV 168,208,36
MXV 168,212,52
MXV 172,212,56
buffer_load_dwordx4 v90,s[12:15],s41 offen offset:2048 lds
MXV 172,208,40
MXV 188,216,40
s_waitcnt vmcnt(16)
s_barrier
TRA 160,68,0
MXV 188,220,56
TRA 162,68,2048
MXV 184,220,52
TRA 236,3,0
MXV 184,216,36
TRA 164,64,32768
MXV 180,216,32
TRA 166,64,34816
MXV 180,220,48
buffer_load_dwordx4 v91,s[12:15],s41 offen offset:3072 lds
MXV 176,220,44
TRA 168,68,8
MXV 176,216,28
TRA 170,68,2056
MXV 192,128,28
TRA 238,3,6144
MXV 192,132,44
TRA 172,64,32776
MXV 196,132,48
s_mov_b32 s45,3145728
TRA 174,64,34824
MXV 196,128,32
s_add_u32 m0,s34,65536
TRA 240,3,32
MXV 200,128,36
buffer_load_dwordx4 v84,s[16:19],s45 offen offset:0 nt lds
MXV 200,132,52
TRA 176,69,0
MXV 204,132,56
TRA 178,69,2048
MXV 204,128,40
TRA 180,65,32768
MXV 220,136,40
TRA 182,65,34816
MXV 220,140,56
TRA 242,3,6176
MXV 216,140,52
TRA 184,69,8
MXV 216,136,36
TRA 186,69,2056
MXV 212,136,32
buffer_load_dwordx4 v85,s[16:19],s45 offen offset:1024 nt lds
MXV 212,140,48
TRA 188,65,32776
MXV 208,140,44
TRA 190,65,34824
MXV 208,136,28
TRA 244,3,64
MXV 224,144,28
TRA 192,70,0
MXV 224,148,44
TRA 194,70,2048
MXV 228,148,48
TRA 246,3,6208
MXV 228,144,32
TRA 196,66,32768
MXV 232,144,36
buffer_load_dwordx4 v86,s[16:19],s45 offen offset:2048 nt lds
MXV 232,148,52
TRA 198,66,34816
MXV 236,148,56
TRA 200,70,8
MXV 236,144,40
TRA 202,70,2056
MXV 252,152,40
MXV 252,156,56
TRA 204,66,32776
MXV 248,156,52
TRA 206,66,34824
MXV 248,152,36
MXV 244,152,32
buffer_load_dwordx4 v87,s[16:19],s45 offen offset:3072 nt lds
MXV 244,156,48
TRA 208,71,0
MXV 240,156,44
TRA 210,71,2048
MXV 240,152,28
s_waitcnt lgkmcnt(14)
TRA 212,67,32768
MXA 0,160,96
s_mov_b32 s45,3407872
RD 28,80,49152
MXA 0,164,112
s_add_u32 m0,s34,16384
RD 32,80,51200
MXA 4,164,116
buffer_load_dwordx4 v84,s[16:19],s45 offen offset:0 nt lds
MXA 4,160,100
RD 44,81,49152
MXA 8,160,104
RD 48,81,51200
MXA 8,164,120
TRA 214,67,34816
MXA 12,164,124
TRA 216,71,8
MXA 12,160,108
TRA 218,71,2056
MXA 28,168,108
TRA 220,67,32776
MXA 28,172,124
TRA 222,67,34824
MXA 24,172,120
buffer_load_dwordx4 v85,s[16:19],s45 offen offset:1024 nt lds
MXA 24,168,104
TRA 128,68,256
MXA 20,168,100
TRA 130,68,2304
MXA 20,172,116
TRA 132,64,33024
MXA 16,172,112
TRA 134,64,35072
MXA 16,168,96
TRA 136,68,264
MXA 32,176,96
TRA 138,68,2312
MXA 32,180,112
TRA 140,64,33032
MXA 36,180,116
buffer_load_dwordx4 v86,s[16:19],s45 offen offset:2048 nt lds
MXA 36,176,100
TRA 142,64,35080
MXA 40,176,104
TRA 144,69,256
MXA 40,180,120
TRA 146,69,2304
MXA 44,180,124
MXA 44,176,108
TRA 148,65,33024
MXA 60,184,108
s_waitcnt lgkmcnt(14)
TRA 150,65,35072
MXA 60,188,124
s_add_u32 s35,s32,4
MXA 56,188,120
s_mul_i32 s44,s35,43
buffer_load_dwordx4 v87,s[16:19],s45 offen offset:3072 nt lds
MXA 56,184,104
s_lshr_b32 s44,s44,7
TRA 152,69,264
MXA 52,184,100
s_mul_i32 s44,s44,1170432
TRA 154,69,2312
MXA 52,188,116
s_mul_i32 s35,s35,3072
TRA 156,65,33032
MXA 48,188,112
s_add_u32 s48,s35,s44
TRA 158,65,35080
MXA 48,184,96
buffer_store_dwordx4 a[236:239],v60,s[28:31],s48 offen offset:0 sc1
MXA 64,192,96
s_mov_b32 s41,37632
TRA 160,70,256
MXA 64,196,112
s_add_u32 m0,s34,81920
TRA 162,70,2304
MXA 68,196,116
buffer_load_dwordx4 v88,s[12:15],s41 offen offset:0 lds
MXA 68,192,100
TRA 164,66,33024
MXA 72,192,104
TRA 166,66,35072
MXA 72,196,120
MXA 76,196,124
TRA 168,70,264
MXA 76,192,108
TRA 170,70,2312
MXA 92,200,108
MXA 92,204,124
TRA 172,66,33032
MXA 88,204,120
buffer_load_dwordx4 v89,s[12:15],s41 offen offset:1024 lds
MXA 88,200,104
TRA 174,66,35080
MXA 84,200,100
TRA 176,71,256
MXA 84,204,116
TRA 178,71,2304
MXA 80,204,112
MXA 80,200,96
TRA 180,67,33024
MXA 96,208,96
TRA 182,67,35072
MXA 96,212,112
MXA 100,212,116
buffer_load_dwordx4 v90,s[12:15],s41 offen offset:2048 lds
MXA 100,208,100
TRA 184,71,264
MXA 104,208,104
TRA 186,71,2312
MXA 104,212,120
TRA 188,67,33032
MXA 108,212,124
TRA 190,67,35080
MXA 108,208,108
s_waitcnt lgkmcnt(14)
MXA 124,216,108
MXA 124,220,124
MXA 120,220,120
buffer_load_dwordx4 v91,s[12:15],s41 offen offset:3072 lds
MXA 120,216,104
MXA 116,216,100
MXA 116,220,116
MXA 112,220,112
MXA 112,216,96
MXV 128,128,96
s_waitcnt vmcnt(17)
RD 36,82,0
MXV 128,132,112
RD 40,82,2048
MXV 132,132,116
RD 52,83,0
MXV 132,128,100
RD 56,83,2048
MXV 136,128,104
MXV 136,132,120
buffer_store_dwordx4 a[240:243],v60,s[28:31],s48 offen offset:1024 sc1
MXV 140,132,124
MXV 140,128,108
s_waitcnt lgkmcnt(0)
MXV 156,136,108
s_mov_b32 s41,896
MXV 156,140,124
s_add_u32 m0,s34,98304
MXV 152,140,120
buffer_load_dwordx4 v88,s[12:15],s41 offen offset:0 lds
MXV 152,136,104
MXV 148,136,100
MXV 148,140,116
MXV 144,140,112
buffer_load_dwordx4 v89,s[12:15],s41 offen offset:1024 lds
MXV 144,136,96
MXV 160,144,96
MXV 160,148,112
MXV 164,148,116
buffer_load_dwordx4 v90,s[12:15],s41 offen offset:2048 lds
MXV 164,144,100
MXV 168,144,104
MXV 168,148,120
MXV 172,148,124
buffer_load_dwordx4 v91,s[12:15],s41 offen offset:3072 lds
MXV 172,144,108
MXV 188,152,108
s_barrier
TRA 192,68,16384
MXV 188,156,124
TRA 194,68,18432
MXV 184,156,120
s_mov_b32 s45,768
MXV 184,152,104
s_mul_i32 m0,s32,3072
TRA 196,68,32768
MXV 180,152,100
buffer_load_dwordx4 v92,s[24:27],s45 offen offset:0 nt lds
MXV 180,156,116
TRA 198,68,34816
MXV 176,156,112
TRA 200,68,16392
MXV 176,152,96
TRA 202,68,18440
MXV 192,160,96
MXV 192,164,112
buffer_load_dwordx4 v93,s[24:27],s45 offen offset:1024 nt lds
MXV 196,164,116
TRA 204,68,32776
MXV 196,160,100
TRA 206,68,34824
MXV 200,160,104
TRA 208,69,16384
MXV 200,164,120
TRA 210,69,18432
MXV 204,164,124
buffer_load_dwordx4 v94,s[24:27],s45 offen offset:2048 nt lds
MXV 204,160,108
TRA 212,69,32768
MXV 220,168,108
TRA 214,69,34816
MXV 220,172,124
MXV 216,172,120
s_mov_b32 s45,3670016
TRA 216,69,16392
MXV 216,168,104
s_add_u32 m0,s34,114688
TRA 218,69,18440
MXV 212,168,100
buffer_load_dwordx4 v84,s[16:19],s45 offen offset:0 nt lds
MXV 212,172,116
TRA 220,69,32776
MXV 208,172,112
TRA 222,69,34824
MXV 208,168,96
MXV 224,176,96
TRA 128,70,16384
MXV 224,180,112
TRA 130,70,18432
MXV 228,180,116
buffer_load_dwordx4 v85,s[16:19],s45 offen offset:1024 nt lds
MXV 228,176,100
TRA 132,70,32768
MXV 232,176,104
TRA 134,70,34816
MXV 232,180,120
MXV 236,180,124
TRA 136,70,16392
MXV 236,176,108
buffer_load_dwordx4 v86,s[16:19],s45 offen offset:2048 nt lds
MXV 252,184,108
TRA 138,70,18440
MXV 252,188,124
TRA 140,70,32776
MXV 248,188,120
TRA 142,70,34824
MXV 248,184,104
MXV 244,184,100
buffer_load_dwordx4 v87,s[16:19],s45 offen offset:3072 nt lds
MXV 244,188,116
TRA 144,71,16384
MXV 240,188,112
TRA 146,71,18432
MXV 240,184,96
s_waitcnt lgkmcnt(14)
TRA 148,71,32768
MXA 0,192,28
s_mov_b32 s45,3932160
s_waitcnt vmcnt(25)
RD 96,80,0
MXA 0,196,44
s_add_u32 m0,s34,49152
RD 100,80,2048
MXA 4,196,48
buffer_load_dwordx4 v84,s[16:19],s45 offen offset:0 nt lds
MXA 4,192,32
RD 112,81,0
MXA 8,192,36
RD 116,81,2048
MXA 8,196,52
TRA 150,71,34816
MXA 12,196,56
TRA 152,71,16392
MXA 12,192,40
TRA 154,71,18440
MXA 28,200,40
TRA 156,71,32776
MXA 28,204,56
TRA 158,71,34824
MXA 24,204,52
buffer_load_dwordx4 v85,s[16:19],s45 offen offset:1024 nt lds
MXA 24,200,36
TRA 160,68,16640
MXA 20,200,32
TRA 162,68,18688
MXA 20,204,48
TRA 164,68,33024
MXA 16,204,44
TRA 166,68,35072
MXA 16,200,28
TRA 168,68,16648
MXA 32,208,28
TRA 170,68,18696
MXA 32,212,44
TRA 172,68,33032
MXA 36,212,48
buffer_load_dwordx4 v86,s[16:19],s45 offen offset:2048 nt lds
MXA 36,208,32
TRA 174,68,35080
MXA 40,208,36
TRA 176,69,16640
MXA 40,212,52
TRA 178,69,18688
MXA 44,212,56
MXA 44,208,40
s_waitcnt lgkmcnt(14)
TRA 180,69,33024
MXA 60,216,40
TRA 182,69,35072
MXA 60,220,56
MXA 56,220,52
buffer_load_dwordx4 v87,s[16:19],s45 offen offset:3072 nt lds
MXA 56,216,36
TRA 184,69,16648
MXA 52,216,32
TRA 186,69,18696
MXA 52,220,48
TRA 188,69,33032
MXA 48,220,44
buffer_store_dwordx4 a[244:247],v60,s[28:31],s48 offen offset:2048 sc1
MXA 48,216,28
TRA 190,69,35080
MXA 64,128,28
s_mov_b32 s41,37760
TRA 192,70,16640
MXA 64,132,44
s_add_u32 m0,s34,32768
TRA 194,70,18688
MXA 68,132,48
buffer_load_dwordx4 v88,s[12:15],s41 offen offset:0 lds
MXA 68,128,32
TRA 196,70,33024
MXA 72,128,36
TRA 198,70,35072
MXA 72,132,52
MXA 76,132,56
TRA 200,70,16648
MXA 76,128,40
TRA 202,70,18696
MXA 92,136,40
MXA 92,140,56
TRA 204,70,33032
MXA 88,140,52
buffer_load_dwordx4 v89,s[12:15],s41 offen offset:1024 lds
MXA 88,136,36
TRA 206,70,35080
MXA 84,136,32
TRA 208,71,16640
MXA 84,140,48
TRA 210,71,18688
MXA 80,140,44
MXA 80,136,28
TRA 212,71,33024
MXA 96,144,28
TRA 214,71,35072
MXA 96,148,44
MXA 100,148,48
buffer_load_dwordx4 v90,s[12:15],s41 offen offset:2048 lds
MXA 100,144,32
TRA 216,71,16648
MXA 104,144,36
TRA 218,71,18696
MXA 104,148,52
TRA 220,71,33032
MXA 108,148,56
TRA 222,71,35080
MXA 108,144,40
s_waitcnt lgkmcnt(14)
MXA 124,152,40
MXA 124,156,56
MXA 120,156,52
buffer_load_dwordx4 v91,s[12:15],s41 offen offset:3072 lds
MXA 120,152,36
MXA 116,152,32
MXA 116,156,48
MXA 112,156,44
MXA 112,152,28
MXV 128,160,28
s_waitcnt vmcnt(21)
RD 104,80,49152
MXV 128,164,44
RD 108,80,51200
MXV 132,164,48
RD 120,81,49152
MXV 132,160,32
RD 124,81,51200
MXV 136,160,36
MXV 136,164,52
MXV 140,164,56
MXV 140,160,40
s_waitcnt lgkmcnt(0)
MXV 156,168,40
s_mov_b32 s41,1024
MXV 156,172,56
s_add_u32 m0,s34,81920
MXV 152,172,52
buffer_load_dwordx4 v88,s[12:15],s41 offen offset:0 lds
MXV 152,168,36
MXV 148,168,32
MXV 148,172,48
MXV 144,172,44
MXV 144,168,28
MXV 160,176,28
buffer_load_dwordx4 v89,s[12:15],s41 offen offset:1024 lds
MXV 160,180,44
MXV 164,180,48
MXV 164,176,32
MXV 168,176,36
MXV 168,180,52
MXV 172,180,56
buffer_load_dwordx4 v90,s[12:15],s41 offen offset:2048 lds
MXV 172,176,40
MXV 188,184,40
s_waitcnt vmcnt(16)
s_barrier
TRA 128,64,49152
MXV 188,188,56
TRA 130,64,51200
MXV 184,188,52
TRA 248,3,0
MXV 184,184,36
TRA 132,64,0
MXV 180,184,32
TRA 134,64,2048
MXV 180,188,48
buffer_load_dwordx4 v91,s[12:15],s41 offen offset:3072 lds
MXV 176,188,44
TRA 136,64,49160
MXV 176,184,28
TRA 138,64,51208
MXV 192,192,28
TRA 250,3,6144
MXV 192,196,44
TRA 140,64,8
MXV 196,196,48
s_mov_b32 s45,4194304
TRA 142,64,2056
MXV 196,192,32
s_add_u32 m0,s34,131072
TRA 252,3,32
MXV 200,192,36
buffer_load_dwordx4 v84,s[16:19],s45 offen offset:0 nt lds
MXV 200,196,52
TRA 144,65,49152
MXV 204,196,56
TRA 146,65,51200
MXV 204,192,40
TRA 148,65,0
MXV 220,200,40
TRA 150,65,2048
MXV 220,204,56
TRA 254,3,6176
MXV 216,204,52
TRA 152,65,49160
MXV 216,200,36
TRA 154,65,51208
MXV 212,200,32
buffer_load_dwordx4 v85,s[16:19],s45 offen offset:1024 nt lds
MXV 212,204,48
TRA 156,65,8
MXV 208,204,44
TRA 158,65,2056
MXV 208,200,28
TR 92,3,64
MXV 224,208,28
TRA 160,66,49152
MXV 224,212,44
TRA 162,66,51200
MXV 228,212,48
TR 94,3,6208
MXV 228,208,32
TRA 164,66,0
MXV 232,208,36
buffer_load_dwordx4 v86,s[16:19],s45 offen offset:2048 nt lds
MXV 232,212,52
TRA 166,66,2048
MXV 236,212,56
TRA 168,66,49160
MXV 236,208,40
TRA 170,66,51208
MXV 252,216,40
MXV 252,220,56
TRA 172,66,8
MXV 248,220,52
TRA 174,66,2056
MXV 248,216,36
MXV 244,216,32
buffer_load_dwordx4 v87,s[16:19],s45 offen offset:3072 nt lds
MXV 244,220,48
TRA 176,67,49152
MXV 240,220,44
TRA 178,67,51200
MXV 240,216,28
s_waitcnt lgkmcnt(14)
TRA 180,67,0
MXA 0,128,96
s_mov_b32 s45,4456448
RD 28,82,0
MXA 0,132,112
s_add_u32 m0,s34,147456
RD 32,82,2048
MXA 4,132,116
buffer_load_dwordx4 v84,s[16:19],s45 offen offset:0 nt lds
MXA 4,128,100
RD 44,83,0
MXA 8,128,104
RD 48,83,2048
MXA 8,132,120
TRA 182,67,2048
MXA 12,132,124
TRA 184,67,49160
MXA 12,128,108
TRA 186,67,51208
MXA 28,136,108
TRA 188,67,8
MXA 28,140,124
s_add_u32 s35,s32,8
TRA 190,67,2056
MXA 24,140,120
s_mul_i32 s44,s35,43
buffer_load_dwordx4 v85,s[16:19],s45 offen offset:1024 nt lds
MXA 24,136,104
s_lshr_b32 s44,s44,7
TRA 192,64,49408
MXA 20,136,100
s_mul_i32 s44,s44,1170432
TRA 194,64,51456
MXA 20,140,116
s_mul_i32 s35,s35,3072
TRA 196,64,256
MXA 16,140,112
s_add_u32 s48,s35,s44
TRA 198,64,2304
MXA 16,136,96
buffer_store_dwordx4 a[248:251],v60,s[28:31],s48 offen offset:0 sc1
MXA 32,144,96
TRA 200,64,49416
MXA 32,148,112
TRA 202,64,51464
MXA 36,148,116
buffer_load_dwordx4 v86,s[16:19],s45 offen offset:2048 nt lds
MXA 36,144,100
TRA 204,64,264
MXA 40,144,104
TRA 206,64,2312
MXA 40,148,120
TRA 208,65,49408
MXA 44,148,124
TRA 210,65,51456
MXA 44,144,108
TRA 212,65,256
MXA 60,152,108
s_waitcnt lgkmcnt(14)
TRA 214,65,2304
MXA 60,156,124
MXA 56,156,120
buffer_load_dwordx4 v87,s[16:19],s45 offen offset:3072 nt lds
MXA 56,152,104
TRA 216,65,49416
MXA 52,152,100
TRA 218,65,51464
MXA 52,156,116
TRA 220,65,264
MXA 48,156,112
TRA 222,65,2312
MXA 48,152,96
MXA 64,160,96
s_mov_b32 s41,37888
TRA 128,66,49408
MXA 64,164,112
s_add_u32 m0,s34,98304
TRA 130,66,51456
MXA 68,164,116
buffer_load_dwordx4 v88,s[12:15],s41 offen offset:0 lds
MXA 68,160,100
TRA 132,66,256
MXA 72,160,104
TRA 134,66,2304
MXA 72,164,120
MXA 76,164,124
buffer_store_dwordx4 a[252:255],v60,s[28:31],s48 offen offset:1024 sc1
MXA 76,160,108
TRA 136,66,49416
MXA 92,168,108
TRA 138,66,51464
MXA 92,172,124
TRA 140,66,264
MXA 88,172,120
buffer_load_dwordx4 v89,s[12:15],s41 offen offset:1024 lds
MXA 88,168,104
TRA 142,66,2312
MXA 84,168,100
TRA 144,67,49408
v_mov_b32 v3,0
MXA 84,172,116
TRA 146,67,51456
MXA 80,172,112
buffer_store_dword v3,v60,s[88:91],0 offen sc1
MXA 80,168,96
TRA 148,67,256
MXA 96,176,96
TRA 150,67,2304
MXA 96,180,112
MXA 100,180,116
buffer_load_dwordx4 v90,s[12:15],s41 offen offset:2048 lds
MXA 100,176,100
TRA 152,67,49416
MXA 104,176,104
TRA 154,67,51464
MXA 104,180,120
TRA 156,67,264
MXA 108,180,124
TRA 158,67,2312
MXA 108,176,108
s_waitcnt lgkmcnt(14)
MXA 124,184,108
MXA 124,188,124
MXA 120,188,120
buffer_load_dwordx4 v91,s[12:15],s41 offen offset:3072 lds
MXA 120,184,104
MXA 116,184,100
MXA 116,188,116
MXA 112,188,112
buffer_store_dwordx4 v[92:95],v60,s[28:31],s48 offen offset:2048 sc1
MXA 112,184,96
MXV 128,192,96
s_waitcnt vmcnt(20)
RD 36,80,0
MXV 128,196,112
RD 40,80,2048
MXV 132,196,116
RD 52,81,0
MXV 132,192,100
RD 56,81,2048
MXV 136,192,104
MXV 136,196,120
MXV 140,196,124
MXV 140,192,108
MXV 156,200,108
MXV 156,204,124
MXV 152,204,120
MXV 152,200,104
MXV 148,200,100
MXV 148,204,116
MXV 144,204,112
MXV 144,200,96
MXV 160,208,96
MXV 160,212,112
MXV 164,212,116
MXV 164,208,100
MXV 168,208,104
MXV 168,212,120
MXV 172,212,124
MXV 172,208,108
MXV 188,216,108
s_waitcnt lgkmcnt(0)
s_barrier
TRA 160,68,0
MXV 188,220,124
TRA 162,68,2048
MXV 184,220,120
s_mov_b32 s45,0
TRA 168,64,32768
MXV 184,216,104
s_add_u32 m0,s34,0
TRA 170,64,34816
MXV 180,216,100
buffer_load_dwordx4 v24,s[4:7],s45 offen offset:0 nt lds
MXV 180,220,116
TRA 164,68,8
MXV 176,220,112
TRA 166,68,2056
MXV 176,216,96
TRA 172,64,32776
MXV 192,128,96
TRA 174,64,34824
MXV 192,132,112
buffer_load_dwordx4 v25,s[4:7],s45 offen offset:1024 nt lds
MXV 196,132,116
MXV 196,128,100
MXV 200,128,104
MXV 200,132,120
MXV 204,132,124
buffer_load_dwordx4 v26,s[4:7],s45 offen offset:2048 nt lds
MXV 204,128,108
MXV 220,136,108
MXV 220,140,124
MXV 216,140,120
MXV 216,136,104
buffer_load_dwordx4 v27,s[4:7],s45 offen offset:3072 nt lds
MXV 212,136,100
MXV 212,140,116
MXV 208,140,112
s_mov_b32 s45,0
MXV 208,136,96
s_add_u32 m0,s34,65536
MXV 224,144,96
buffer_load_dwordx4 v20,s[8:11],s45 offen offset:0 nt lds
MXV 224,148,112
MXV 228,148,116
MXV 228,144,100
MXV 232,144,104
buffer_load_dwordx4 v21,s[8:11],s45 offen offset:1024 nt lds
MXV 232,148,120
MXV 236,148,124
MXV 236,144,108
MXV 252,152,108
buffer_load_dwordx4 v22,s[8:11],s45 offen offset:2048 nt lds
MXV 252,156,124
MXV 248,156,120
MXV 248,152,104
MXV 244,152,100
buffer_load_dwordx4 v23,s[8:11],s45 offen offset:3072 nt lds
MXV 244,156,116
MXV 240,156,112
s_waitcnt vmcnt(9) lgkmcnt(0)
s_barrier
MXV 240,152,96
MXA 0,160,28
RD 96,80,49152
MXA 0,168,44
RD 100,80,51200
MXA 4,168,48
RD 112,81,49152
MXA 4,160,32
RD 116,81,51200
MXA 8,160,36
TRA 176,68,16384
MXA 8,168,52
TRA 178,68,18432
MXA 12,168,56
TRA 184,68,32768
MXA 12,160,40
TRA 186,68,34816
MXA 16,164,28
RD 104,82,0
MXA 16,172,44
RD 108,82,2048
MXA 20,172,48
RD 120,83,0
MXA 20,164,32
RD 124,83,2048
MXA 24,164,36
TRA 180,68,16392
MXA 24,172,52
TRA 182,68,18440
MXA 28,172,56
TRA 188,68,32776
MXA 28,164,40
s_waitcnt lgkmcnt(9)
TRA 190,68,34824
MXA 0,176,96
s_waitcnt lgkmcnt(8)
TRA 192,69,0
MXA 0,184,112
TRA 194,69,2048
MXA 4,184,116
s_mov_b32 s45,16384
TRA 200,65,32768
MXA 4,176,100
s_add_u32 m0,s34,16384
TRA 202,65,34816
s_waitcnt lgkmcnt(11)
MXA 8,176,104
s_waitcnt lgkmcnt(9)
buffer_load_dwordx4 v24,s[4:7],s45 offen offset:0 nt lds
MXA 8,184,120
s_waitcnt lgkmcnt(8)
TRA 208,69,16384
MXA 12,184,124
TRA 210,69,18432
MXA 12,176,108
s_waitcnt lgkmcnt(8)
TRA 216,69,32768
MXA 16,180,96
s_waitcnt lgkmcnt(7)
TRA 218,69,34816
MXA 16,188,112
TRA 196,69,8
MXA 20,188,116
TRA 198,69,2056
MXA 20,180,100
TRA 204,65,32776
MXA 24,180,104
TRA 206,65,34824
MXA 24,188,120
TRA 212,69,16392
MXA 28,188,124
TRA 214,69,18440
MXA 28,180,108
s_waitcnt lgkmcnt(12)
TRA 220,69,32776
MXA 32,192,28
s_waitcnt lgkmcnt(11)
TRA 222,69,34824
MXA 32,200,44
s_waitcnt lgkmcnt(10)
buffer_load_dwordx4 v25,s[4:7],s45 offen offset:1024 nt lds
v_accvgpr_read_b32 v84,a0
v_accvgpr_read_b32 v85,a1
v_accvgpr_read_b32 v86,a2
v_accvgpr_read_b32 v87,a3
MXA 32,208,96
s_waitcnt lgkmcnt(8)
TRA 160,70,0
v_mul_f32 v84,s38,v84
v_mul_f32 v85,s38,v85
v_mul_f32 v86,s38,v86
MXA 32,216,112
TRA 162,70,2048
v_mul_f32 v87,s38,v87
CV 84,84,85
CV 85,86,87
MXA 36,216,116
TRA 168,66,32768
v_accvgpr_read_b32 v88,a4
v_accvgpr_read_b32 v89,a5
v_accvgpr_read_b32 v90,a6
MXA 36,208,100
TRA 170,66,34816
v_accvgpr_read_b32 v91,a7
v_mul_f32 v88,s38,v88
v_mul_f32 v89,s38,v89
MXA 36,200,48
TRA 176,70,16384
v_mul_f32 v90,s38,v90
v_mul_f32 v91,s38,v91
v_accvgpr_write_b32 a128,v84
v_accvgpr_write_b32 a129,v85
MXA 36,192,32
TRA 178,70,18432
CV 88,88,89
CV 89,90,91
v_accvgpr_read_b32 v92,a8
MXA 40,192,36
v_accvgpr_read_b32 v93,a9
v_accvgpr_read_b32 v94,a10
v_accvgpr_read_b32 v95,a11
MXA 40,200,52
TRA 184,70,32768
v_mul_f32 v92,s38,v92
v_mul_f32 v93,s38,v93
v_mul_f32 v94,s38,v94
MXA 40,208,104
TRA 186,70,34816
v_mul_f32 v95,s38,v95
v_accvgpr_write_b32 a132,v88
v_accvgpr_write_b32 a133,v89
MXA 40,216,120
CV 92,92,93
CV 93,94,95
v_accvgpr_read_b32 v84,a12
v_accvgpr_read_b32 v85,a13
MXA 44,216,124
TRA 164,70,8
v_accvgpr_read_b32 v86,a14
v_accvgpr_read_b32 v87,a15
v_mul_f32 v84,s38,v84
MXA 44,208,108
TRA 166,70,2056
v_mul_f32 v85,s38,v85
v_mul_f32 v86,s38,v86
v_mul_f32 v87,s38,v87
MXA 44,200,56
buffer_load_dwordx4 v26,s[4:7],s45 offen offset:2048 nt lds
v_accvgpr_write_b32 a136,v92
v_accvgpr_write_b32 a137,v93
CV 84,84,85
MXA 44,192,40
s_waitcnt lgkmcnt(14)
TRA 172,66,32776
CV 85,86,87
v_accvgpr_read_b32 v88,a16
v_accvgpr_read_b32 v89,a17
MXA 48,196,28
TRA 174,66,34824
v_accvgpr_read_b32 v90,a18
v_accvgpr_read_b32 v91,a19
v_mul_f32 v88,s38,v88
v_mul_f32 v89,s38,v89
MXA 48,204,44
s_waitcnt lgkmcnt(14)
v_mul_f32 v90,s38,v90
v_mul_f32 v91,s38,v91
v_accvgpr_write_b32 a140,v84
MXA 48,212,96
s_waitcnt lgkmcnt(12)
TRA 180,70,16392
v_accvgpr_write_b32 a141,v85
CV 88,88,89
CV 89,90,91
MXA 48,220,112
TRA 182,70,18440
v_accvgpr_read_b32 v92,a20
v_accvgpr_read_b32 v93,a21
v_accvgpr_read_b32 v94,a22
MXA 52,220,116
v_accvgpr_read_b32 v95,a23
v_mul_f32 v92,s38,v92
v_mul_f32 v93,s38,v93
MXA 52,212,100
TRA 188,70,32776
v_mul_f32 v94,s38,v94
v_mul_f32 v95,s38,v95
v_accvgpr_write_b32 a130,v88
v_accvgpr_write_b32 a131,v89
MXA 52,204,48
TRA 190,70,34824
CV 92,92,93
CV 93,94,95
v_accvgpr_read_b32 v84,a24
MXA 52,196,32
v_accvgpr_read_b32 v85,a25
v_accvgpr_read_b32 v86,a26
v_accvgpr_read_b32 v87,a27
MXA 56,196,36
v_mul_f32 v84,s38,v84
v_mul_f32 v85,s38,v85
v_mul_f32 v86,s38,v86
MXA 56,204,52
v_mul_f32 v87,s38,v87
v_accvgpr_write_b32 a134,v92
v_accvgpr_write_b32 a135,v93
MXA 56,212,104
CV 84,84,85
CV 85,86,87
v_accvgpr_read_b32 v88,a28
v_accvgpr_read_b32 v89,a29
MXA 56,220,120
buffer_load_dwordx4 v27,s[4:7],s45 offen offset:3072 nt lds
v_accvgpr_read_b32 v90,a30
v_accvgpr_read_b32 v91,a31
v_mul_f32 v88,s38,v88
MXA 60,220,124
v_mul_f32 v89,s38,v89
v_mul_f32 v90,s38,v90
v_mul_f32 v91,s38,v91
MXA 60,212,108
v_accvgpr_write_b32 a138,v84
v_accvgpr_write_b32 a139,v85
CV 88,88,89
MXA 60,204,56
CV 89,90,91
v_accvgpr_write_b32 a142,v88
v_accvgpr_write_b32 a143,v89
MXA 60,196,40
s_waitcnt lgkmcnt(14)
MXA 64,160,28
s_waitcnt lgkmcnt(12)
TRA 192,71,0
MXA 64,168,44
s_waitcnt lgkmcnt(11)
TRA 194,71,2048
v_accvgpr_read_b32 v92,a32
v_accvgpr_read_b32 v93,a33
v_accvgpr_read_b32 v94,a34
v_accvgpr_read_b32 v95,a35
MXA 64,176,96
s_waitcnt lgkmcnt(10)
v_mul_f32 v92,s38,v92
v_mul_f32 v93,s38,v93
v_mul_f32 v94,s38,v94
MXA 64,184,112
TRA 200,67,32768
v_mul_f32 v95,s38,v95
CV 92,92,93
CV 93,94,95
MXA 68,184,116
TRA 202,67,34816
v_accvgpr_read_b32 v84,a36
v_accvgpr_read_b32 v85,a37
v_accvgpr_read_b32 v86,a38
MXA 68,176,100
v_accvgpr_read_b32 v87,a39
v_mul_f32 v84,s38,v84
v_mul_f32 v85,s38,v85
MXA 68,168,48
s_mov_b32 s45,16384
TRA 208,71,16384
v_mul_f32 v86,s38,v86
v_mul_f32 v87,s38,v87
v_accvgpr_write_b32 a144,v92
v_accvgpr_write_b32 a145,v93
MXA 68,160,32
s_add_u32 m0,s34,81920
TRA 210,71,18432
CV 84,84,85
CV 85,86,87
v_accvgpr_read_b32 v88,a40
MXA 72,160,36
buffer_load_dwordx4 v20,s[8:11],s45 offen offset:0 nt lds
v_accvgpr_read_b32 v89,a41
v_accvgpr_read_b32 v90,a42
v_accvgpr_read_b32 v91,a43
MXA 72,168,52
TRA 216,71,32768
v_mul_f32 v88,s38,v88
v_mul_f32 v89,s38,v89
v_mul_f32 v90,s38,v90
MXA 72,176,104
TRA 218,71,34816
v_mul_f32 v91,s38,v91
v_accvgpr_write_b32 a148,v84
v_accvgpr_write_b32 a149,v85
MXA 72,184,120
CV 88,88,89
CV 89,90,91
v_accvgpr_read_b32 v92,a44
v_accvgpr_read_b32 v93,a45
MXA 76,184,124
TRA 196,71,8
v_accvgpr_read_b32 v94,a46
v_accvgpr_read_b32 v95,a47
v_mul_f32 v92,s38,v92
MXA 76,176,108
TRA 198,71,2056
v_mul_f32 v93,s38,v93
v_mul_f32 v94,s38,v94
v_mul_f32 v95,s38,v95
MXA 76,168,56
v_accvgpr_write_b32 a152,v88
v_accvgpr_write_b32 a153,v89
CV 92,92,93
MXA 76,160,40
s_waitcnt lgkmcnt(14)
TRA 204,67,32776
CV 93,94,95
v_accvgpr_read_b32 v84,a48
v_accvgpr_read_b32 v85,a49
MXA 80,164,28
TRA 206,67,34824
v_accvgpr_read_b32 v86,a50
v_accvgpr_read_b32 v87,a51
v_mul_f32 v84,s38,v84
v_mul_f32 v85,s38,v85
MXA 80,172,44
s_waitcnt lgkmcnt(14)
v_mul_f32 v86,s38,v86
v_mul_f32 v87,s38,v87
v_accvgpr_write_b32 a156,v92
MXA 80,180,96
s_waitcnt lgkmcnt(12)
TRA 212,71,16392
v_accvgpr_write_b32 a157,v93
CV 84,84,85
CV 85,86,87
MXA 80,188,112
TRA 214,71,18440
v_accvgpr_read_b32 v88,a52
v_accvgpr_read_b32 v89,a53
v_accvgpr_read_b32 v90,a54
MXA 84,188,116
v_accvgpr_read_b32 v91,a55
v_mul_f32 v88,s38,v88
v_mul_f32 v89,s38,v89
MXA 84,180,100
buffer_load_dwordx4 v21,s[8:11],s45 offen offset:1024 nt lds
v_mul_f32 v90,s38,v90
v_mul_f32 v91,s38,v91
v_accvgpr_write_b32 a146,v84
v_accvgpr_write_b32 a147,v85
MXA 84,172,48
TRA 220,71,32776
CV 88,88,89
CV 89,90,91
v_accvgpr_read_b32 v92,a56
MXA 84,164,32
TRA 222,71,34824
v_accvgpr_read_b32 v93,a57
v_accvgpr_read_b32 v94,a58
v_accvgpr_read_b32 v95,a59
MXA 88,164,36
v_mul_f32 v92,s38,v92
v_mul_f32 v93,s38,v93
v_mul_f32 v94,s38,v94
MXA 88,172,52
v_mul_f32 v95,s38,v95
v_accvgpr_write_b32 a150,v88
v_accvgpr_write_b32 a151,v89
MXA 88,180,104
CV 92,92,93
CV 93,94,95
v_accvgpr_read_b32 v84,a60
v_accvgpr_read_b32 v85,a61
MXA 88,188,120
v_accvgpr_read_b32 v86,a62
v_accvgpr_read_b32 v87,a63
v_mul_f32 v84,s38,v84
MXA 92,188,124
v_mul_f32 v85,s38,v85
v_mul_f32 v86,s38,v86
v_mul_f32 v87,s38,v87
MXA 92,180,108
v_accvgpr_write_b32 a154,v92
v_accvgpr_write_b32 a155,v93
CV 84,84,85
MXA 92,172,56
CV 85,86,87
v_accvgpr_write_b32 a158,v84
v_accvgpr_write_b32 a159,v85
MXA 92,164,40
s_waitcnt lgkmcnt(14)
MXA 96,192,28
s_waitcnt lgkmcnt(12)
TRA 0,68,256
MXA 96,200,44
s_waitcnt lgkmcnt(11)
TRA 2,68,2304
v_accvgpr_read_b32 v88,a64
v_accvgpr_read_b32 v89,a65
v_accvgpr_read_b32 v90,a66
v_accvgpr_read_b32 v91,a67
MXA 96,208,96
s_waitcnt lgkmcnt(10)
buffer_load_dwordx4 v22,s[8:11],s45 offen offset:2048 nt lds
v_mul_f32 v88,s38,v88
v_mul_f32 v89,s38,v89
v_mul_f32 v90,s38,v90
MXA 96,216,112
TRA 8,64,33024
v_mul_f32 v91,s38,v91
CV 88,88,89
CV 89,90,91
MXA 100,216,116
TRA 10,64,35072
v_accvgpr_read_b32 v92,a68
v_accvgpr_read_b32 v93,a69
v_accvgpr_read_b32 v94,a70
MXA 100,208,100
v_accvgpr_read_b32 v95,a71
v_mul_f32 v92,s38,v92
v_mul_f32 v93,s38,v93
MXA 100,200,48
TRA 16,68,16640
v_mul_f32 v94,s38,v94
v_mul_f32 v95,s38,v95
v_accvgpr_write_b32 a160,v88
v_accvgpr_write_b32 a161,v89
MXA 100,192,32
TRA 18,68,18688
CV 92,92,93
CV 93,94,95
v_accvgpr_read_b32 v84,a72
MXA 104,192,36
v_accvgpr_read_b32 v85,a73
v_accvgpr_read_b32 v86,a74
v_accvgpr_read_b32 v87,a75
MXA 104,200,52
TRA 24,68,33024
v_mul_f32 v84,s38,v84
v_mul_f32 v85,s38,v85
v_mul_f32 v86,s38,v86
MXA 104,208,104
TRA 26,68,35072
v_mul_f32 v87,s38,v87
v_accvgpr_write_b32 a164,v92
v_accvgpr_write_b32 a165,v93
MXA 104,216,120
CV 84,84,85
CV 85,86,87
v_accvgpr_read_b32 v88,a76
v_accvgpr_read_b32 v89,a77
MXA 108,216,124
TRA 4,68,264
v_accvgpr_read_b32 v90,a78
v_accvgpr_read_b32 v91,a79
v_mul_f32 v88,s38,v88
MXA 108,208,108
TRA 6,68,2312
v_mul_f32 v89,s38,v89
v_mul_f32 v90,s38,v90
v_mul_f32 v91,s38,v91
MXA 108,200,56
v_accvgpr_write_b32 a168,v84
v_accvgpr_write_b32 a169,v85
CV 88,88,89
MXA 108,192,40
s_waitcnt lgkmcnt(14)
buffer_load_dwordx4 v23,s[8:11],s45 offen offset:3072 nt lds
CV 89,90,91
v_accvgpr_read_b32 v92,a80
v_accvgpr_read_b32 v93,a81
MXA 112,196,28
TRA 12,64,33032
v_accvgpr_read_b32 v94,a82
v_accvgpr_read_b32 v95,a83
v_mul_f32 v92,s38,v92
v_mul_f32 v93,s38,v93
MXA 112,204,44
s_waitcnt lgkmcnt(13)
TRA 14,64,35080
v_mul_f32 v94,s38,v94
v_mul_f32 v95,s38,v95
v_accvgpr_write_b32 a172,v88
MXA 112,212,96
s_waitcnt lgkmcnt(12)
TRA 20,68,16648
v_accvgpr_write_b32 a173,v89
CV 92,92,93
CV 93,94,95
MXA 112,220,112
TRA 22,68,18696
v_accvgpr_read_b32 v84,a84
v_accvgpr_read_b32 v85,a85
v_accvgpr_read_b32 v86,a86
MXA 116,220,116
v_accvgpr_read_b32 v87,a87
v_mul_f32 v84,s38,v84
v_mul_f32 v85,s38,v85
MXA 116,212,100
TRA 28,68,33032
v_mul_f32 v86,s38,v86
v_mul_f32 v87,s38,v87
v_accvgpr_write_b32 a162,v92
v_accvgpr_write_b32 a163,v93
MXA 116,204,48
TRA 30,68,35080
CV 84,84,85
CV 85,86,87
v_accvgpr_read_b32 v88,a88
MXA 116,196,32
v_accvgpr_read_b32 v89,a89
v_accvgpr_read_b32 v90,a90
v_accvgpr_read_b32 v91,a91
MXA 120,196,36
v_mul_f32 v88,s38,v88
v_mul_f32 v89,s38,v89
v_mul_f32 v90,s38,v90
MXA 120,204,52
v_mul_f32 v91,s38,v91
v_accvgpr_write_b32 a166,v84
v_accvgpr_write_b32 a167,v85
MXA 120,212,104
s_mov_b32 s45,32768
CV 88,88,89
CV 89,90,91
v_accvgpr_read_b32 v92,a92
v_accvgpr_read_b32 v93,a93
MXA 120,220,120
s_add_u32 m0,s34,32768
v_accvgpr_read_b32 v94,a94
v_accvgpr_read_b32 v95,a95
v_mul_f32 v92,s38,v92
MXA 124,220,124
buffer_load_dwordx4 v24,s[4:7],s45 offen offset:0 nt lds
v_mul_f32 v93,s38,v93
v_mul_f32 v94,s38,v94
v_mul_f32 v95,s38,v95
MXA 124,212,108
v_accvgpr_write_b32 a170,v88
v_accvgpr_write_b32 a171,v89
CV 92,92,93
MXA 124,204,56
CV 93,94,95
v_accvgpr_write_b32 a174,v92
v_accvgpr_write_b32 a175,v93
MXA 124,196,40
s_waitcnt lgkmcnt(14)
MXV 128,0,28
s_waitcnt lgkmcnt(12)
TRA 32,69,256
MXV 128,8,44
s_waitcnt lgkmcnt(11)
TRA 34,69,2304
v_accvgpr_read_b32 v84,a96
v_accvgpr_read_b32 v85,a97
v_accvgpr_read_b32 v86,a98
v_accvgpr_read_b32 v87,a99
MXV 128,16,96
s_waitcnt lgkmcnt(10)
v_mul_f32 v84,s38,v84
v_mul_f32 v85,s38,v85
v_mul_f32 v86,s38,v86
MXV 128,24,112
TRA 40,65,33024
v_mul_f32 v87,s38,v87
CV 84,84,85
CV 85,86,87
MXV 132,24,116
TRA 42,65,35072
v_accvgpr_read_b32 v88,a100
v_accvgpr_read_b32 v89,a101
v_accvgpr_read_b32 v90,a102
MXV 132,16,100
v_accvgpr_read_b32 v91,a103
v_mul_f32 v88,s38,v88
v_mul_f32 v89,s38,v89
MXV 132,8,48
TRA 48,69,16640
v_mul_f32 v90,s38,v90
v_mul_f32 v91,s38,v91
v_accvgpr_write_b32 a176,v84
v_accvgpr_write_b32 a177,v85
MXV 132,0,32
TRA 50,69,18688
CV 88,88,89
CV 89,90,91
v_accvgpr_read_b32 v92,a104
MXV 136,0,36
v_accvgpr_read_b32 v93,a105
v_accvgpr_read_b32 v94,a106
v_accvgpr_read_b32 v95,a107
MXV 136,8,52
buffer_load_dwordx4 v25,s[4:7],s45 offen offset:1024 nt lds
v_mul_f32 v92,s38,v92
v_mul_f32 v93,s38,v93
v_mul_f32 v94,s38,v94
MXV 136,16,104
TRA 56,69,33024
v_mul_f32 v95,s38,v95
v_accvgpr_write_b32 a180,v88
v_accvgpr_write_b32 a181,v89
MXV 136,24,120
TRA 58,69,35072
CV 92,92,93
CV 93,94,95
v_accvgpr_read_b32 v84,a108
v_accvgpr_read_b32 v85,a109
MXV 140,24,124
TRA 36,69,264
v_accvgpr_read_b32 v86,a110
v_accvgpr_read_b32 v87,a111
v_mul_f32 v84,s38,v84
MXV 140,16,108
TRA 38,69,2312
v_mul_f32 v85,s38,v85
v_mul_f32 v86,s38,v86
v_mul_f32 v87,s38,v87
MXV 140,8,56
v_accvgpr_write_b32 a184,v92
v_accvgpr_write_b32 a185,v93
CV 84,84,85
MXV 140,0,40
s_waitcnt lgkmcnt(14)
TRA 44,65,33032
CV 85,86,87
v_accvgpr_read_b32 v88,a112
v_accvgpr_read_b32 v89,a113
MXV 144,4,28
TRA 46,65,35080
v_accvgpr_read_b32 v90,a114
v_accvgpr_read_b32 v91,a115
v_mul_f32 v88,s38,v88
v_mul_f32 v89,s38,v89
MXV 144,12,44
s_waitcnt lgkmcnt(14)
v_mul_f32 v90,s38,v90
v_mul_f32 v91,s38,v91
v_accvgpr_write_b32 a188,v84
MXV 144,20,96
s_waitcnt lgkmcnt(12)
TRA 52,69,16648
v_accvgpr_write_b32 a189,v85
CV 88,88,89
CV 89,90,91
MXV 144,28,112
TRA 54,69,18696
v_accvgpr_read_b32 v92,a116
v_accvgpr_read_b32 v93,a117
v_accvgpr_read_b32 v94,a118
MXV 148,28,116
v_accvgpr_read_b32 v95,a119
v_mul_f32 v92,s38,v92
v_mul_f32 v93,s38,v93
MXV 148,20,100
TRA 60,69,33032
v_mul_f32 v94,s38,v94
v_mul_f32 v95,s38,v95
v_accvgpr_write_b32 a178,v88
v_accvgpr_write_b32 a179,v89
MXV 148,12,48
buffer_load_dwordx4 v26,s[4:7],s45 offen offset:2048 nt lds
CV 92,92,93
CV 93,94,95
v_accvgpr_read_b32 v84,a120
MXV 148,4,32
TRA 62,69,35080
v_accvgpr_read_b32 v85,a121
v_accvgpr_read_b32 v86,a122
v_accvgpr_read_b32 v87,a123
MXV 152,4,36
v_mul_f32 v84,s38,v84
v_mul_f32 v85,s38,v85
v_mul_f32 v86,s38,v86
MXV 152,12,52
v_mul_f32 v87,s38,v87
v_accvgpr_write_b32 a182,v92
v_accvgpr_write_b32 a183,v93
MXV 152,20,104
CV 84,84,85
CV 85,86,87
v_accvgpr_read_b32 v88,a124
v_accvgpr_read_b32 v89,a125
MXV 152,28,120
v_accvgpr_read_b32 v90,a126
v_accvgpr_read_b32 v91,a127
v_mul_f32 v88,s38,v88
MXV 156,28,124
v_mul_f32 v89,s38,v89
v_mul_f32 v90,s38,v90
v_mul_f32 v91,s38,v91
MXV 156,20,108
v_accvgpr_write_b32 a186,v84
v_accvgpr_write_b32 a187,v85
CV 88,88,89
MXV 156,12,56
CV 89,90,91
v_accvgpr_write_b32 a190,v88
v_accvgpr_write_b32 a191,v89
MXV 156,4,40
s_waitcnt lgkmcnt(14)
MXV 160,32,28
s_waitcnt lgkmcnt(12)
TRA 0,70,256
MXV 160,40,44
s_waitcnt lgkmcnt(11)
TRA 2,70,2304
v_mul_f32 v128,s38,v128
v_mul_f32 v129,s38,v129
v_mul_f32 v130,s38,v130
MXV 160,48,96
s_waitcnt lgkmcnt(10)
v_mul_f32 v131,s38,v131
CV 128,128,129
MXV 160,56,112
buffer_load_dwordx4 v27,s[4:7],s45 offen offset:3072 nt lds
CV 129,130,131
v_mul_f32 v132,s38,v132
MXV 164,56,116
TRA 8,66,33024
v_mul_f32 v133,s38,v133
v_mul_f32 v134,s38,v134
MXV 164,48,100
TRA 10,66,35072
v_mul_f32 v135,s38,v135
v_accvgpr_write_b32 a192,v128
MXV 164,40,48
TRA 16,70,16640
v_accvgpr_write_b32 a193,v129
CV 132,132,133
MXV 164,32,32
TRA 18,70,18688
CV 133,134,135
v_mul_f32 v136,s38,v136
MXV 168,32,36
v_mul_f32 v137,s38,v137
v_mul_f32 v138,s38,v138
v_mul_f32 v139,s38,v139
MXV 168,40,52
TRA 24,70,33024
v_accvgpr_write_b32 a196,v132
v_accvgpr_write_b32 a197,v133
MXV 168,48,104
TRA 26,70,35072
CV 136,136,137
CV 137,138,139
MXV 168,56,120
v_mul_f32 v140,s38,v140
v_mul_f32 v141,s38,v141
MXV 172,56,124
TRA 4,70,264
v_mul_f32 v142,s38,v142
v_mul_f32 v143,s38,v143
MXV 172,48,108
TRA 6,70,2312
v_accvgpr_write_b32 a200,v136
v_accvgpr_write_b32 a201,v137
MXV 172,40,56
s_mov_b32 s45,32768
CV 140,140,141
CV 141,142,143
MXV 172,32,40
s_add_u32 m0,s34,98304
TRA 12,66,33032
v_mul_f32 v144,s38,v144
v_mul_f32 v145,s38,v145
s_waitcnt lgkmcnt(14)
MXV 176,36,28
buffer_load_dwordx4 v20,s[8:11],s45 offen offset:0 nt lds
v_mul_f32 v146,s38,v146
v_mul_f32 v147,s38,v147
v_accvgpr_write_b32 a204,v140
MXV 176,44,44
s_waitcnt lgkmcnt(13)
TRA 14,66,35080
v_accvgpr_write_b32 a205,v141
CV 144,144,145
MXV 176,52,96
s_waitcnt lgkmcnt(12)
TRA 20,70,16648
CV 145,146,147
v_mul_f32 v148,s38,v148
MXV 176,60,112
TRA 22,70,18696
v_mul_f32 v149,s38,v149
v_mul_f32 v150,s38,v150
MXV 180,60,116
v_mul_f32 v151,s38,v151
v_accvgpr_write_b32 a194,v144
MXV 180,52,100
TRA 28,70,33032
v_accvgpr_write_b32 a195,v145
CV 148,148,149
MXV 180,44,48
TRA 30,70,35080
CV 149,150,151
v_mul_f32 v152,s38,v152
MXV 180,36,32
v_mul_f32 v153,s38,v153
v_mul_f32 v154,s38,v154
v_mul_f32 v155,s38,v155
MXV 184,36,36
v_accvgpr_write_b32 a198,v148
v_accvgpr_write_b32 a199,v149
MXV 184,44,52
CV 152,152,153
CV 153,154,155
MXV 184,52,104
v_mul_f32 v156,s38,v156
v_mul_f32 v157,s38,v157
MXV 184,60,120
v_mul_f32 v158,s38,v158
v_mul_f32 v159,s38,v159
MXV 188,60,124
v_accvgpr_write_b32 a202,v152
v_accvgpr_write_b32 a203,v153
MXV 188,52,108
buffer_load_dwordx4 v21,s[8:11],s45 offen offset:1024 nt lds
CV 156,156,157
CV 157,158,159
MXV 188,44,56
v_accvgpr_write_b32 a206,v156
v_accvgpr_write_b32 a207,v157
MXV 188,36,40
s_waitcnt lgkmcnt(14)
MXV 192,0,28
s_waitcnt lgkmcnt(12)
TRA 32,71,256
MXV 192,8,44
s_waitcnt lgkmcnt(11)
TRA 34,71,2304
v_mul_f32 v160,s38,v160
v_mul_f32 v161,s38,v161
v_mul_f32 v162,s38,v162
MXV 192,16,96
s_waitcnt lgkmcnt(10)
v_mul_f32 v163,s38,v163
CV 160,160,161
MXV 192,24,112
TRA 40,67,33024
CV 161,162,163
v_mul_f32 v164,s38,v164
MXV 196,24,116
TRA 42,67,35072
v_mul_f32 v165,s38,v165
v_mul_f32 v166,s38,v166
MXV 196,16,100
v_mul_f32 v167,s38,v167
v_accvgpr_write_b32 a208,v160
MXV 196,8,48
TRA 48,71,16640
v_accvgpr_write_b32 a209,v161
CV 164,164,165
MXV 196,0,32
TRA 50,71,18688
CV 165,166,167
v_mul_f32 v168,s38,v168
MXV 200,0,36
v_mul_f32 v169,s38,v169
v_mul_f32 v170,s38,v170
v_mul_f32 v171,s38,v171
MXV 200,8,52
TRA 56,71,33024
v_accvgpr_write_b32 a212,v164
v_accvgpr_write_b32 a213,v165
MXV 200,16,104
buffer_load_dwordx4 v22,s[8:11],s45 offen offset:2048 nt lds
CV 168,168,169
CV 169,170,171
MXV 200,24,120
TRA 58,71,35072
v_mul_f32 v172,s38,v172
v_mul_f32 v173,s38,v173
MXV 204,24,124
TRA 36,71,264
v_mul_f32 v174,s38,v174
v_mul_f32 v175,s38,v175
MXV 204,16,108
TRA 38,71,2312
v_accvgpr_write_b32 a216,v168
v_accvgpr_write_b32 a217,v169
MXV 204,8,56
CV 172,172,173
CV 173,174,175
MXV 204,0,40
s_waitcnt lgkmcnt(14)
TRA 44,67,33032
v_mul_f32 v176,s38,v176
v_mul_f32 v177,s38,v177
MXV 208,4,28
TRA 46,67,35080
v_mul_f32 v178,s38,v178
v_mul_f32 v179,s38,v179
v_accvgpr_write_b32 a220,v172
MXV 208,12,44
s_waitcnt lgkmcnt(14)
v_accvgpr_write_b32 a221,v173
CV 176,176,177
MXV 208,20,96
s_waitcnt lgkmcnt(12)
TRA 52,71,16648
CV 177,178,179
v_mul_f32 v180,s38,v180
MXV 208,28,112
TRA 54,71,18696
v_mul_f32 v181,s38,v181
v_mul_f32 v182,s38,v182
MXV 212,28,116
v_mul_f32 v183,s38,v183
v_accvgpr_write_b32 a210,v176
MXV 212,20,100
TRA 60,71,33032
v_accvgpr_write_b32 a211,v177
CV 180,180,181
MXV 212,12,48
TRA 62,71,35080
CV 181,182,183
v_mul_f32 v184,s38,v184
MXV 212,4,32
buffer_load_dwordx4 v23,s[8:11],s45 offen offset:3072 nt lds
v_mul_f32 v185,s38,v185
v_mul_f32 v186,s38,v186
v_mul_f32 v187,s38,v187
MXV 216,4,36
v_accvgpr_write_b32 a214,v180
v_accvgpr_write_b32 a215,v181
MXV 216,12,52
CV 184,184,185
CV 185,186,187
MXV 216,20,104
v_mul_f32 v188,s38,v188
v_mul_f32 v189,s38,v189
MXV 216,28,120
v_mul_f32 v190,s38,v190
v_mul_f32 v191,s38,v191
MXV 220,28,124
v_accvgpr_write_b32 a218,v184
v_accvgpr_write_b32 a219,v185
MXV 220,20,108
CV 188,188,189
CV 189,190,191
MXV 220,12,56
v_accvgpr_write_b32 a222,v188
v_accvgpr_write_b32 a223,v189
MXV 220,4,40
s_waitcnt lgkmcnt(14)
MXV 224,32,28
s_waitcnt lgkmcnt(12)
MXV 224,40,44
s_waitcnt lgkmcnt(10)
v_mul_f32 v192,s38,v192
v_mul_f32 v193,s38,v193
v_mul_f32 v194,s38,v194
MXV 224,48,96
s_waitcnt lgkmcnt(8)
v_mul_f32 v195,s38,v195
CV 192,192,193
MXV 224,56,112
CV 193,194,195
v_mul_f32 v196,s38,v196
MXV 228,56,116
v_mul_f32 v197,s38,v197
v_mul_f32 v198,s38,v198
MXV 228,48,100
v_mul_f32 v199,s38,v199
v_accvgpr_write_b32 a224,v192
MXV 228,40,48
v_accvgpr_write_b32 a225,v193
CV 196,196,197
MXV 228,32,32
CV 197,198,199
v_mul_f32 v200,s38,v200
MXV 232,32,36
v_mul_f32 v201,s38,v201
v_mul_f32 v202,s38,v202
v_mul_f32 v203,s38,v203
MXV 232,40,52
s_waitcnt vmcnt(20) lgkmcnt(0)
s_barrier
RD 64,4,0
v_accvgpr_write_b32 a228,v196
v_accvgpr_write_b32 a229,v197
MXV 232,48,104
CV 200,200,201
CV 201,202,203
MXV 232,56,120
RD 68,5,0
v_mul_f32 v204,s38,v204
v_mul_f32 v205,s38,v205
MXV 236,56,124
v_mul_f32 v206,s38,v206
v_mul_f32 v207,s38,v207
MXV 236,48,108
RD 72,6,0
v_accvgpr_write_b32 a232,v200
v_accvgpr_write_b32 a233,v201
MXV 236,40,56
CV 204,204,205
CV 205,206,207
MXV 236,32,40
RD 76,7,0
v_mul_f32 v208,s38,v208
v_mul_f32 v209,s38,v209
MXV 240,36,28
v_mul_f32 v210,s38,v210
v_mul_f32 v211,s38,v211
v_accvgpr_write_b32 a236,v204
MXV 240,44,44
RD 80,4,4096
v_accvgpr_write_b32 a237,v205
CV 208,208,209
MXV 240,52,96
CV 209,210,211
v_mul_f32 v212,s38,v212
MXV 240,60,112
RD 84,5,4096
v_mul_f32 v213,s38,v213
v_mul_f32 v214,s38,v214
MXV 244,60,116
v_mul_f32 v215,s38,v215
v_accvgpr_write_b32 a226,v208
MXV 244,52,100
RD 88,6,4096
v_accvgpr_write_b32 a227,v209
CV 212,212,213
MXV 244,44,48
CV 213,214,215
v_mul_f32 v216,s38,v216
MXV 244,36,32
RD 92,7,4096
v_mul_f32 v217,s38,v217
v_mul_f32 v218,s38,v218
v_mul_f32 v219,s38,v219
MXV 248,36,36
s_mov_b32 s45,49152
v_accvgpr_write_b32 a230,v212
v_accvgpr_write_b32 a231,v213
MXV 248,44,52
s_add_u32 m0,s34,49152
CV 216,216,217
CV 217,218,219
MXV 248,52,104
buffer_load_dwordx4 v24,s[4:7],s45 offen offset:0 nt lds
v_mul_f32 v220,s38,v220
v_mul_f32 v221,s38,v221
MXV 248,60,120
v_mul_f32 v222,s38,v222
v_mul_f32 v223,s38,v223
MXV 252,60,124
v_accvgpr_write_b32 a234,v216
v_accvgpr_write_b32 a235,v217
MXV 252,52,108
CV 220,220,221
CV 221,222,223
MXV 252,44,56
v_accvgpr_write_b32 a238,v220
v_accvgpr_write_b32 a239,v221
MXV 252,36,40
v_mov_b32 v44,0xc1a00000
v_mov_b32 v45,0xc1a00000
v_mov_b64 v[46:47],v[44:45]
v_mov_b64 v[48:49],v[44:45]
v_mov_b64 v[50:51],v[44:45]
v_mov_b64 v[52:53],v[44:45]
v_mov_b64 v[54:55],v[44:45]
v_mov_b64 v[56:57],v[44:45]
v_mov_b64 v[58:59],v[44:45]
s_waitcnt lgkmcnt(7)
MV 128,64,128,44
s_waitcnt lgkmcnt(6)
MV 128,68,144,128
s_waitcnt lgkmcnt(5)
v_mul_f32 v224,s38,v224
v_mul_f32 v225,s38,v225
v_mul_f32 v226,s38,v226
MV 128,72,160,128
s_waitcnt lgkmcnt(4)
buffer_load_dwordx4 v25,s[4:7],s45 offen offset:1024 nt lds
v_mul_f32 v227,s38,v227
CV 224,224,225
MV 128,76,176,128
CV 225,226,227
v_mul_f32 v228,s38,v228
MV 132,76,180,48
s_and_b32 s50,s2,6
v_mul_f32 v229,s38,v229
v_mul_f32 v230,s38,v230
MV 132,72,164,132
s_lshl_b32 s50,s50,3
v_mul_f32 v231,s38,v231
v_accvgpr_write_b32 a240,v224
MV 132,68,148,132
s_lshr_b32 s51,s2,5
v_accvgpr_write_b32 a241,v225
CV 228,228,229
MV 132,64,132,132
s_lshl_b32 s51,s51,1
CV 229,230,231
v_mul_f32 v232,s38,v232
MV 136,64,136,52
s_add_u32 s50,s50,s51
v_mul_f32 v233,s38,v233
v_mul_f32 v234,s38,v234
v_mul_f32 v235,s38,v235
v_exp_f32 v28,v128
MV 136,68,152,136
s_lshr_b32 s51,s32,1
v_accvgpr_write_b32 a244,v228
v_accvgpr_write_b32 a245,v229
MV 136,72,168,136
s_add_u32 s50,s50,s51
buffer_load_dwordx4 v26,s[4:7],s45 offen offset:2048 nt lds
CV 232,232,233
CV 233,234,235
v_exp_f32 v29,v129
MV 136,76,184,136
s_lshl_b32 s50,s50,19
v_mul_f32 v236,s38,v236
v_mul_f32 v237,s38,v237
MV 140,76,188,56
s_and_b32 s51,s2,1
v_mul_f32 v238,s38,v238
v_mul_f32 v239,s38,v239
v_exp_f32 v30,v130
MV 140,72,172,140
s_lshl_b32 s51,s51,18
v_accvgpr_write_b32 a248,v232
v_accvgpr_write_b32 a249,v233
MV 140,68,156,140
s_add_u32 s50,s50,s51
CV 236,236,237
CV 237,238,239
CV 192,28,29
MV 140,64,140,140
s_and_b32 s51,s32,1
v_mul_f32 v240,s38,v240
v_mul_f32 v241,s38,v241
s_waitcnt lgkmcnt(3)
MV 144,80,128,44
s_lshl_b32 s51,s51,11
RD 64,4,8192
v_mul_f32 v242,s38,v242
v_mul_f32 v243,s38,v243
v_accvgpr_write_b32 a252,v236
s_waitcnt lgkmcnt(3)
MV 144,84,144,144
s_add_u32 s50,s50,s51
RD 68,5,8192
v_accvgpr_write_b32 a253,v237
CV 240,240,241
v_exp_f32 v31,v131
s_waitcnt lgkmcnt(3)
MV 144,88,160,144
s_add_u32 s12,s52,s50
s_addc_u32 s13,s53,0
buffer_load_dwordx4 v27,s[4:7],s45 offen offset:3072 nt lds
CV 241,242,243
v_mul_f32 v244,s38,v244
s_waitcnt lgkmcnt(2)
MV 144,92,176,144
s_mov_b32 s14,260096
RD 72,6,8192
v_mul_f32 v245,s38,v245
v_mul_f32 v246,s38,v246
MV 148,92,180,48
s_and_b32 s50,s2,4
RD 76,7,8192
v_mul_f32 v247,s38,v247
v_accvgpr_write_b32 a242,v240
MV 148,88,164,148
s_bfe_u32 s51,s2,0x20003
v_accvgpr_write_b32 a243,v241
CV 244,244,245
MV 148,84,148,148
s_add_u32 s50,s50,s51
CV 245,246,247
v_mul_f32 v248,s38,v248
MV 148,80,132,148
s_lshl_b32 s50,s50,1
v_mul_f32 v249,s38,v249
v_mul_f32 v250,s38,v250
v_mul_f32 v251,s38,v251
MV 152,80,136,52
s_and_b32 s51,s2,1
v_accvgpr_write_b32 a246,v244
v_accvgpr_write_b32 a247,v245
v_exp_f32 v32,v144
MV 152,84,152,152
s_add_u32 s50,s50,s51
CV 248,248,249
CV 249,250,251
CV 193,30,31
MV 152,88,168,152
s_mul_i32 s50,s50,589824
v_mul_f32 v252,s38,v252
v_mul_f32 v253,s38,v253
MV 152,92,184,152
s_add_u32 s50,s50,33554432
v_mul_f32 v254,s38,v254
v_mul_f32 v255,s38,v255
v_exp_f32 v33,v145
MV 156,92,188,56
s_add_u32 s16,s52,s50
s_addc_u32 s17,s53,0
v_accvgpr_write_b32 a250,v248
v_accvgpr_write_b32 a251,v249
v_exp_f32 v34,v146
MV 156,88,172,156
s_mov_b32 s18,589824
CV 252,252,253
CV 253,254,255
MV 156,84,156,156
v_accvgpr_write_b32 a254,v252
v_accvgpr_write_b32 a255,v253
CV 194,32,33
MV 156,80,140,156
RD 80,4,12288
RD 84,5,12288
RD 88,6,12288
v_and_b32 v36,3,v2
v_cmp_eq_u32 vcc,0,v36
v_mov_b32 v37,0x3f803f80
s_nop 0
v_cndmask_b32 v36,0,v37,vcc
v_mov_b32 v37,v36
v_mov_b64 v[38:39],v[36:37]
v_exp_f32 v35,v147
v_exp_f32 v28,v132
CV 195,34,35
v_exp_f32 v29,v133
v_exp_f32 v30,v134
CV 196,28,29
v_exp_f32 v31,v135
v_exp_f32 v32,v148
CV 197,30,31
v_exp_f32 v33,v149
v_exp_f32 v34,v150
CV 198,32,33
v_exp_f32 v35,v151
v_exp_f32 v28,v136
CV 199,34,35
v_exp_f32 v29,v137
v_exp_f32 v30,v138
CV 200,28,29
v_exp_f32 v31,v139
v_exp_f32 v32,v152
CV 201,30,31
v_mfma_f32_16x16x32_bf16 v[224:227],v[36:39],v[192:195],0
v_exp_f32 v33,v153
v_mfma_f32_16x16x32_bf16 v[228:231],v[36:39],v[196:199],0
s_waitcnt lgkmcnt(6)
RD 92,7,12288
L_s0:
s_waitcnt lgkmcnt(7)
MV 160,64,128,44
s_waitcnt vmcnt(16) lgkmcnt(0)
s_barrier
v_exp_f32 v34,v154
MV 160,68,144,160
TR 96,8,0
CV 202,32,33
MV 160,72,160,160
v_exp_f32 v35,v155
MV 160,76,176,160
TR 98,8,4096
MV 176,92,176,44
v_exp_f32 v28,v140
MV 176,88,160,176
TR 100,9,0
CV 203,34,35
MV 176,84,144,176
v_exp_f32 v29,v141
MV 176,80,128,176
TR 102,9,4096
MV 180,80,132,48
v_exp_f32 v30,v142
MV 180,84,148,180
TR 104,10,0
CV 204,28,29
MV 180,88,164,180
s_add_u32 m0,s33,0
v_exp_f32 v31,v143
MV 180,92,180,180
buffer_load_dwordx4 v16,s[4:7],s36 offen nt lds
MV 164,76,180,48
v_exp_f32 v32,v156
MV 164,72,164,164
TR 106,10,4096
CV 205,30,31
MV 164,68,148,164
v_exp_f32 v33,v157
MV 164,64,132,164
TR 108,11,0
MV 168,64,136,52
v_exp_f32 v34,v158
MV 168,68,152,168
TR 110,11,4096
CV 206,32,33
MV 168,72,168,168
v_exp_f32 v35,v159
MV 168,76,184,168
TR 112,12,0
MV 184,92,184,52
v_max_f32 v40,v224,v228
MV 184,88,168,184
TR 114,12,4096
CV 207,34,35
MV 184,84,152,184
TR 116,13,0
v_min_f32 v42,v224,v228
MV 184,80,136,184
TR 118,13,4096
v_mfma_f32_16x16x32_bf16 v[232:235],v[36:39],v[200:203],0
v_exp_f32 v28,v160
v_mfma_f32_16x16x32_bf16 v[236:239],v[36:39],v[204:207],0
TR 120,14,0
MV 188,80,140,56
v_exp_f32 v29,v161
MV 188,84,156,188
buffer_load_dwordx4 v17,s[4:7],s36 offen offset:1024 nt lds
MV 188,88,172,188
s_add_u32 s36,s36,8192
v_exp_f32 v30,v162
MV 188,92,188,188
CV 208,28,29
v_max3_f32 v40,v40,v232,v236
v_min3_f32 v42,v42,v232,v236
MV 172,76,188,56
v_exp_f32 v31,v163
v_cmp_gt_f32 s[50:51],s39,v42
MV 172,72,172,172
v_cmp_lt_f32 vcc,s40,v40
MV 172,68,156,172
s_or_b64 s[50:51],s[50:51],vcc
s_cbranch_scc1 L_st_s0
L_bk_s0:
v_exp_f32 v32,v176
MV 172,64,140,172
s_waitcnt lgkmcnt(11)
TR 122,14,4096
CV 209,30,31
v_mfma_f32_16x16x32_bf16 a[0:3],v[96:99],v[192:195],0
v_exp_f32 v33,v177
v_mfma_f32_16x16x32_bf16 a[4:7],v[96:99],v[196:199],0
TR 124,15,0
v_mfma_f32_16x16x32_bf16 a[8:11],v[96:99],v[200:203],0
v_exp_f32 v34,v178
v_mfma_f32_16x16x32_bf16 a[12:15],v[96:99],v[204:207],0
s_waitcnt lgkmcnt(11)
TR 126,15,4096
CV 210,32,33
v_mfma_f32_16x16x32_bf16 a[28:31],v[100:103],v[204:207],0
v_exp_f32 v35,v179
v_mfma_f32_16x16x32_bf16 a[24:27],v[100:103],v[200:203],0
RD 64,4,16384
v_mfma_f32_16x16x32_bf16 a[20:23],v[100:103],v[196:199],0
v_exp_f32 v28,v164
v_mfma_f32_16x16x32_bf16 a[16:19],v[100:103],v[192:195],0
s_waitcnt lgkmcnt(11)
RD 68,5,16384
CV 211,34,35
v_mfma_f32_16x16x32_bf16 a[32:35],v[104:107],v[192:195],0
s_add_u32 m0,s33,114688
v_exp_f32 v29,v165
v_mfma_f32_16x16x32_bf16 a[36:39],v[104:107],v[196:199],0
buffer_load_dwordx4 v18,s[8:11],s37 offen nt lds
v_mfma_f32_16x16x32_bf16 a[40:43],v[104:107],v[200:203],0
v_exp_f32 v30,v166
v_mfma_f32_16x16x32_bf16 a[44:47],v[104:107],v[204:207],0
s_waitcnt lgkmcnt(10)
RD 72,6,16384
CV 212,28,29
v_mfma_f32_16x16x32_bf16 a[60:63],v[108:111],v[204:207],0
v_exp_f32 v31,v167
v_mfma_f32_16x16x32_bf16 a[56:59],v[108:111],v[200:203],0
RD 76,7,16384
v_mfma_f32_16x16x32_bf16 a[52:55],v[108:111],v[196:199],0
v_exp_f32 v32,v180
v_mfma_f32_16x16x32_bf16 a[48:51],v[108:111],v[192:195],0
s_waitcnt lgkmcnt(10)
RD 80,4,20480
CV 213,30,31
v_mfma_f32_16x16x32_bf16 a[64:67],v[112:115],v[192:195],0
v_exp_f32 v33,v181
v_mfma_f32_16x16x32_bf16 a[68:71],v[112:115],v[196:199],0
RD 84,5,20480
v_mfma_f32_16x16x32_bf16 a[72:75],v[112:115],v[200:203],0
v_exp_f32 v34,v182
v_mfma_f32_16x16x32_bf16 a[76:79],v[112:115],v[204:207],0
s_waitcnt lgkmcnt(10)
RD 88,6,20480
CV 214,32,33
v_mfma_f32_16x16x32_bf16 a[92:95],v[116:119],v[204:207],0
v_exp_f32 v35,v183
v_mfma_f32_16x16x32_bf16 a[88:91],v[116:119],v[200:203],0
RD 92,7,20480
v_mfma_f32_16x16x32_bf16 a[84:87],v[116:119],v[196:199],0
v_exp_f32 v28,v168
v_mfma_f32_16x16x32_bf16 a[80:83],v[116:119],v[192:195],0
s_waitcnt lgkmcnt(10)
CV 215,34,35
v_mfma_f32_16x16x32_bf16 a[96:99],v[120:123],v[192:195],0
v_exp_f32 v29,v169
v_mfma_f32_16x16x32_bf16 a[100:103],v[120:123],v[196:199],0
buffer_load_dwordx4 v19,s[8:11],s37 offen offset:1024 nt lds
v_mfma_f32_16x16x32_bf16 a[104:107],v[120:123],v[200:203],0
s_add_u32 s37,s37,8192
v_exp_f32 v30,v170
v_mfma_f32_16x16x32_bf16 a[108:111],v[120:123],v[204:207],0
s_waitcnt lgkmcnt(8)
CV 216,28,29
v_mfma_f32_16x16x32_bf16 a[124:127],v[124:127],v[204:207],0
v_exp_f32 v31,v171
v_mfma_f32_16x16x32_bf16 a[120:123],v[124:127],v[200:203],0
v_mfma_f32_16x16x32_bf16 a[116:119],v[124:127],v[196:199],0
v_exp_f32 v32,v184
v_mfma_f32_16x16x32_bf16 a[112:115],v[124:127],v[192:195],0
CV 217,30,31
v_mfma_f32_16x16x32_bf16 v[240:243],v[36:39],v[208:211],v[224:227]
v_exp_f32 v33,v185
v_mfma_f32_16x16x32_bf16 v[244:247],v[36:39],v[212:215],v[228:231]
s_waitcnt lgkmcnt(7)
s_branch L_r1
.p2align 6
L_r0:
s_waitcnt lgkmcnt(7)
MV 160,64,128,44
s_waitcnt vmcnt(16) lgkmcnt(0)
s_barrier
v_exp_f32 v34,v154
MV 160,68,144,160
TR 96,8,0
CV 202,32,33
MV 160,72,160,160
v_exp_f32 v35,v155
MV 160,76,176,160
TR 98,8,4096
MV 176,92,176,44
v_exp_f32 v28,v140
MV 176,88,160,176
TR 100,9,0
CV 203,34,35
MV 176,84,144,176
v_exp_f32 v29,v141
MV 176,80,128,176
TR 102,9,4096
MV 180,80,132,48
v_exp_f32 v30,v142
MV 180,84,148,180
TR 104,10,0
CV 204,28,29
MV 180,88,164,180
s_add_u32 m0,s33,0
v_exp_f32 v31,v143
MV 180,92,180,180
buffer_load_dwordx4 v16,s[4:7],s36 offen nt lds
MV 164,76,180,48
v_exp_f32 v32,v156
MV 164,72,164,164
TR 106,10,4096
CV 205,30,31
MV 164,68,148,164
v_exp_f32 v33,v157
MV 164,64,132,164
TR 108,11,0
MV 168,64,136,52
v_exp_f32 v34,v158
MV 168,68,152,168
TR 110,11,4096
CV 206,32,33
MV 168,72,168,168
v_exp_f32 v35,v159
MV 168,76,184,168
TR 112,12,0
MV 184,92,184,52
v_max_f32 v40,v224,v228
MV 184,88,168,184
TR 114,12,4096
CV 207,34,35
MV 184,84,152,184
TR 116,13,0
MV 184,80,136,184
TR 118,13,4096
v_mfma_f32_16x16x32_bf16 v[232:235],v[36:39],v[200:203],v[248:251]
v_exp_f32 v28,v160
v_mfma_f32_16x16x32_bf16 v[236:239],v[36:39],v[204:207],v[252:255]
TR 120,14,0
MV 188,80,140,56
v_exp_f32 v29,v161
MV 188,84,156,188
buffer_load_dwordx4 v17,s[4:7],s36 offen offset:1024 nt lds
MV 188,88,172,188
s_add_u32 s36,s36,8192
v_exp_f32 v30,v162
MV 188,92,188,188
CV 208,28,29
v_max3_f32 v40,v40,v232,v236
MV 172,76,188,56
v_exp_f32 v31,v163
MV 172,72,172,172
v_cmp_lt_f32 vcc,s40,v40
MV 172,68,156,172
s_cbranch_vccnz L_st_r0
L_bk_r0:
v_exp_f32 v32,v176
MV 172,64,140,172
s_waitcnt lgkmcnt(11)
TR 122,14,4096
CV 209,30,31
MA 0,96,192
v_exp_f32 v33,v177
MA 4,96,196
TR 124,15,0
MA 8,96,200
v_exp_f32 v34,v178
MA 12,96,204
s_waitcnt lgkmcnt(11)
TR 126,15,4096
CV 210,32,33
MA 28,100,204
v_exp_f32 v35,v179
MA 24,100,200
RD 64,4,16384
MA 20,100,196
v_exp_f32 v28,v164
MA 16,100,192
s_waitcnt lgkmcnt(11)
RD 68,5,16384
CV 211,34,35
MA 32,104,192
s_add_u32 m0,s33,114688
v_exp_f32 v29,v165
MA 36,104,196
buffer_load_dwordx4 v18,s[8:11],s37 offen nt lds
MA 40,104,200
v_exp_f32 v30,v166
MA 44,104,204
s_waitcnt lgkmcnt(10)
RD 72,6,16384
CV 212,28,29
MA 60,108,204
v_exp_f32 v31,v167
MA 56,108,200
RD 76,7,16384
MA 52,108,196
v_exp_f32 v32,v180
MA 48,108,192
s_waitcnt lgkmcnt(10)
RD 80,4,20480
CV 213,30,31
MA 64,112,192
v_exp_f32 v33,v181
MA 68,112,196
RD 84,5,20480
MA 72,112,200
v_exp_f32 v34,v182
MA 76,112,204
s_waitcnt lgkmcnt(10)
RD 88,6,20480
CV 214,32,33
MA 92,116,204
v_exp_f32 v35,v183
MA 88,116,200
RD 92,7,20480
MA 84,116,196
v_exp_f32 v28,v168
MA 80,116,192
s_waitcnt lgkmcnt(10)
CV 215,34,35
MA 96,120,192
v_exp_f32 v29,v169
MA 100,120,196
buffer_load_dwordx4 v19,s[8:11],s37 offen offset:1024 nt lds
MA 104,120,200
s_add_u32 s37,s37,8192
v_exp_f32 v30,v170
MA 108,120,204
s_waitcnt lgkmcnt(8)
CV 216,28,29
MA 124,124,204
v_exp_f32 v31,v171
MA 120,124,200
MA 116,124,196
v_exp_f32 v32,v184
MA 112,124,192
CV 217,30,31
v_mfma_f32_16x16x32_bf16 v[240:243],v[36:39],v[208:211],v[224:227]
v_exp_f32 v33,v185
v_mfma_f32_16x16x32_bf16 v[244:247],v[36:39],v[212:215],v[228:231]
s_waitcnt lgkmcnt(7)
L_r1:
MV 128,64,128,44
s_waitcnt lgkmcnt(6)
v_exp_f32 v34,v186
MV 128,68,144,128
s_waitcnt lgkmcnt(5)
TR 96,8,8192
CV 218,32,33
MV 128,72,160,128
s_waitcnt lgkmcnt(5)
v_exp_f32 v35,v187
MV 128,76,176,128
s_waitcnt lgkmcnt(1)
TR 98,8,12288
MV 144,92,176,44
v_exp_f32 v28,v172
MV 144,88,160,144
TR 100,9,8192
CV 219,34,35
MV 144,84,144,144
v_exp_f32 v29,v173
MV 144,80,128,144
TR 102,9,12288
MV 148,80,132,48
v_exp_f32 v30,v174
MV 148,84,148,148
TR 104,10,8192
CV 220,28,29
MV 148,88,164,148
s_add_u32 m0,s33,8192
v_exp_f32 v31,v175
MV 148,92,180,148
buffer_load_dwordx4 v16,s[4:7],s36 offen nt lds
MV 132,76,180,48
v_exp_f32 v32,v188
MV 132,72,164,132
TR 106,10,12288
CV 221,30,31
MV 132,68,148,132
v_exp_f32 v33,v189
MV 132,64,132,132
TR 108,11,8192
MV 136,64,136,52
v_exp_f32 v34,v190
MV 136,68,152,136
TR 110,11,12288
CV 222,32,33
MV 136,72,168,136
v_exp_f32 v35,v191
MV 136,76,184,136
TR 112,12,8192
MV 152,92,184,52
v_max_f32 v40,v240,v244
MV 152,88,168,152
TR 114,12,12288
CV 223,34,35
MV 152,84,152,152
TR 116,13,8192
MV 152,80,136,152
TR 118,13,12288
v_mfma_f32_16x16x32_bf16 v[248:251],v[36:39],v[216:219],v[232:235]
v_exp_f32 v28,v128
v_mfma_f32_16x16x32_bf16 v[252:255],v[36:39],v[220:223],v[236:239]
TR 120,14,8192
MV 156,80,140,56
v_exp_f32 v29,v129
MV 156,84,156,156
buffer_load_dwordx4 v17,s[4:7],s36 offen offset:1024 nt lds
MV 156,88,172,156
s_add_u32 s36,s36,8192
v_exp_f32 v30,v130
MV 156,92,188,156
CV 192,28,29
v_max3_f32 v40,v40,v248,v252
MV 140,76,188,56
v_exp_f32 v31,v131
MV 140,72,172,140
v_cmp_lt_f32 vcc,s40,v40
MV 140,68,156,140
s_cbranch_vccnz L_st_r1
L_bk_r1:
v_exp_f32 v32,v144
MV 140,64,140,140
s_waitcnt lgkmcnt(11)
TR 122,14,12288
CV 193,30,31
MA 0,96,208
v_exp_f32 v33,v145
MA 4,96,212
TR 124,15,8192
MA 8,96,216
v_exp_f32 v34,v146
MA 12,96,220
s_waitcnt lgkmcnt(11)
TR 126,15,12288
CV 194,32,33
MA 28,100,220
v_exp_f32 v35,v147
MA 24,100,216
RD 64,4,24576
MA 20,100,212
v_exp_f32 v28,v132
MA 16,100,208
s_waitcnt lgkmcnt(11)
RD 68,5,24576
CV 195,34,35
MA 32,104,208
s_add_u32 m0,s33,122880
v_exp_f32 v29,v133
MA 36,104,212
buffer_load_dwordx4 v18,s[8:11],s37 offen nt lds
MA 40,104,216
v_exp_f32 v30,v134
MA 44,104,220
s_waitcnt lgkmcnt(10)
RD 72,6,24576
CV 196,28,29
MA 60,108,220
v_exp_f32 v31,v135
MA 56,108,216
RD 76,7,24576
MA 52,108,212
v_exp_f32 v32,v148
MA 48,108,208
s_waitcnt lgkmcnt(10)
RD 80,4,28672
CV 197,30,31
MA 64,112,208
v_exp_f32 v33,v149
MA 68,112,212
RD 84,5,28672
MA 72,112,216
v_exp_f32 v34,v150
MA 76,112,220
s_waitcnt lgkmcnt(10)
RD 88,6,28672
CV 198,32,33
MA 92,116,220
v_exp_f32 v35,v151
MA 88,116,216
RD 92,7,28672
MA 84,116,212
v_exp_f32 v28,v136
MA 80,116,208
s_waitcnt lgkmcnt(10)
CV 199,34,35
MA 96,120,208
v_exp_f32 v29,v137
MA 100,120,212
buffer_load_dwordx4 v19,s[8:11],s37 offen offset:1024 nt lds
MA 104,120,216
s_add_u32 s37,s37,8192
v_exp_f32 v30,v138
MA 108,120,220
s_waitcnt lgkmcnt(8)
CV 200,28,29
MA 124,124,220
v_exp_f32 v31,v139
MA 120,124,216
MA 116,124,212
v_exp_f32 v32,v152
MA 112,124,208
CV 201,30,31
v_mfma_f32_16x16x32_bf16 v[224:227],v[36:39],v[192:195],v[240:243]
v_exp_f32 v33,v153
v_mfma_f32_16x16x32_bf16 v[228:231],v[36:39],v[196:199],v[244:247]
s_waitcnt lgkmcnt(7)
MV 160,64,128,44
s_waitcnt vmcnt(16) lgkmcnt(0)
s_barrier
v_exp_f32 v34,v154
MV 160,68,144,160
TR 96,8,16384
CV 202,32,33
MV 160,72,160,160
v_exp_f32 v35,v155
MV 160,76,176,160
TR 98,8,20480
MV 176,92,176,44
v_exp_f32 v28,v140
MV 176,88,160,176
TR 100,9,16384
CV 203,34,35
MV 176,84,144,176
v_exp_f32 v29,v141
MV 176,80,128,176
TR 102,9,20480
MV 180,80,132,48
v_exp_f32 v30,v142
MV 180,84,148,180
TR 104,10,16384
CV 204,28,29
MV 180,88,164,180
s_add_u32 m0,s33,16384
v_exp_f32 v31,v143
MV 180,92,180,180
buffer_load_dwordx4 v16,s[4:7],s36 offen nt lds
MV 164,76,180,48
v_exp_f32 v32,v156
MV 164,72,164,164
TR 106,10,20480
CV 205,30,31
MV 164,68,148,164
v_exp_f32 v33,v157
MV 164,64,132,164
TR 108,11,16384
MV 168,64,136,52
v_exp_f32 v34,v158
MV 168,68,152,168
TR 110,11,20480
CV 206,32,33
MV 168,72,168,168
v_exp_f32 v35,v159
MV 168,76,184,168
TR 112,12,16384
MV 184,92,184,52
v_max_f32 v40,v224,v228
MV 184,88,168,184
TR 114,12,20480
CV 207,34,35
MV 184,84,152,184
TR 116,13,16384
MV 184,80,136,184
TR 118,13,20480
v_mfma_f32_16x16x32_bf16 v[232:235],v[36:39],v[200:203],v[248:251]
v_exp_f32 v28,v160
v_mfma_f32_16x16x32_bf16 v[236:239],v[36:39],v[204:207],v[252:255]
TR 120,14,16384
MV 188,80,140,56
v_exp_f32 v29,v161
MV 188,84,156,188
buffer_load_dwordx4 v17,s[4:7],s36 offen offset:1024 nt lds
MV 188,88,172,188
s_add_u32 s36,s36,8192
v_exp_f32 v30,v162
MV 188,92,188,188
CV 208,28,29
v_max3_f32 v40,v40,v232,v236
MV 172,76,188,56
v_exp_f32 v31,v163
MV 172,72,172,172
v_cmp_lt_f32 vcc,s40,v40
MV 172,68,156,172
s_cbranch_vccnz L_st_r2
L_bk_r2:
v_exp_f32 v32,v176
MV 172,64,140,172
s_waitcnt lgkmcnt(11)
TR 122,14,20480
CV 209,30,31
MA 0,96,192
v_exp_f32 v33,v177
MA 4,96,196
TR 124,15,16384
MA 8,96,200
v_exp_f32 v34,v178
MA 12,96,204
s_waitcnt lgkmcnt(11)
TR 126,15,20480
CV 210,32,33
MA 28,100,204
v_exp_f32 v35,v179
MA 24,100,200
RD 64,4,32768
MA 20,100,196
v_exp_f32 v28,v164
MA 16,100,192
s_waitcnt lgkmcnt(11)
RD 68,5,32768
CV 211,34,35
MA 32,104,192
s_add_u32 m0,s33,65536
v_exp_f32 v29,v165
MA 36,104,196
buffer_load_dwordx4 v18,s[8:11],s37 offen nt lds
MA 40,104,200
v_exp_f32 v30,v166
MA 44,104,204
s_waitcnt lgkmcnt(10)
RD 72,6,32768
CV 212,28,29
MA 60,108,204
v_exp_f32 v31,v167
MA 56,108,200
RD 76,7,32768
MA 52,108,196
v_exp_f32 v32,v180
MA 48,108,192
s_waitcnt lgkmcnt(10)
RD 80,4,36864
CV 213,30,31
MA 64,112,192
v_exp_f32 v33,v181
MA 68,112,196
RD 84,5,36864
MA 72,112,200
v_exp_f32 v34,v182
MA 76,112,204
s_waitcnt lgkmcnt(10)
RD 88,6,36864
CV 214,32,33
MA 92,116,204
v_exp_f32 v35,v183
MA 88,116,200
RD 92,7,36864
MA 84,116,196
v_exp_f32 v28,v168
MA 80,116,192
s_waitcnt lgkmcnt(10)
CV 215,34,35
MA 96,120,192
v_exp_f32 v29,v169
MA 100,120,196
buffer_load_dwordx4 v19,s[8:11],s37 offen offset:1024 nt lds
MA 104,120,200
s_add_u32 s37,s37,8192
v_exp_f32 v30,v170
MA 108,120,204
s_waitcnt lgkmcnt(8)
CV 216,28,29
MA 124,124,204
v_exp_f32 v31,v171
MA 120,124,200
MA 116,124,196
v_exp_f32 v32,v184
MA 112,124,192
CV 217,30,31
v_mfma_f32_16x16x32_bf16 v[240:243],v[36:39],v[208:211],v[224:227]
v_exp_f32 v33,v185
v_mfma_f32_16x16x32_bf16 v[244:247],v[36:39],v[212:215],v[228:231]
s_waitcnt lgkmcnt(7)
MV 128,64,128,44
s_waitcnt lgkmcnt(6)
v_exp_f32 v34,v186
MV 128,68,144,128
s_waitcnt lgkmcnt(5)
TR 96,8,24576
CV 218,32,33
MV 128,72,160,128
s_waitcnt lgkmcnt(5)
v_exp_f32 v35,v187
MV 128,76,176,128
s_waitcnt lgkmcnt(1)
TR 98,8,28672
MV 144,92,176,44
v_exp_f32 v28,v172
MV 144,88,160,144
TR 100,9,24576
CV 219,34,35
MV 144,84,144,144
v_exp_f32 v29,v173
MV 144,80,128,144
TR 102,9,28672
MV 148,80,132,48
v_exp_f32 v30,v174
MV 148,84,148,148
TR 104,10,24576
CV 220,28,29
MV 148,88,164,148
s_add_u32 m0,s33,24576
v_exp_f32 v31,v175
MV 148,92,180,148
buffer_load_dwordx4 v16,s[4:7],s36 offen nt lds
MV 132,76,180,48
v_exp_f32 v32,v188
MV 132,72,164,132
TR 106,10,28672
CV 221,30,31
MV 132,68,148,132
v_exp_f32 v33,v189
MV 132,64,132,132
TR 108,11,24576
MV 136,64,136,52
v_exp_f32 v34,v190
MV 136,68,152,136
TR 110,11,28672
CV 222,32,33
MV 136,72,168,136
v_exp_f32 v35,v191
MV 136,76,184,136
TR 112,12,24576
MV 152,92,184,52
v_max_f32 v40,v240,v244
MV 152,88,168,152
TR 114,12,28672
CV 223,34,35
MV 152,84,152,152
TR 116,13,24576
MV 152,80,136,152
TR 118,13,28672
v_mfma_f32_16x16x32_bf16 v[248:251],v[36:39],v[216:219],v[232:235]
v_exp_f32 v28,v128
v_mfma_f32_16x16x32_bf16 v[252:255],v[36:39],v[220:223],v[236:239]
TR 120,14,24576
MV 156,80,140,56
v_exp_f32 v29,v129
MV 156,84,156,156
buffer_load_dwordx4 v17,s[4:7],s36 offen offset:1024 nt lds
MV 156,88,172,156
s_add_u32 s36,s36,8192
v_exp_f32 v30,v130
MV 156,92,188,156
CV 192,28,29
v_max3_f32 v40,v40,v248,v252
MV 140,76,188,56
v_exp_f32 v31,v131
MV 140,72,172,140
v_cmp_lt_f32 vcc,s40,v40
MV 140,68,156,140
s_cbranch_vccnz L_st_r3
L_bk_r3:
v_exp_f32 v32,v144
MV 140,64,140,140
s_waitcnt lgkmcnt(11)
TR 122,14,28672
CV 193,30,31
MA 0,96,208
v_exp_f32 v33,v145
MA 4,96,212
TR 124,15,24576
MA 8,96,216
v_exp_f32 v34,v146
MA 12,96,220
s_waitcnt lgkmcnt(11)
TR 126,15,28672
CV 194,32,33
MA 28,100,220
v_exp_f32 v35,v147
MA 24,100,216
RD 64,4,40960
MA 20,100,212
v_exp_f32 v28,v132
MA 16,100,208
s_waitcnt lgkmcnt(11)
RD 68,5,40960
CV 195,34,35
MA 32,104,208
s_add_u32 m0,s33,73728
v_exp_f32 v29,v133
MA 36,104,212
buffer_load_dwordx4 v18,s[8:11],s37 offen nt lds
MA 40,104,216
v_exp_f32 v30,v134
MA 44,104,220
s_waitcnt lgkmcnt(10)
RD 72,6,40960
CV 196,28,29
MA 60,108,220
v_exp_f32 v31,v135
MA 56,108,216
RD 76,7,40960
MA 52,108,212
v_exp_f32 v32,v148
MA 48,108,208
s_waitcnt lgkmcnt(10)
RD 80,4,45056
CV 197,30,31
MA 64,112,208
v_exp_f32 v33,v149
MA 68,112,212
RD 84,5,45056
MA 72,112,216
v_exp_f32 v34,v150
MA 76,112,220
s_waitcnt lgkmcnt(10)
RD 88,6,45056
CV 198,32,33
MA 92,116,220
v_exp_f32 v35,v151
MA 88,116,216
RD 92,7,45056
MA 84,116,212
v_exp_f32 v28,v136
MA 80,116,208
s_waitcnt lgkmcnt(10)
CV 199,34,35
MA 96,120,208
v_exp_f32 v29,v137
MA 100,120,212
buffer_load_dwordx4 v19,s[8:11],s37 offen offset:1024 nt lds
MA 104,120,216
s_add_u32 s37,s37,8192
v_exp_f32 v30,v138
MA 108,120,220
s_waitcnt lgkmcnt(8)
CV 200,28,29
MA 124,124,220
v_exp_f32 v31,v139
MA 120,124,216
MA 116,124,212
v_exp_f32 v32,v152
MA 112,124,208
CV 201,30,31
v_mfma_f32_16x16x32_bf16 v[224:227],v[36:39],v[192:195],v[240:243]
v_exp_f32 v33,v153
v_mfma_f32_16x16x32_bf16 v[228:231],v[36:39],v[196:199],v[244:247]
s_waitcnt lgkmcnt(7)
MV 160,64,128,44
s_waitcnt vmcnt(16) lgkmcnt(0)
s_barrier
v_exp_f32 v34,v154
MV 160,68,144,160
TR 96,8,32768
CV 202,32,33
MV 160,72,160,160
v_exp_f32 v35,v155
MV 160,76,176,160
TR 98,8,36864
MV 176,92,176,44
v_exp_f32 v28,v140
MV 176,88,160,176
TR 100,9,32768
CV 203,34,35
MV 176,84,144,176
v_exp_f32 v29,v141
MV 176,80,128,176
TR 102,9,36864
MV 180,80,132,48
v_exp_f32 v30,v142
MV 180,84,148,180
TR 104,10,32768
CV 204,28,29
MV 180,88,164,180
s_add_u32 m0,s33,32768
v_exp_f32 v31,v143
MV 180,92,180,180
buffer_load_dwordx4 v16,s[4:7],s36 offen nt lds
MV 164,76,180,48
v_exp_f32 v32,v156
MV 164,72,164,164
TR 106,10,36864
CV 205,30,31
MV 164,68,148,164
v_exp_f32 v33,v157
MV 164,64,132,164
TR 108,11,32768
MV 168,64,136,52
v_exp_f32 v34,v158
MV 168,68,152,168
TR 110,11,36864
CV 206,32,33
MV 168,72,168,168
v_exp_f32 v35,v159
MV 168,76,184,168
TR 112,12,32768
MV 184,92,184,52
v_max_f32 v40,v224,v228
MV 184,88,168,184
TR 114,12,36864
CV 207,34,35
MV 184,84,152,184
TR 116,13,32768
MV 184,80,136,184
TR 118,13,36864
v_mfma_f32_16x16x32_bf16 v[232:235],v[36:39],v[200:203],v[248:251]
v_exp_f32 v28,v160
v_mfma_f32_16x16x32_bf16 v[236:239],v[36:39],v[204:207],v[252:255]
TR 120,14,32768
MV 188,80,140,56
v_exp_f32 v29,v161
MV 188,84,156,188
buffer_load_dwordx4 v17,s[4:7],s36 offen offset:1024 nt lds
MV 188,88,172,188
s_add_u32 s36,s36,8192
v_exp_f32 v30,v162
MV 188,92,188,188
CV 208,28,29
v_max3_f32 v40,v40,v232,v236
MV 172,76,188,56
v_exp_f32 v31,v163
MV 172,72,172,172
v_cmp_lt_f32 vcc,s40,v40
MV 172,68,156,172
s_cbranch_vccnz L_st_r4
L_bk_r4:
v_exp_f32 v32,v176
MV 172,64,140,172
s_waitcnt lgkmcnt(11)
TR 122,14,36864
CV 209,30,31
MA 0,96,192
v_exp_f32 v33,v177
MA 4,96,196
TR 124,15,32768
MA 8,96,200
v_exp_f32 v34,v178
MA 12,96,204
s_waitcnt lgkmcnt(11)
TR 126,15,36864
CV 210,32,33
MA 28,100,204
v_exp_f32 v35,v179
MA 24,100,200
RD 64,4,49152
MA 20,100,196
v_exp_f32 v28,v164
MA 16,100,192
s_waitcnt lgkmcnt(11)
RD 68,5,49152
CV 211,34,35
MA 32,104,192
s_add_u32 m0,s33,81920
v_exp_f32 v29,v165
MA 36,104,196
buffer_load_dwordx4 v18,s[8:11],s37 offen nt lds
MA 40,104,200
v_exp_f32 v30,v166
MA 44,104,204
s_waitcnt lgkmcnt(10)
RD 72,6,49152
CV 212,28,29
MA 60,108,204
v_exp_f32 v31,v167
MA 56,108,200
RD 76,7,49152
MA 52,108,196
v_exp_f32 v32,v180
MA 48,108,192
s_waitcnt lgkmcnt(10)
RD 80,4,53248
CV 213,30,31
MA 64,112,192
v_exp_f32 v33,v181
MA 68,112,196
RD 84,5,53248
MA 72,112,200
v_exp_f32 v34,v182
MA 76,112,204
s_waitcnt lgkmcnt(10)
RD 88,6,53248
CV 214,32,33
MA 92,116,204
v_exp_f32 v35,v183
MA 88,116,200
RD 92,7,53248
MA 84,116,196
v_exp_f32 v28,v168
MA 80,116,192
s_waitcnt lgkmcnt(10)
CV 215,34,35
MA 96,120,192
v_exp_f32 v29,v169
MA 100,120,196
buffer_load_dwordx4 v19,s[8:11],s37 offen offset:1024 nt lds
MA 104,120,200
s_add_u32 s37,s37,8192
v_exp_f32 v30,v170
MA 108,120,204
s_waitcnt lgkmcnt(8)
CV 216,28,29
MA 124,124,204
v_exp_f32 v31,v171
MA 120,124,200
MA 116,124,196
v_exp_f32 v32,v184
MA 112,124,192
CV 217,30,31
v_mfma_f32_16x16x32_bf16 v[240:243],v[36:39],v[208:211],v[224:227]
v_exp_f32 v33,v185
v_mfma_f32_16x16x32_bf16 v[244:247],v[36:39],v[212:215],v[228:231]
s_waitcnt lgkmcnt(7)
MV 128,64,128,44
s_waitcnt lgkmcnt(6)
v_exp_f32 v34,v186
MV 128,68,144,128
s_waitcnt lgkmcnt(5)
TR 96,8,40960
CV 218,32,33
MV 128,72,160,128
s_waitcnt lgkmcnt(5)
v_exp_f32 v35,v187
MV 128,76,176,128
s_waitcnt lgkmcnt(1)
TR 98,8,45056
MV 144,92,176,44
v_exp_f32 v28,v172
MV 144,88,160,144
TR 100,9,40960
CV 219,34,35
MV 144,84,144,144
v_exp_f32 v29,v173
MV 144,80,128,144
TR 102,9,45056
MV 148,80,132,48
v_exp_f32 v30,v174
MV 148,84,148,148
TR 104,10,40960
CV 220,28,29
MV 148,88,164,148
s_add_u32 m0,s33,40960
v_exp_f32 v31,v175
MV 148,92,180,148
buffer_load_dwordx4 v16,s[4:7],s36 offen nt lds
MV 132,76,180,48
v_exp_f32 v32,v188
MV 132,72,164,132
TR 106,10,45056
CV 221,30,31
MV 132,68,148,132
v_exp_f32 v33,v189
MV 132,64,132,132
TR 108,11,40960
MV 136,64,136,52
v_exp_f32 v34,v190
MV 136,68,152,136
TR 110,11,45056
CV 222,32,33
MV 136,72,168,136
v_exp_f32 v35,v191
MV 136,76,184,136
TR 112,12,40960
MV 152,92,184,52
v_max_f32 v40,v240,v244
MV 152,88,168,152
TR 114,12,45056
CV 223,34,35
MV 152,84,152,152
TR 116,13,40960
MV 152,80,136,152
TR 118,13,45056
v_mfma_f32_16x16x32_bf16 v[248:251],v[36:39],v[216:219],v[232:235]
v_exp_f32 v28,v128
v_mfma_f32_16x16x32_bf16 v[252:255],v[36:39],v[220:223],v[236:239]
TR 120,14,40960
MV 156,80,140,56
v_exp_f32 v29,v129
MV 156,84,156,156
buffer_load_dwordx4 v17,s[4:7],s36 offen offset:1024 nt lds
MV 156,88,172,156
s_add_u32 s36,s36,8192
v_exp_f32 v30,v130
MV 156,92,188,156
CV 192,28,29
v_max3_f32 v40,v40,v248,v252
MV 140,76,188,56
v_exp_f32 v31,v131
MV 140,72,172,140
v_cmp_lt_f32 vcc,s40,v40
MV 140,68,156,140
s_cbranch_vccnz L_st_r5
L_bk_r5:
v_exp_f32 v32,v144
MV 140,64,140,140
s_waitcnt lgkmcnt(11)
TR 122,14,45056
CV 193,30,31
MA 0,96,208
v_exp_f32 v33,v145
MA 4,96,212
TR 124,15,40960
MA 8,96,216
v_exp_f32 v34,v146
MA 12,96,220
s_waitcnt lgkmcnt(11)
TR 126,15,45056
CV 194,32,33
MA 28,100,220
v_exp_f32 v35,v147
MA 24,100,216
RD 64,4,57344
MA 20,100,212
v_exp_f32 v28,v132
MA 16,100,208
s_waitcnt lgkmcnt(11)
RD 68,5,57344
CV 195,34,35
MA 32,104,208
s_add_u32 m0,s33,90112
v_exp_f32 v29,v133
MA 36,104,212
buffer_load_dwordx4 v18,s[8:11],s37 offen nt lds
MA 40,104,216
v_exp_f32 v30,v134
MA 44,104,220
s_waitcnt lgkmcnt(10)
RD 72,6,57344
CV 196,28,29
MA 60,108,220
v_exp_f32 v31,v135
MA 56,108,216
RD 76,7,57344
MA 52,108,212
v_exp_f32 v32,v148
MA 48,108,208
s_waitcnt lgkmcnt(10)
RD 80,4,61440
CV 197,30,31
MA 64,112,208
v_exp_f32 v33,v149
MA 68,112,212
RD 84,5,61440
MA 72,112,216
v_exp_f32 v34,v150
MA 76,112,220
s_waitcnt lgkmcnt(10)
RD 88,6,61440
CV 198,32,33
MA 92,116,220
v_exp_f32 v35,v151
MA 88,116,216
RD 92,7,61440
MA 84,116,212
v_exp_f32 v28,v136
MA 80,116,208
s_waitcnt lgkmcnt(10)
CV 199,34,35
MA 96,120,208
v_exp_f32 v29,v137
MA 100,120,212
buffer_load_dwordx4 v19,s[8:11],s37 offen offset:1024 nt lds
MA 104,120,216
s_add_u32 s37,s37,8192
v_exp_f32 v30,v138
MA 108,120,220
s_waitcnt lgkmcnt(8)
CV 200,28,29
MA 124,124,220
v_exp_f32 v31,v139
MA 120,124,216
MA 116,124,212
v_exp_f32 v32,v152
MA 112,124,208
CV 201,30,31
v_mfma_f32_16x16x32_bf16 v[224:227],v[36:39],v[192:195],v[240:243]
v_exp_f32 v33,v153
v_mfma_f32_16x16x32_bf16 v[228:231],v[36:39],v[196:199],v[244:247]
s_waitcnt lgkmcnt(7)
MV 160,64,128,44
s_waitcnt vmcnt(16) lgkmcnt(0)
s_barrier
v_exp_f32 v34,v154
MV 160,68,144,160
TR 96,8,49152
CV 202,32,33
MV 160,72,160,160
v_exp_f32 v35,v155
MV 160,76,176,160
TR 98,8,53248
MV 176,92,176,44
v_exp_f32 v28,v140
MV 176,88,160,176
TR 100,9,49152
CV 203,34,35
MV 176,84,144,176
v_exp_f32 v29,v141
MV 176,80,128,176
TR 102,9,53248
MV 180,80,132,48
v_exp_f32 v30,v142
MV 180,84,148,180
TR 104,10,49152
CV 204,28,29
MV 180,88,164,180
s_add_u32 m0,s33,49152
v_exp_f32 v31,v143
MV 180,92,180,180
buffer_load_dwordx4 v16,s[4:7],s36 offen nt lds
MV 164,76,180,48
v_exp_f32 v32,v156
MV 164,72,164,164
TR 106,10,53248
CV 205,30,31
MV 164,68,148,164
v_exp_f32 v33,v157
MV 164,64,132,164
TR 108,11,49152
MV 168,64,136,52
v_exp_f32 v34,v158
MV 168,68,152,168
TR 110,11,53248
CV 206,32,33
MV 168,72,168,168
v_exp_f32 v35,v159
MV 168,76,184,168
TR 112,12,49152
MV 184,92,184,52
v_max_f32 v40,v224,v228
MV 184,88,168,184
TR 114,12,53248
CV 207,34,35
MV 184,84,152,184
TR 116,13,49152
MV 184,80,136,184
TR 118,13,53248
v_mfma_f32_16x16x32_bf16 v[232:235],v[36:39],v[200:203],v[248:251]
v_exp_f32 v28,v160
v_mfma_f32_16x16x32_bf16 v[236:239],v[36:39],v[204:207],v[252:255]
TR 120,14,49152
MV 188,80,140,56
v_exp_f32 v29,v161
MV 188,84,156,188
buffer_load_dwordx4 v17,s[4:7],s36 offen offset:1024 nt lds
MV 188,88,172,188
s_add_u32 s36,s36,8192
v_exp_f32 v30,v162
MV 188,92,188,188
CV 208,28,29
v_max3_f32 v40,v40,v232,v236
MV 172,76,188,56
v_exp_f32 v31,v163
MV 172,72,172,172
v_cmp_lt_f32 vcc,s40,v40
MV 172,68,156,172
s_cbranch_vccnz L_st_r6
L_bk_r6:
v_exp_f32 v32,v176
MV 172,64,140,172
s_waitcnt lgkmcnt(11)
TR 122,14,53248
CV 209,30,31
MA 0,96,192
v_exp_f32 v33,v177
MA 4,96,196
TR 124,15,49152
MA 8,96,200
v_exp_f32 v34,v178
MA 12,96,204
s_waitcnt lgkmcnt(11)
TR 126,15,53248
CV 210,32,33
MA 28,100,204
v_exp_f32 v35,v179
MA 24,100,200
RD 64,4,0
MA 20,100,196
v_exp_f32 v28,v164
MA 16,100,192
s_waitcnt lgkmcnt(11)
RD 68,5,0
CV 211,34,35
MA 32,104,192
s_add_u32 m0,s33,98304
v_exp_f32 v29,v165
MA 36,104,196
buffer_load_dwordx4 v18,s[8:11],s37 offen nt lds
MA 40,104,200
v_exp_f32 v30,v166
MA 44,104,204
s_waitcnt lgkmcnt(10)
RD 72,6,0
CV 212,28,29
MA 60,108,204
v_exp_f32 v31,v167
MA 56,108,200
RD 76,7,0
MA 52,108,196
v_exp_f32 v32,v180
MA 48,108,192
s_waitcnt lgkmcnt(10)
RD 80,4,4096
CV 213,30,31
MA 64,112,192
v_exp_f32 v33,v181
MA 68,112,196
RD 84,5,4096
MA 72,112,200
v_exp_f32 v34,v182
MA 76,112,204
s_waitcnt lgkmcnt(10)
RD 88,6,4096
CV 214,32,33
MA 92,116,204
v_exp_f32 v35,v183
MA 88,116,200
RD 92,7,4096
MA 84,116,196
v_exp_f32 v28,v168
MA 80,116,192
s_waitcnt lgkmcnt(10)
CV 215,34,35
MA 96,120,192
v_exp_f32 v29,v169
MA 100,120,196
buffer_load_dwordx4 v19,s[8:11],s37 offen offset:1024 nt lds
MA 104,120,200
s_add_u32 s37,s37,8192
v_exp_f32 v30,v170
MA 108,120,204
s_waitcnt lgkmcnt(8)
CV 216,28,29
MA 124,124,204
v_exp_f32 v31,v171
MA 120,124,200
MA 116,124,196
v_exp_f32 v32,v184
MA 112,124,192
CV 217,30,31
v_mfma_f32_16x16x32_bf16 v[240:243],v[36:39],v[208:211],v[224:227]
s_sub_u32 s94,s94,1
v_exp_f32 v33,v185
v_mfma_f32_16x16x32_bf16 v[244:247],v[36:39],v[212:215],v[228:231]
s_waitcnt lgkmcnt(7)
s_cbranch_scc1 L_sp
MV 128,64,128,44
s_waitcnt lgkmcnt(6)
v_exp_f32 v34,v186
MV 128,68,144,128
s_waitcnt lgkmcnt(5)
TR 96,8,57344
CV 218,32,33
MV 128,72,160,128
s_waitcnt lgkmcnt(5)
v_exp_f32 v35,v187
MV 128,76,176,128
s_waitcnt lgkmcnt(1)
TR 98,8,61440
MV 144,92,176,44
v_exp_f32 v28,v172
MV 144,88,160,144
TR 100,9,57344
CV 219,34,35
MV 144,84,144,144
v_exp_f32 v29,v173
MV 144,80,128,144
TR 102,9,61440
MV 148,80,132,48
v_exp_f32 v30,v174
MV 148,84,148,148
TR 104,10,57344
CV 220,28,29
MV 148,88,164,148
s_add_u32 m0,s33,57344
v_exp_f32 v31,v175
MV 148,92,180,148
buffer_load_dwordx4 v16,s[4:7],s36 offen nt lds
MV 132,76,180,48
v_exp_f32 v32,v188
MV 132,72,164,132
TR 106,10,61440
CV 221,30,31
MV 132,68,148,132
v_exp_f32 v33,v189
MV 132,64,132,132
TR 108,11,57344
MV 136,64,136,52
v_exp_f32 v34,v190
MV 136,68,152,136
TR 110,11,61440
CV 222,32,33
MV 136,72,168,136
v_exp_f32 v35,v191
MV 136,76,184,136
TR 112,12,57344
MV 152,92,184,52
v_max_f32 v40,v240,v244
MV 152,88,168,152
TR 114,12,61440
CV 223,34,35
MV 152,84,152,152
TR 116,13,57344
MV 152,80,136,152
TR 118,13,61440
v_mfma_f32_16x16x32_bf16 v[248:251],v[36:39],v[216:219],v[232:235]
v_exp_f32 v28,v128
v_mfma_f32_16x16x32_bf16 v[252:255],v[36:39],v[220:223],v[236:239]
TR 120,14,57344
MV 156,80,140,56
v_exp_f32 v29,v129
MV 156,84,156,156
buffer_load_dwordx4 v17,s[4:7],s36 offen offset:1024 nt lds
MV 156,88,172,156
s_add_u32 s36,s36,8192
v_exp_f32 v30,v130
MV 156,92,188,156
CV 192,28,29
v_max3_f32 v40,v40,v248,v252
MV 140,76,188,56
v_exp_f32 v31,v131
MV 140,72,172,140
v_cmp_lt_f32 vcc,s40,v40
MV 140,68,156,140
s_cbranch_vccnz L_st_r7
L_bk_r7:
v_exp_f32 v32,v144
MV 140,64,140,140
s_waitcnt lgkmcnt(11)
TR 122,14,61440
CV 193,30,31
MA 0,96,208
v_exp_f32 v33,v145
MA 4,96,212
TR 124,15,57344
MA 8,96,216
v_exp_f32 v34,v146
MA 12,96,220
s_waitcnt lgkmcnt(11)
TR 126,15,61440
CV 194,32,33
MA 28,100,220
v_exp_f32 v35,v147
MA 24,100,216
RD 64,4,8192
MA 20,100,212
v_exp_f32 v28,v132
MA 16,100,208
s_waitcnt lgkmcnt(11)
RD 68,5,8192
CV 195,34,35
MA 32,104,208
s_add_u32 m0,s33,106496
v_exp_f32 v29,v133
MA 36,104,212
buffer_load_dwordx4 v18,s[8:11],s37 offen nt lds
MA 40,104,216
v_exp_f32 v30,v134
MA 44,104,220
s_waitcnt lgkmcnt(10)
RD 72,6,8192
CV 196,28,29
MA 60,108,220
v_exp_f32 v31,v135
MA 56,108,216
RD 76,7,8192
MA 52,108,212
v_exp_f32 v32,v148
MA 48,108,208
s_waitcnt lgkmcnt(10)
RD 80,4,12288
CV 197,30,31
MA 64,112,208
v_exp_f32 v33,v149
MA 68,112,212
RD 84,5,12288
MA 72,112,216
v_exp_f32 v34,v150
MA 76,112,220
s_waitcnt lgkmcnt(10)
RD 88,6,12288
CV 198,32,33
MA 92,116,220
v_exp_f32 v35,v151
MA 88,116,216
RD 92,7,12288
MA 84,116,212
v_exp_f32 v28,v136
MA 80,116,208
s_waitcnt lgkmcnt(10)
CV 199,34,35
MA 96,120,208
v_exp_f32 v29,v137
MA 100,120,212
buffer_load_dwordx4 v19,s[8:11],s37 offen offset:1024 nt lds
MA 104,120,216
s_add_u32 s37,s37,8192
v_exp_f32 v30,v138
MA 108,120,220
s_waitcnt lgkmcnt(8)
CV 200,28,29
MA 124,124,220
v_exp_f32 v31,v139
MA 120,124,216
MA 116,124,212
v_exp_f32 v32,v152
MA 112,124,208
CV 201,30,31
v_mfma_f32_16x16x32_bf16 v[224:227],v[36:39],v[192:195],v[240:243]
s_cmp_lt_u32 s36,0x50000
v_exp_f32 v33,v153
v_mfma_f32_16x16x32_bf16 v[228:231],v[36:39],v[196:199],v[244:247]
s_waitcnt lgkmcnt(7)
s_cbranch_scc1 L_r0
s_cmp_eq_u32 s36,0x80000
s_cbranch_scc1 L_fin
s_cmp_eq_u32 s36,0x70000
s_cbranch_scc1 L_b47
s_cmp_eq_u32 s36,0x60000
s_cbranch_scc1 L_b39
L_b7:
s_branch L_r0
L_b39:
buffer_store_dword v61,v63,s[88:91],0 offen sc1
buffer_load_dword v62,v3,s[24:27],0 offen sc1
s_branch L_r0
L_b47:
s_movk_i32 s44,256
v_cmp_gt_u32 vcc,s44,v62
s_nop 0
s_cbranch_vccnz L_spin_c
L_back_c:
s_andn2_b32 s50,s2,0x38
s_lshl_b32 s50,s50,7
s_bfe_u32 s51,s2,0x10005
s_lshl_b32 s51,s51,3
s_add_u32 s50,s50,s51
s_lshr_b32 s51,s32,1
s_lshl_b32 s51,s51,2
s_add_u32 s50,s50,s51
s_add_u32 s24,s52,58720256
s_addc_u32 s25,s53,0
s_mov_b32 s26,32768
v_and_b32 v3,7,v0
v_lshlrev_b32 v3,10,v3
v_add_u32 v3,s50,v3
s_xor_b32 s50,s2,1
s_lshl_b32 s50,s50,7
s_lshl_b32 s49,s32,2
v_mov_b32 v41,s50
buffer_load_dword v62,v3,s[24:27],0 offen sc1
s_getpc_b64 s[50:51]
L_pc_L_fin:
s_add_u32 s50,s50,L_fin-L_pc_L_fin
s_addc_u32 s51,s51,0
v_lshlrev_b32 v21,7,v0
v_min_u32 v22,L_code_end-L_fin-4,v21
global_load_dword v23,v22,s[50:51]
s_getpc_b64 s[50:51]
L_pcc_L_fin:
s_add_u32 s50,s50,L_fin-L_pcc_L_fin
s_addc_u32 s51,s51,0
v_lshlrev_b32 v21,7,v0
v_add_u32 v21,32768,v21
v_min_u32 v22,L_code_end-L_fin-4,v21
global_load_dword v25,v22,s[50:51]
s_branch L_r0
L_sp:
v_mov_b32 v44,0xc1a00000
v_mov_b32 v45,0xc1a00000
v_mov_b64 v[46:47],v[44:45]
v_mov_b64 v[48:49],v[44:45]
v_mov_b64 v[50:51],v[44:45]
v_mov_b64 v[52:53],v[44:45]
v_mov_b64 v[54:55],v[44:45]
v_mov_b64 v[56:57],v[44:45]
v_mov_b64 v[58:59],v[44:45]
s_waitcnt lgkmcnt(7)
MV 128,64,192,44
s_waitcnt lgkmcnt(6)
v_exp_f32 v34,v186
MV 128,68,208,128
s_waitcnt lgkmcnt(5)
TR 96,8,57344
CV 218,32,33
v_accvgpr_mov_b32 a128,a192
v_accvgpr_mov_b32 a129,a193
MV 128,72,224,128
s_waitcnt lgkmcnt(5)
v_exp_f32 v35,v187
v_accvgpr_mov_b32 a130,a194
v_accvgpr_mov_b32 a131,a195
MV 128,76,240,128
s_waitcnt lgkmcnt(1)
TR 98,8,61440
v_accvgpr_mov_b32 a132,a196
v_accvgpr_mov_b32 a133,a197
v_accvgpr_mov_b32 a134,a198
MV 144,92,240,44
v_exp_f32 v28,v172
v_accvgpr_mov_b32 a135,a199
v_accvgpr_mov_b32 a136,a200
MV 144,88,224,144
TR 100,9,57344
CV 219,34,35
v_accvgpr_mov_b32 a137,a201
v_accvgpr_mov_b32 a138,a202
MV 144,84,208,144
v_exp_f32 v29,v173
v_accvgpr_mov_b32 a139,a203
v_accvgpr_mov_b32 a140,a204
MV 144,80,192,144
TR 102,9,61440
v_accvgpr_mov_b32 a141,a205
v_accvgpr_mov_b32 a142,a206
v_accvgpr_mov_b32 a143,a207
MV 148,80,196,48
v_exp_f32 v30,v174
v_accvgpr_mov_b32 a144,a208
v_accvgpr_mov_b32 a145,a209
MV 148,84,212,148
TR 104,10,57344
CV 220,28,29
v_accvgpr_mov_b32 a146,a210
v_accvgpr_mov_b32 a147,a211
MV 148,88,228,148
s_add_u32 m0,s33,57344
v_exp_f32 v31,v175
v_accvgpr_mov_b32 a148,a212
v_accvgpr_mov_b32 a149,a213
MV 148,92,244,148
buffer_load_dwordx4 v16,s[4:7],s36 offen nt lds
v_accvgpr_mov_b32 a150,a214
MV 132,76,244,48
v_exp_f32 v32,v188
v_accvgpr_mov_b32 a151,a215
v_accvgpr_mov_b32 a152,a216
MV 132,72,228,132
TR 106,10,61440
CV 221,30,31
v_accvgpr_mov_b32 a153,a217
v_accvgpr_mov_b32 a154,a218
MV 132,68,212,132
v_exp_f32 v33,v189
v_accvgpr_mov_b32 a155,a219
v_accvgpr_mov_b32 a156,a220
MV 132,64,196,132
TR 108,11,57344
v_accvgpr_mov_b32 a157,a221
v_accvgpr_mov_b32 a158,a222
v_accvgpr_mov_b32 a159,a223
MV 136,64,200,52
v_exp_f32 v34,v190
v_accvgpr_mov_b32 a160,a224
v_accvgpr_mov_b32 a161,a225
MV 136,68,216,136
TR 110,11,61440
CV 222,32,33
v_accvgpr_mov_b32 a162,a226
v_accvgpr_mov_b32 a163,a227
MV 136,72,232,136
v_exp_f32 v35,v191
v_accvgpr_mov_b32 a164,a228
v_accvgpr_mov_b32 a165,a229
MV 136,76,248,136
TR 112,12,57344
v_accvgpr_mov_b32 a166,a230
v_accvgpr_mov_b32 a167,a231
v_accvgpr_mov_b32 a168,a232
MV 152,92,248,52
v_max_f32 v40,v240,v244
v_accvgpr_mov_b32 a169,a233
v_accvgpr_mov_b32 a170,a234
v_accvgpr_mov_b32 a171,a235
MV 152,88,232,152
TR 114,12,61440
CV 223,34,35
v_accvgpr_mov_b32 a172,a236
v_accvgpr_mov_b32 a173,a237
MV 152,84,216,152
TR 116,13,57344
v_accvgpr_mov_b32 a174,a238
v_accvgpr_mov_b32 a175,a239
v_accvgpr_mov_b32 a176,a240
MV 152,80,200,152
TR 118,13,61440
v_accvgpr_mov_b32 a177,a241
v_accvgpr_mov_b32 a178,a242
v_accvgpr_mov_b32 a179,a243
v_mfma_f32_16x16x32_bf16 v[248:251],v[36:39],v[216:219],v[232:235]
v_exp_f32 v28,v128
v_accvgpr_mov_b32 a180,a244
v_accvgpr_mov_b32 a181,a245
v_mfma_f32_16x16x32_bf16 v[252:255],v[36:39],v[220:223],v[236:239]
TR 120,14,57344
v_accvgpr_mov_b32 a182,a246
v_accvgpr_mov_b32 a183,a247
v_accvgpr_mov_b32 a184,a248
MV 156,80,204,56
v_exp_f32 v29,v129
v_accvgpr_mov_b32 a185,a249
v_accvgpr_mov_b32 a186,a250
MV 156,84,220,156
buffer_load_dwordx4 v17,s[4:7],s36 offen offset:1024 nt lds
v_accvgpr_mov_b32 a187,a251
MV 156,88,236,156
s_add_u32 s36,s36,8192
v_exp_f32 v30,v130
v_accvgpr_mov_b32 a188,a252
v_accvgpr_mov_b32 a189,a253
MV 156,92,252,156
CV 192,28,29
v_max3_f32 v40,v40,v248,v252
v_accvgpr_mov_b32 a190,a254
v_accvgpr_mov_b32 a191,a255
MV 140,76,252,56
v_exp_f32 v31,v131
MV 140,72,236,140
v_cmp_lt_f32 vcc,s40,v40
MV 140,68,220,140
s_cbranch_vccnz L_st_sp31
L_bk_sp31:
v_exp_f32 v32,v144
MV 140,64,204,140
s_waitcnt lgkmcnt(11)
TR 122,14,61440
CV 193,30,31
v_rcp_f32 v20,v240
MA 0,96,208
v_exp_f32 v33,v145
v_rcp_f32 v22,v244
MA 4,96,212
TR 124,15,57344
v_rcp_f32 v24,v248
MA 8,96,216
v_exp_f32 v34,v146
v_rcp_f32 v26,v252
MA 12,96,220
s_waitcnt lgkmcnt(11)
TR 126,15,61440
CV 194,32,33
MA 16,100,208
v_exp_f32 v35,v147
MA 20,100,212
RD 64,4,8192
MA 24,100,216
v_exp_f32 v28,v132
MA 28,100,220
s_waitcnt lgkmcnt(11)
RD 68,5,8192
CV 195,34,35
MA 32,104,208
s_add_u32 m0,s33,106496
v_exp_f32 v29,v133
v_accvgpr_read_b32 v160,a0
v_accvgpr_read_b32 v161,a1
v_accvgpr_read_b32 v162,a2
MA 36,104,212
buffer_load_dwordx4 v18,s[8:11],s37 offen nt lds
v_accvgpr_read_b32 v163,a3
v_accvgpr_read_b32 v164,a16
MA 40,104,216
v_exp_f32 v30,v134
v_accvgpr_read_b32 v165,a17
v_accvgpr_read_b32 v166,a18
v_accvgpr_read_b32 v167,a19
MA 44,104,220
s_waitcnt lgkmcnt(10)
RD 72,6,8192
CV 196,28,29
v_mul_f32 v160,v20,v160
v_mul_f32 v161,v20,v161
v_mul_f32 v162,v20,v162
MA 48,108,208
v_exp_f32 v31,v135
v_mul_f32 v163,v20,v163
v_mul_f32 v164,v20,v164
v_mul_f32 v165,v20,v165
MA 52,108,212
RD 76,7,8192
v_mul_f32 v166,v20,v166
v_mul_f32 v167,v20,v167
CV 168,160,161
CV 169,162,163
MA 56,108,216
v_exp_f32 v32,v148
CV 170,164,165
CV 171,166,167
v_accvgpr_read_b32 v172,a4
MA 60,108,220
s_waitcnt lgkmcnt(10)
RD 80,4,12288
CV 197,30,31
v_accvgpr_read_b32 v173,a5
v_accvgpr_read_b32 v174,a6
v_accvgpr_read_b32 v175,a7
MA 64,112,208
v_exp_f32 v33,v149
v_accvgpr_read_b32 v176,a20
v_accvgpr_read_b32 v177,a21
v_accvgpr_read_b32 v178,a22
MA 68,112,212
RD 84,5,12288
v_accvgpr_read_b32 v179,a23
MA 72,112,216
buffer_store_dwordx4 v[168:171],v60,s[20:23],s96 offen offset:0 sc1
v_exp_f32 v34,v150
MA 76,112,220
s_waitcnt lgkmcnt(10)
RD 88,6,12288
CV 198,32,33
v_mul_f32 v172,v22,v172
v_mul_f32 v173,v22,v173
v_mul_f32 v174,v22,v174
MA 80,116,208
v_exp_f32 v35,v151
v_mul_f32 v175,v22,v175
v_mul_f32 v176,v22,v176
v_mul_f32 v177,v22,v177
MA 84,116,212
RD 92,7,12288
v_mul_f32 v178,v22,v178
v_mul_f32 v179,v22,v179
CV 180,172,173
CV 181,174,175
MA 88,116,216
v_exp_f32 v28,v136
CV 182,176,177
CV 183,178,179
v_accvgpr_read_b32 v160,a8
MA 92,116,220
s_waitcnt lgkmcnt(10)
CV 199,34,35
v_accvgpr_read_b32 v161,a9
v_accvgpr_read_b32 v162,a10
v_accvgpr_read_b32 v163,a11
v_accvgpr_read_b32 v164,a24
MA 96,120,208
v_exp_f32 v29,v137
v_accvgpr_read_b32 v165,a25
v_accvgpr_read_b32 v166,a26
v_accvgpr_read_b32 v167,a27
MA 100,120,212
buffer_load_dwordx4 v19,s[8:11],s37 offen offset:1024 nt lds
MA 104,120,216
s_add_u32 s37,s37,8192
buffer_store_dwordx4 v[180:183],v60,s[20:23],s96 offen offset:1024 sc1
v_exp_f32 v30,v138
MA 108,120,220
s_waitcnt lgkmcnt(8)
CV 200,28,29
v_mul_f32 v160,v24,v160
v_mul_f32 v161,v24,v161
v_mul_f32 v162,v24,v162
v_mul_f32 v163,v24,v163
MA 112,124,208
v_exp_f32 v31,v139
v_mul_f32 v164,v24,v164
v_mul_f32 v165,v24,v165
v_mul_f32 v166,v24,v166
MA 116,124,212
v_mul_f32 v167,v24,v167
CV 168,160,161
CV 169,162,163
CV 170,164,165
CV 171,166,167
MA 120,124,216
v_exp_f32 v32,v152
MA 124,124,220
CV 201,30,31
v_mfma_f32_16x16x32_bf16 v[224:227],v[36:39],v[192:195],0
v_exp_f32 v33,v153
v_mfma_f32_16x16x32_bf16 v[228:231],v[36:39],v[196:199],0
s_mov_b32 s24,s46
s_mov_b32 s25,s47
s_mov_b32 s26,4
v_mov_b32 v61,1
v_lshlrev_b32 v3,2,v0
v_lshlrev_b32 v63,7,v2
buffer_atomic_add v61,v3,s[24:27],0 offen sc1
v_mov_b32 v3,0
v_accvgpr_read_b32 v172,a12
v_accvgpr_read_b32 v173,a13
v_accvgpr_read_b32 v174,a14
v_accvgpr_read_b32 v175,a15
v_accvgpr_read_b32 v176,a28
v_accvgpr_read_b32 v177,a29
v_accvgpr_read_b32 v178,a30
v_accvgpr_read_b32 v179,a31
buffer_store_dwordx4 v[168:171],v60,s[20:23],s96 offen offset:2048 sc1
v_pk_mul_f32 v[172:173],v[172:173],v[26:27] op_sel_hi:[1,0]
v_pk_mul_f32 v[174:175],v[174:175],v[26:27] op_sel_hi:[1,0]
v_pk_mul_f32 v[176:177],v[176:177],v[26:27] op_sel_hi:[1,0]
v_pk_mul_f32 v[178:179],v[178:179],v[26:27] op_sel_hi:[1,0]
CV 180,172,173
CV 181,174,175
CV 182,176,177
CV 183,178,179
v_accvgpr_read_b32 v160,a32
v_accvgpr_read_b32 v161,a33
v_accvgpr_read_b32 v162,a34
v_accvgpr_read_b32 v163,a35
v_accvgpr_read_b32 v164,a48
v_accvgpr_read_b32 v165,a49
v_accvgpr_read_b32 v166,a50
v_accvgpr_read_b32 v167,a51
buffer_store_dwordx4 v[180:183],v60,s[20:23],s96 offen offset:3072 sc1
s_add_u32 s96,s96,4096
v_pk_mul_f32 v[160:161],v[160:161],v[20:21] op_sel_hi:[1,0]
v_pk_mul_f32 v[162:163],v[162:163],v[20:21] op_sel_hi:[1,0]
v_pk_mul_f32 v[164:165],v[164:165],v[20:21] op_sel_hi:[1,0]
v_pk_mul_f32 v[166:167],v[166:167],v[20:21] op_sel_hi:[1,0]
CV 168,160,161
CV 169,162,163
CV 170,164,165
CV 171,166,167
v_accvgpr_read_b32 v172,a36
v_accvgpr_read_b32 v173,a37
v_accvgpr_read_b32 v174,a38
v_accvgpr_read_b32 v175,a39
v_accvgpr_read_b32 v176,a52
v_accvgpr_read_b32 v177,a53
v_accvgpr_read_b32 v178,a54
v_accvgpr_read_b32 v179,a55
buffer_store_dwordx4 v[168:171],v60,s[20:23],s96 offen offset:0 sc1
v_pk_mul_f32 v[172:173],v[172:173],v[22:23] op_sel_hi:[1,0]
v_pk_mul_f32 v[174:175],v[174:175],v[22:23] op_sel_hi:[1,0]
v_pk_mul_f32 v[176:177],v[176:177],v[22:23] op_sel_hi:[1,0]
v_pk_mul_f32 v[178:179],v[178:179],v[22:23] op_sel_hi:[1,0]
CV 180,172,173
CV 181,174,175
CV 182,176,177
CV 183,178,179
v_accvgpr_read_b32 v160,a40
v_accvgpr_read_b32 v161,a41
v_accvgpr_read_b32 v162,a42
v_accvgpr_read_b32 v163,a43
v_accvgpr_read_b32 v164,a56
v_accvgpr_read_b32 v165,a57
v_accvgpr_read_b32 v166,a58
v_accvgpr_read_b32 v167,a59
buffer_store_dwordx4 v[180:183],v60,s[20:23],s96 offen offset:1024 sc1
v_pk_mul_f32 v[160:161],v[160:161],v[24:25] op_sel_hi:[1,0]
v_pk_mul_f32 v[162:163],v[162:163],v[24:25] op_sel_hi:[1,0]
v_pk_mul_f32 v[164:165],v[164:165],v[24:25] op_sel_hi:[1,0]
v_pk_mul_f32 v[166:167],v[166:167],v[24:25] op_sel_hi:[1,0]
CV 168,160,161
CV 169,162,163
CV 170,164,165
CV 171,166,167
v_accvgpr_read_b32 v172,a44
v_accvgpr_read_b32 v173,a45
v_accvgpr_read_b32 v174,a46
v_accvgpr_read_b32 v175,a47
v_accvgpr_read_b32 v176,a60
v_accvgpr_read_b32 v177,a61
v_accvgpr_read_b32 v178,a62
v_accvgpr_read_b32 v179,a63
buffer_store_dwordx4 v[168:171],v60,s[20:23],s96 offen offset:2048 sc1
v_pk_mul_f32 v[172:173],v[172:173],v[26:27] op_sel_hi:[1,0]
v_pk_mul_f32 v[174:175],v[174:175],v[26:27] op_sel_hi:[1,0]
v_pk_mul_f32 v[176:177],v[176:177],v[26:27] op_sel_hi:[1,0]
v_pk_mul_f32 v[178:179],v[178:179],v[26:27] op_sel_hi:[1,0]
CV 180,172,173
CV 181,174,175
CV 182,176,177
CV 183,178,179
v_accvgpr_read_b32 v160,a64
v_accvgpr_read_b32 v161,a65
v_accvgpr_read_b32 v162,a66
v_accvgpr_read_b32 v163,a67
v_accvgpr_read_b32 v164,a80
v_accvgpr_read_b32 v165,a81
v_accvgpr_read_b32 v166,a82
v_accvgpr_read_b32 v167,a83
buffer_store_dwordx4 v[180:183],v60,s[20:23],s96 offen offset:3072 sc1
s_add_u32 s96,s96,4096
v_pk_mul_f32 v[160:161],v[160:161],v[20:21] op_sel_hi:[1,0]
v_pk_mul_f32 v[162:163],v[162:163],v[20:21] op_sel_hi:[1,0]
v_pk_mul_f32 v[164:165],v[164:165],v[20:21] op_sel_hi:[1,0]
v_pk_mul_f32 v[166:167],v[166:167],v[20:21] op_sel_hi:[1,0]
CV 168,160,161
CV 169,162,163
CV 170,164,165
CV 171,166,167
v_accvgpr_read_b32 v172,a68
v_accvgpr_read_b32 v173,a69
v_accvgpr_read_b32 v174,a70
v_accvgpr_read_b32 v175,a71
v_accvgpr_read_b32 v176,a84
v_accvgpr_read_b32 v177,a85
v_accvgpr_read_b32 v178,a86
v_accvgpr_read_b32 v179,a87
buffer_store_dwordx4 v[168:171],v60,s[20:23],s96 offen offset:0 sc1
v_pk_mul_f32 v[172:173],v[172:173],v[22:23] op_sel_hi:[1,0]
v_pk_mul_f32 v[174:175],v[174:175],v[22:23] op_sel_hi:[1,0]
v_pk_mul_f32 v[176:177],v[176:177],v[22:23] op_sel_hi:[1,0]
v_pk_mul_f32 v[178:179],v[178:179],v[22:23] op_sel_hi:[1,0]
CV 180,172,173
CV 181,174,175
CV 182,176,177
CV 183,178,179
v_accvgpr_read_b32 v160,a72
v_accvgpr_read_b32 v161,a73
v_accvgpr_read_b32 v162,a74
v_accvgpr_read_b32 v163,a75
v_accvgpr_read_b32 v164,a88
v_accvgpr_read_b32 v165,a89
v_accvgpr_read_b32 v166,a90
v_accvgpr_read_b32 v167,a91
buffer_store_dwordx4 v[180:183],v60,s[20:23],s96 offen offset:1024 sc1
v_pk_mul_f32 v[160:161],v[160:161],v[24:25] op_sel_hi:[1,0]
v_pk_mul_f32 v[162:163],v[162:163],v[24:25] op_sel_hi:[1,0]
v_pk_mul_f32 v[164:165],v[164:165],v[24:25] op_sel_hi:[1,0]
v_pk_mul_f32 v[166:167],v[166:167],v[24:25] op_sel_hi:[1,0]
CV 168,160,161
CV 169,162,163
CV 170,164,165
CV 171,166,167
v_accvgpr_read_b32 v172,a76
v_accvgpr_read_b32 v173,a77
v_accvgpr_read_b32 v174,a78
v_accvgpr_read_b32 v175,a79
v_accvgpr_read_b32 v176,a92
v_accvgpr_read_b32 v177,a93
v_accvgpr_read_b32 v178,a94
v_accvgpr_read_b32 v179,a95
buffer_store_dwordx4 v[168:171],v60,s[20:23],s96 offen offset:2048 sc1
v_pk_mul_f32 v[172:173],v[172:173],v[26:27] op_sel_hi:[1,0]
v_pk_mul_f32 v[174:175],v[174:175],v[26:27] op_sel_hi:[1,0]
v_pk_mul_f32 v[176:177],v[176:177],v[26:27] op_sel_hi:[1,0]
v_pk_mul_f32 v[178:179],v[178:179],v[26:27] op_sel_hi:[1,0]
CV 180,172,173
CV 181,174,175
CV 182,176,177
CV 183,178,179
v_accvgpr_read_b32 v160,a96
v_accvgpr_read_b32 v161,a97
v_accvgpr_read_b32 v162,a98
v_accvgpr_read_b32 v163,a99
v_accvgpr_read_b32 v164,a112
v_accvgpr_read_b32 v165,a113
v_accvgpr_read_b32 v166,a114
v_accvgpr_read_b32 v167,a115
buffer_store_dwordx4 v[180:183],v60,s[20:23],s96 offen offset:3072 sc1
s_add_u32 s96,s96,4096
v_pk_mul_f32 v[160:161],v[160:161],v[20:21] op_sel_hi:[1,0]
v_pk_mul_f32 v[162:163],v[162:163],v[20:21] op_sel_hi:[1,0]
v_pk_mul_f32 v[164:165],v[164:165],v[20:21] op_sel_hi:[1,0]
v_pk_mul_f32 v[166:167],v[166:167],v[20:21] op_sel_hi:[1,0]
CV 168,160,161
CV 169,162,163
CV 170,164,165
CV 171,166,167
v_accvgpr_read_b32 v172,a100
v_accvgpr_read_b32 v173,a101
v_accvgpr_read_b32 v174,a102
v_accvgpr_read_b32 v175,a103
v_accvgpr_read_b32 v176,a116
v_accvgpr_read_b32 v177,a117
v_accvgpr_read_b32 v178,a118
v_accvgpr_read_b32 v179,a119
buffer_store_dwordx4 v[168:171],v60,s[20:23],s96 offen offset:0 sc1
v_pk_mul_f32 v[172:173],v[172:173],v[22:23] op_sel_hi:[1,0]
v_pk_mul_f32 v[174:175],v[174:175],v[22:23] op_sel_hi:[1,0]
v_pk_mul_f32 v[176:177],v[176:177],v[22:23] op_sel_hi:[1,0]
v_pk_mul_f32 v[178:179],v[178:179],v[22:23] op_sel_hi:[1,0]
CV 180,172,173
CV 181,174,175
CV 182,176,177
CV 183,178,179
v_accvgpr_read_b32 v160,a104
v_accvgpr_read_b32 v161,a105
v_accvgpr_read_b32 v162,a106
v_accvgpr_read_b32 v163,a107
v_accvgpr_read_b32 v164,a120
v_accvgpr_read_b32 v165,a121
v_accvgpr_read_b32 v166,a122
v_accvgpr_read_b32 v167,a123
buffer_store_dwordx4 v[180:183],v60,s[20:23],s96 offen offset:1024 sc1
v_pk_mul_f32 v[160:161],v[160:161],v[24:25] op_sel_hi:[1,0]
v_pk_mul_f32 v[162:163],v[162:163],v[24:25] op_sel_hi:[1,0]
v_pk_mul_f32 v[164:165],v[164:165],v[24:25] op_sel_hi:[1,0]
v_pk_mul_f32 v[166:167],v[166:167],v[24:25] op_sel_hi:[1,0]
CV 168,160,161
CV 169,162,163
CV 170,164,165
CV 171,166,167
v_accvgpr_read_b32 v172,a108
v_accvgpr_read_b32 v173,a109
v_accvgpr_read_b32 v174,a110
v_accvgpr_read_b32 v175,a111
v_accvgpr_read_b32 v176,a124
v_accvgpr_read_b32 v177,a125
v_accvgpr_read_b32 v178,a126
v_accvgpr_read_b32 v179,a127
buffer_store_dwordx4 v[168:171],v60,s[20:23],s96 offen offset:2048 sc1
v_pk_mul_f32 v[172:173],v[172:173],v[26:27] op_sel_hi:[1,0]
v_pk_mul_f32 v[174:175],v[174:175],v[26:27] op_sel_hi:[1,0]
v_pk_mul_f32 v[176:177],v[176:177],v[26:27] op_sel_hi:[1,0]
v_pk_mul_f32 v[178:179],v[178:179],v[26:27] op_sel_hi:[1,0]
CV 180,172,173
CV 181,174,175
CV 182,176,177
CV 183,178,179
buffer_store_dwordx4 v[180:183],v60,s[20:23],s96 offen offset:3072 sc1
s_add_u32 s96,s96,4096
v_mov_b32 v44,0xc1a00000
v_mov_b32 v45,0xc1a00000
v_mov_b64 v[46:47],v[44:45]
v_mov_b64 v[48:49],v[44:45]
v_mov_b64 v[50:51],v[44:45]
v_mov_b64 v[52:53],v[44:45]
v_mov_b64 v[54:55],v[44:45]
v_mov_b64 v[56:57],v[44:45]
v_mov_b64 v[58:59],v[44:45]
s_mov_b32 s95,1
s_mov_b32 s94,3
s_branch L_s0
L_st_r0:
s_mov_b32 s44,0
s_call_b64 s[42:43],L_fb0
v_exp_f32 v28,v160
v_exp_f32 v29,v161
v_exp_f32 v30,v162
CV 208,28,29
v_exp_f32 v31,v163
s_branch L_bk_r0
L_st_r1:
s_mov_b32 s44,0
s_call_b64 s[42:43],L_fb1
v_exp_f32 v28,v128
v_exp_f32 v29,v129
v_exp_f32 v30,v130
CV 192,28,29
v_exp_f32 v31,v131
s_branch L_bk_r1
L_st_r2:
s_mov_b32 s44,0
s_call_b64 s[42:43],L_fb0
v_exp_f32 v28,v160
v_exp_f32 v29,v161
v_exp_f32 v30,v162
CV 208,28,29
v_exp_f32 v31,v163
s_branch L_bk_r2
L_st_r3:
s_mov_b32 s44,0
s_call_b64 s[42:43],L_fb1
v_exp_f32 v28,v128
v_exp_f32 v29,v129
v_exp_f32 v30,v130
CV 192,28,29
v_exp_f32 v31,v131
s_branch L_bk_r3
L_st_r4:
s_mov_b32 s44,0
s_call_b64 s[42:43],L_fb0
v_exp_f32 v28,v160
v_exp_f32 v29,v161
v_exp_f32 v30,v162
CV 208,28,29
v_exp_f32 v31,v163
s_branch L_bk_r4
L_st_r5:
s_mov_b32 s44,0
s_call_b64 s[42:43],L_fb1
v_exp_f32 v28,v128
v_exp_f32 v29,v129
v_exp_f32 v30,v130
CV 192,28,29
v_exp_f32 v31,v131
s_branch L_bk_r5
L_st_r6:
s_mov_b32 s44,0
s_call_b64 s[42:43],L_fb0
v_exp_f32 v28,v160
v_exp_f32 v29,v161
v_exp_f32 v30,v162
CV 208,28,29
v_exp_f32 v31,v163
s_branch L_bk_r6
L_st_r7:
s_mov_b32 s44,0
s_call_b64 s[42:43],L_fb1
v_exp_f32 v28,v128
v_exp_f32 v29,v129
v_exp_f32 v30,v130
CV 192,28,29
v_exp_f32 v31,v131
s_branch L_bk_r7
L_st_p56:
s_mov_b32 s44,0
s_call_b64 s[42:43],L_fb0
v_exp_f32 v28,v160
v_exp_f32 v29,v161
v_exp_f32 v30,v162
CV 208,28,29
v_exp_f32 v31,v163
s_branch L_bk_p56
L_st_p57:
s_mov_b32 s44,0
s_call_b64 s[42:43],L_fb1
v_exp_f32 v28,v128
v_exp_f32 v29,v129
v_exp_f32 v30,v130
CV 192,28,29
v_exp_f32 v31,v131
s_branch L_bk_p57
L_st_p58:
s_mov_b32 s44,0
s_call_b64 s[42:43],L_fb0
v_exp_f32 v28,v160
v_exp_f32 v29,v161
v_exp_f32 v30,v162
CV 208,28,29
v_exp_f32 v31,v163
s_branch L_bk_p58
L_st_p59:
s_mov_b32 s44,0
s_call_b64 s[42:43],L_fb1
v_exp_f32 v28,v128
v_exp_f32 v29,v129
v_exp_f32 v30,v130
CV 192,28,29
v_exp_f32 v31,v131
s_branch L_bk_p59
L_st_p60:
s_mov_b32 s44,0
s_call_b64 s[42:43],L_fb0
v_exp_f32 v28,v160
v_exp_f32 v29,v161
v_exp_f32 v30,v162
CV 208,28,29
v_exp_f32 v31,v163
s_branch L_bk_p60
L_st_p61:
s_mov_b32 s44,0
s_call_b64 s[42:43],L_fb1
v_exp_f32 v28,v128
v_exp_f32 v29,v129
v_exp_f32 v30,v130
CV 192,28,29
v_exp_f32 v31,v131
s_branch L_bk_p61
L_st_p62:
s_mov_b32 s44,0
s_call_b64 s[42:43],L_fb0
v_exp_f32 v28,v160
v_exp_f32 v29,v161
v_exp_f32 v30,v162
CV 208,28,29
v_exp_f32 v31,v163
s_branch L_bk_p62
L_st_sp31:
s_mov_b32 s44,1
s_call_b64 s[42:43],L_fb1
v_exp_f32 v28,v128
v_exp_f32 v29,v129
v_exp_f32 v30,v130
CV 192,28,29
v_exp_f32 v31,v131
s_branch L_bk_sp31
L_st_fin31:
s_mov_b32 s44,1
s_call_b64 s[42:43],L_fb1
s_branch L_bk_fin31
L_st_s0:
s_call_b64 s[42:43],L_fbf
v_exp_f32 v28,v160
v_exp_f32 v29,v161
v_exp_f32 v30,v162
CV 208,28,29
v_exp_f32 v31,v163
s_branch L_bk_s0
L_fb0:
s_nop 7
s_nop 7
v_max3_f32 v208,v128,v129,v130
v_max3_f32 v209,v132,v133,v134
v_max3_f32 v210,v136,v137,v138
v_max3_f32 v211,v140,v141,v142
v_max3_f32 v208,v208,v131,v144
v_max3_f32 v209,v209,v135,v148
v_max3_f32 v210,v210,v139,v152
v_max3_f32 v211,v211,v143,v156
v_max3_f32 v208,v208,v145,v146
v_max3_f32 v209,v209,v149,v150
v_max3_f32 v210,v210,v153,v154
v_max3_f32 v211,v211,v157,v158
v_max_f32 v208,v208,v147
v_max_f32 v209,v209,v151
v_max_f32 v210,v210,v155
v_max_f32 v211,v211,v159
v_mov_b32 v28,v208
v_mov_b32 v29,v209
v_mov_b32 v30,v210
v_mov_b32 v31,v211
v_permlane16_swap_b32 v28,v208
v_permlane16_swap_b32 v29,v209
v_permlane16_swap_b32 v30,v210
v_permlane16_swap_b32 v31,v211
v_max_f32 v208,v208,v28
v_max_f32 v209,v209,v29
v_max_f32 v210,v210,v30
v_max_f32 v211,v211,v31
v_mov_b32 v28,v208
v_mov_b32 v29,v209
v_mov_b32 v30,v210
v_mov_b32 v31,v211
v_permlane32_swap_b32 v28,v208
v_permlane32_swap_b32 v29,v209
v_permlane32_swap_b32 v30,v210
v_permlane32_swap_b32 v31,v211
v_max_f32 v208,v208,v28
v_max_f32 v209,v209,v29
v_max_f32 v210,v210,v30
v_max_f32 v211,v211,v31
v_max_f32 v208,0,v208
v_max_f32 v209,0,v209
v_max_f32 v210,0,v210
v_max_f32 v211,0,v211
v_exp_f32 v212,-v208
v_exp_f32 v213,-v209
v_exp_f32 v214,-v210
v_exp_f32 v215,-v211
v_sub_f32 v128,v128,v208
v_sub_f32 v129,v129,v208
v_sub_f32 v130,v130,v208
v_sub_f32 v131,v131,v208
v_sub_f32 v144,v144,v208
v_sub_f32 v145,v145,v208
v_sub_f32 v146,v146,v208
v_sub_f32 v147,v147,v208
v_sub_f32 v44,v44,v208
v_sub_f32 v45,v45,v208
v_sub_f32 v46,v46,v208
v_sub_f32 v47,v47,v208
v_mul_f32 v240,v240,v212
v_sub_f32 v132,v132,v209
v_sub_f32 v133,v133,v209
v_sub_f32 v134,v134,v209
v_sub_f32 v135,v135,v209
v_sub_f32 v148,v148,v209
v_sub_f32 v149,v149,v209
v_sub_f32 v150,v150,v209
v_sub_f32 v151,v151,v209
v_sub_f32 v48,v48,v209
v_sub_f32 v49,v49,v209
v_sub_f32 v50,v50,v209
v_sub_f32 v51,v51,v209
v_mul_f32 v244,v244,v213
v_sub_f32 v136,v136,v210
v_sub_f32 v137,v137,v210
v_sub_f32 v138,v138,v210
v_sub_f32 v139,v139,v210
v_sub_f32 v152,v152,v210
v_sub_f32 v153,v153,v210
v_sub_f32 v154,v154,v210
v_sub_f32 v155,v155,v210
v_sub_f32 v52,v52,v210
v_sub_f32 v53,v53,v210
v_sub_f32 v54,v54,v210
v_sub_f32 v55,v55,v210
v_mul_f32 v248,v248,v214
v_sub_f32 v140,v140,v211
v_sub_f32 v141,v141,v211
v_sub_f32 v142,v142,v211
v_sub_f32 v143,v143,v211
v_sub_f32 v156,v156,v211
v_sub_f32 v157,v157,v211
v_sub_f32 v158,v158,v211
v_sub_f32 v159,v159,v211
v_sub_f32 v56,v56,v211
v_sub_f32 v57,v57,v211
v_sub_f32 v58,v58,v211
v_sub_f32 v59,v59,v211
v_mul_f32 v252,v252,v215
s_cmp_lg_u32 s44,0
s_cbranch_scc1 L_fb0_b
v_sub_f32 v160,v160,v208
v_sub_f32 v161,v161,v208
v_sub_f32 v162,v162,v208
v_sub_f32 v163,v163,v208
v_sub_f32 v176,v176,v208
v_sub_f32 v177,v177,v208
v_sub_f32 v178,v178,v208
v_sub_f32 v179,v179,v208
v_sub_f32 v164,v164,v209
v_sub_f32 v165,v165,v209
v_sub_f32 v166,v166,v209
v_sub_f32 v167,v167,v209
v_sub_f32 v180,v180,v209
v_sub_f32 v181,v181,v209
v_sub_f32 v182,v182,v209
v_sub_f32 v183,v183,v209
v_sub_f32 v168,v168,v210
v_sub_f32 v169,v169,v210
v_sub_f32 v170,v170,v210
v_sub_f32 v171,v171,v210
v_sub_f32 v184,v184,v210
v_sub_f32 v185,v185,v210
v_sub_f32 v186,v186,v210
v_sub_f32 v187,v187,v210
v_sub_f32 v172,v172,v211
v_sub_f32 v173,v173,v211
v_sub_f32 v174,v174,v211
v_sub_f32 v175,v175,v211
v_sub_f32 v188,v188,v211
v_sub_f32 v189,v189,v211
v_sub_f32 v190,v190,v211
v_sub_f32 v191,v191,v211
L_fb0_b:
v_accvgpr_read_b32 v216,a0
v_accvgpr_read_b32 v217,a1
v_accvgpr_read_b32 v218,a2
v_accvgpr_read_b32 v219,a3
v_mul_f32 v216,v216,v212
v_mul_f32 v217,v217,v212
v_mul_f32 v218,v218,v212
v_mul_f32 v219,v219,v212
v_accvgpr_write_b32 a0,v216
v_accvgpr_write_b32 a1,v217
v_accvgpr_write_b32 a2,v218
v_accvgpr_write_b32 a3,v219
v_accvgpr_read_b32 v220,a4
v_accvgpr_read_b32 v221,a5
v_accvgpr_read_b32 v222,a6
v_accvgpr_read_b32 v223,a7
v_mul_f32 v220,v220,v213
v_mul_f32 v221,v221,v213
v_mul_f32 v222,v222,v213
v_mul_f32 v223,v223,v213
v_accvgpr_write_b32 a4,v220
v_accvgpr_write_b32 a5,v221
v_accvgpr_write_b32 a6,v222
v_accvgpr_write_b32 a7,v223
v_accvgpr_read_b32 v216,a8
v_accvgpr_read_b32 v217,a9
v_accvgpr_read_b32 v218,a10
v_accvgpr_read_b32 v219,a11
v_mul_f32 v216,v216,v214
v_mul_f32 v217,v217,v214
v_mul_f32 v218,v218,v214
v_mul_f32 v219,v219,v214
v_accvgpr_write_b32 a8,v216
v_accvgpr_write_b32 a9,v217
v_accvgpr_write_b32 a10,v218
v_accvgpr_write_b32 a11,v219
v_accvgpr_read_b32 v220,a12
v_accvgpr_read_b32 v221,a13
v_accvgpr_read_b32 v222,a14
v_accvgpr_read_b32 v223,a15
v_mul_f32 v220,v220,v215
v_mul_f32 v221,v221,v215
v_mul_f32 v222,v222,v215
v_mul_f32 v223,v223,v215
v_accvgpr_write_b32 a12,v220
v_accvgpr_write_b32 a13,v221
v_accvgpr_write_b32 a14,v222
v_accvgpr_write_b32 a15,v223
v_accvgpr_read_b32 v216,a16
v_accvgpr_read_b32 v217,a17
v_accvgpr_read_b32 v218,a18
v_accvgpr_read_b32 v219,a19
v_mul_f32 v216,v216,v212
v_mul_f32 v217,v217,v212
v_mul_f32 v218,v218,v212
v_mul_f32 v219,v219,v212
v_accvgpr_write_b32 a16,v216
v_accvgpr_write_b32 a17,v217
v_accvgpr_write_b32 a18,v218
v_accvgpr_write_b32 a19,v219
v_accvgpr_read_b32 v220,a20
v_accvgpr_read_b32 v221,a21
v_accvgpr_read_b32 v222,a22
v_accvgpr_read_b32 v223,a23
v_mul_f32 v220,v220,v213
v_mul_f32 v221,v221,v213
v_mul_f32 v222,v222,v213
v_mul_f32 v223,v223,v213
v_accvgpr_write_b32 a20,v220
v_accvgpr_write_b32 a21,v221
v_accvgpr_write_b32 a22,v222
v_accvgpr_write_b32 a23,v223
v_accvgpr_read_b32 v216,a24
v_accvgpr_read_b32 v217,a25
v_accvgpr_read_b32 v218,a26
v_accvgpr_read_b32 v219,a27
v_mul_f32 v216,v216,v214
v_mul_f32 v217,v217,v214
v_mul_f32 v218,v218,v214
v_mul_f32 v219,v219,v214
v_accvgpr_write_b32 a24,v216
v_accvgpr_write_b32 a25,v217
v_accvgpr_write_b32 a26,v218
v_accvgpr_write_b32 a27,v219
v_accvgpr_read_b32 v220,a28
v_accvgpr_read_b32 v221,a29
v_accvgpr_read_b32 v222,a30
v_accvgpr_read_b32 v223,a31
v_mul_f32 v220,v220,v215
v_mul_f32 v221,v221,v215
v_mul_f32 v222,v222,v215
v_mul_f32 v223,v223,v215
v_accvgpr_write_b32 a28,v220
v_accvgpr_write_b32 a29,v221
v_accvgpr_write_b32 a30,v222
v_accvgpr_write_b32 a31,v223
v_accvgpr_read_b32 v216,a32
v_accvgpr_read_b32 v217,a33
v_accvgpr_read_b32 v218,a34
v_accvgpr_read_b32 v219,a35
v_mul_f32 v216,v216,v212
v_mul_f32 v217,v217,v212
v_mul_f32 v218,v218,v212
v_mul_f32 v219,v219,v212
v_accvgpr_write_b32 a32,v216
v_accvgpr_write_b32 a33,v217
v_accvgpr_write_b32 a34,v218
v_accvgpr_write_b32 a35,v219
v_accvgpr_read_b32 v220,a36
v_accvgpr_read_b32 v221,a37
v_accvgpr_read_b32 v222,a38
v_accvgpr_read_b32 v223,a39
v_mul_f32 v220,v220,v213
v_mul_f32 v221,v221,v213
v_mul_f32 v222,v222,v213
v_mul_f32 v223,v223,v213
v_accvgpr_write_b32 a36,v220
v_accvgpr_write_b32 a37,v221
v_accvgpr_write_b32 a38,v222
v_accvgpr_write_b32 a39,v223
v_accvgpr_read_b32 v216,a40
v_accvgpr_read_b32 v217,a41
v_accvgpr_read_b32 v218,a42
v_accvgpr_read_b32 v219,a43
v_mul_f32 v216,v216,v214
v_mul_f32 v217,v217,v214
v_mul_f32 v218,v218,v214
v_mul_f32 v219,v219,v214
v_accvgpr_write_b32 a40,v216
v_accvgpr_write_b32 a41,v217
v_accvgpr_write_b32 a42,v218
v_accvgpr_write_b32 a43,v219
v_accvgpr_read_b32 v220,a44
v_accvgpr_read_b32 v221,a45
v_accvgpr_read_b32 v222,a46
v_accvgpr_read_b32 v223,a47
v_mul_f32 v220,v220,v215
v_mul_f32 v221,v221,v215
v_mul_f32 v222,v222,v215
v_mul_f32 v223,v223,v215
v_accvgpr_write_b32 a44,v220
v_accvgpr_write_b32 a45,v221
v_accvgpr_write_b32 a46,v222
v_accvgpr_write_b32 a47,v223
v_accvgpr_read_b32 v216,a48
v_accvgpr_read_b32 v217,a49
v_accvgpr_read_b32 v218,a50
v_accvgpr_read_b32 v219,a51
v_mul_f32 v216,v216,v212
v_mul_f32 v217,v217,v212
v_mul_f32 v218,v218,v212
v_mul_f32 v219,v219,v212
v_accvgpr_write_b32 a48,v216
v_accvgpr_write_b32 a49,v217
v_accvgpr_write_b32 a50,v218
v_accvgpr_write_b32 a51,v219
v_accvgpr_read_b32 v220,a52
v_accvgpr_read_b32 v221,a53
v_accvgpr_read_b32 v222,a54
v_accvgpr_read_b32 v223,a55
v_mul_f32 v220,v220,v213
v_mul_f32 v221,v221,v213
v_mul_f32 v222,v222,v213
v_mul_f32 v223,v223,v213
v_accvgpr_write_b32 a52,v220
v_accvgpr_write_b32 a53,v221
v_accvgpr_write_b32 a54,v222
v_accvgpr_write_b32 a55,v223
v_accvgpr_read_b32 v216,a56
v_accvgpr_read_b32 v217,a57
v_accvgpr_read_b32 v218,a58
v_accvgpr_read_b32 v219,a59
v_mul_f32 v216,v216,v214
v_mul_f32 v217,v217,v214
v_mul_f32 v218,v218,v214
v_mul_f32 v219,v219,v214
v_accvgpr_write_b32 a56,v216
v_accvgpr_write_b32 a57,v217
v_accvgpr_write_b32 a58,v218
v_accvgpr_write_b32 a59,v219
v_accvgpr_read_b32 v220,a60
v_accvgpr_read_b32 v221,a61
v_accvgpr_read_b32 v222,a62
v_accvgpr_read_b32 v223,a63
v_mul_f32 v220,v220,v215
v_mul_f32 v221,v221,v215
v_mul_f32 v222,v222,v215
v_mul_f32 v223,v223,v215
v_accvgpr_write_b32 a60,v220
v_accvgpr_write_b32 a61,v221
v_accvgpr_write_b32 a62,v222
v_accvgpr_write_b32 a63,v223
v_accvgpr_read_b32 v216,a64
v_accvgpr_read_b32 v217,a65
v_accvgpr_read_b32 v218,a66
v_accvgpr_read_b32 v219,a67
v_mul_f32 v216,v216,v212
v_mul_f32 v217,v217,v212
v_mul_f32 v218,v218,v212
v_mul_f32 v219,v219,v212
v_accvgpr_write_b32 a64,v216
v_accvgpr_write_b32 a65,v217
v_accvgpr_write_b32 a66,v218
v_accvgpr_write_b32 a67,v219
v_accvgpr_read_b32 v220,a68
v_accvgpr_read_b32 v221,a69
v_accvgpr_read_b32 v222,a70
v_accvgpr_read_b32 v223,a71
v_mul_f32 v220,v220,v213
v_mul_f32 v221,v221,v213
v_mul_f32 v222,v222,v213
v_mul_f32 v223,v223,v213
v_accvgpr_write_b32 a68,v220
v_accvgpr_write_b32 a69,v221
v_accvgpr_write_b32 a70,v222
v_accvgpr_write_b32 a71,v223
v_accvgpr_read_b32 v216,a72
v_accvgpr_read_b32 v217,a73
v_accvgpr_read_b32 v218,a74
v_accvgpr_read_b32 v219,a75
v_mul_f32 v216,v216,v214
v_mul_f32 v217,v217,v214
v_mul_f32 v218,v218,v214
v_mul_f32 v219,v219,v214
v_accvgpr_write_b32 a72,v216
v_accvgpr_write_b32 a73,v217
v_accvgpr_write_b32 a74,v218
v_accvgpr_write_b32 a75,v219
v_accvgpr_read_b32 v220,a76
v_accvgpr_read_b32 v221,a77
v_accvgpr_read_b32 v222,a78
v_accvgpr_read_b32 v223,a79
v_mul_f32 v220,v220,v215
v_mul_f32 v221,v221,v215
v_mul_f32 v222,v222,v215
v_mul_f32 v223,v223,v215
v_accvgpr_write_b32 a76,v220
v_accvgpr_write_b32 a77,v221
v_accvgpr_write_b32 a78,v222
v_accvgpr_write_b32 a79,v223
v_accvgpr_read_b32 v216,a80
v_accvgpr_read_b32 v217,a81
v_accvgpr_read_b32 v218,a82
v_accvgpr_read_b32 v219,a83
v_mul_f32 v216,v216,v212
v_mul_f32 v217,v217,v212
v_mul_f32 v218,v218,v212
v_mul_f32 v219,v219,v212
v_accvgpr_write_b32 a80,v216
v_accvgpr_write_b32 a81,v217
v_accvgpr_write_b32 a82,v218
v_accvgpr_write_b32 a83,v219
v_accvgpr_read_b32 v220,a84
v_accvgpr_read_b32 v221,a85
v_accvgpr_read_b32 v222,a86
v_accvgpr_read_b32 v223,a87
v_mul_f32 v220,v220,v213
v_mul_f32 v221,v221,v213
v_mul_f32 v222,v222,v213
v_mul_f32 v223,v223,v213
v_accvgpr_write_b32 a84,v220
v_accvgpr_write_b32 a85,v221
v_accvgpr_write_b32 a86,v222
v_accvgpr_write_b32 a87,v223
v_accvgpr_read_b32 v216,a88
v_accvgpr_read_b32 v217,a89
v_accvgpr_read_b32 v218,a90
v_accvgpr_read_b32 v219,a91
v_mul_f32 v216,v216,v214
v_mul_f32 v217,v217,v214
v_mul_f32 v218,v218,v214
v_mul_f32 v219,v219,v214
v_accvgpr_write_b32 a88,v216
v_accvgpr_write_b32 a89,v217
v_accvgpr_write_b32 a90,v218
v_accvgpr_write_b32 a91,v219
v_accvgpr_read_b32 v220,a92
v_accvgpr_read_b32 v221,a93
v_accvgpr_read_b32 v222,a94
v_accvgpr_read_b32 v223,a95
v_mul_f32 v220,v220,v215
v_mul_f32 v221,v221,v215
v_mul_f32 v222,v222,v215
v_mul_f32 v223,v223,v215
v_accvgpr_write_b32 a92,v220
v_accvgpr_write_b32 a93,v221
v_accvgpr_write_b32 a94,v222
v_accvgpr_write_b32 a95,v223
v_accvgpr_read_b32 v216,a96
v_accvgpr_read_b32 v217,a97
v_accvgpr_read_b32 v218,a98
v_accvgpr_read_b32 v219,a99
v_mul_f32 v216,v216,v212
v_mul_f32 v217,v217,v212
v_mul_f32 v218,v218,v212
v_mul_f32 v219,v219,v212
v_accvgpr_write_b32 a96,v216
v_accvgpr_write_b32 a97,v217
v_accvgpr_write_b32 a98,v218
v_accvgpr_write_b32 a99,v219
v_accvgpr_read_b32 v220,a100
v_accvgpr_read_b32 v221,a101
v_accvgpr_read_b32 v222,a102
v_accvgpr_read_b32 v223,a103
v_mul_f32 v220,v220,v213
v_mul_f32 v221,v221,v213
v_mul_f32 v222,v222,v213
v_mul_f32 v223,v223,v213
v_accvgpr_write_b32 a100,v220
v_accvgpr_write_b32 a101,v221
v_accvgpr_write_b32 a102,v222
v_accvgpr_write_b32 a103,v223
v_accvgpr_read_b32 v216,a104
v_accvgpr_read_b32 v217,a105
v_accvgpr_read_b32 v218,a106
v_accvgpr_read_b32 v219,a107
v_mul_f32 v216,v216,v214
v_mul_f32 v217,v217,v214
v_mul_f32 v218,v218,v214
v_mul_f32 v219,v219,v214
v_accvgpr_write_b32 a104,v216
v_accvgpr_write_b32 a105,v217
v_accvgpr_write_b32 a106,v218
v_accvgpr_write_b32 a107,v219
v_accvgpr_read_b32 v220,a108
v_accvgpr_read_b32 v221,a109
v_accvgpr_read_b32 v222,a110
v_accvgpr_read_b32 v223,a111
v_mul_f32 v220,v220,v215
v_mul_f32 v221,v221,v215
v_mul_f32 v222,v222,v215
v_mul_f32 v223,v223,v215
v_accvgpr_write_b32 a108,v220
v_accvgpr_write_b32 a109,v221
v_accvgpr_write_b32 a110,v222
v_accvgpr_write_b32 a111,v223
v_accvgpr_read_b32 v216,a112
v_accvgpr_read_b32 v217,a113
v_accvgpr_read_b32 v218,a114
v_accvgpr_read_b32 v219,a115
v_mul_f32 v216,v216,v212
v_mul_f32 v217,v217,v212
v_mul_f32 v218,v218,v212
v_mul_f32 v219,v219,v212
v_accvgpr_write_b32 a112,v216
v_accvgpr_write_b32 a113,v217
v_accvgpr_write_b32 a114,v218
v_accvgpr_write_b32 a115,v219
v_accvgpr_read_b32 v220,a116
v_accvgpr_read_b32 v221,a117
v_accvgpr_read_b32 v222,a118
v_accvgpr_read_b32 v223,a119
v_mul_f32 v220,v220,v213
v_mul_f32 v221,v221,v213
v_mul_f32 v222,v222,v213
v_mul_f32 v223,v223,v213
v_accvgpr_write_b32 a116,v220
v_accvgpr_write_b32 a117,v221
v_accvgpr_write_b32 a118,v222
v_accvgpr_write_b32 a119,v223
v_accvgpr_read_b32 v216,a120
v_accvgpr_read_b32 v217,a121
v_accvgpr_read_b32 v218,a122
v_accvgpr_read_b32 v219,a123
v_mul_f32 v216,v216,v214
v_mul_f32 v217,v217,v214
v_mul_f32 v218,v218,v214
v_mul_f32 v219,v219,v214
v_accvgpr_write_b32 a120,v216
v_accvgpr_write_b32 a121,v217
v_accvgpr_write_b32 a122,v218
v_accvgpr_write_b32 a123,v219
v_accvgpr_read_b32 v220,a124
v_accvgpr_read_b32 v221,a125
v_accvgpr_read_b32 v222,a126
v_accvgpr_read_b32 v223,a127
v_mul_f32 v220,v220,v215
v_mul_f32 v221,v221,v215
v_mul_f32 v222,v222,v215
v_mul_f32 v223,v223,v215
v_accvgpr_write_b32 a124,v220
v_accvgpr_write_b32 a125,v221
v_accvgpr_write_b32 a126,v222
v_accvgpr_write_b32 a127,v223
v_exp_f32 v28,v128
v_exp_f32 v29,v129
v_exp_f32 v30,v130
CV 192,28,29
v_exp_f32 v31,v131
v_exp_f32 v32,v144
CV 193,30,31
v_exp_f32 v33,v145
v_exp_f32 v34,v146
CV 194,32,33
v_exp_f32 v35,v147
v_exp_f32 v28,v132
CV 195,34,35
v_exp_f32 v29,v133
v_exp_f32 v30,v134
CV 196,28,29
v_exp_f32 v31,v135
v_exp_f32 v32,v148
CV 197,30,31
v_exp_f32 v33,v149
v_exp_f32 v34,v150
CV 198,32,33
v_exp_f32 v35,v151
v_exp_f32 v28,v136
CV 199,34,35
v_exp_f32 v29,v137
v_exp_f32 v30,v138
CV 200,28,29
v_exp_f32 v31,v139
v_exp_f32 v32,v152
CV 201,30,31
v_mfma_f32_16x16x32_bf16 v[224:227],v[36:39],v[192:195],v[240:243]
v_exp_f32 v33,v153
v_mfma_f32_16x16x32_bf16 v[228:231],v[36:39],v[196:199],v[244:247]
v_exp_f32 v34,v154
CV 202,32,33
v_exp_f32 v35,v155
v_exp_f32 v28,v140
CV 203,34,35
v_exp_f32 v29,v141
v_exp_f32 v30,v142
CV 204,28,29
v_exp_f32 v31,v143
v_exp_f32 v32,v156
CV 205,30,31
v_exp_f32 v33,v157
v_exp_f32 v34,v158
CV 206,32,33
v_exp_f32 v35,v159
s_nop 0
CV 207,34,35
v_mfma_f32_16x16x32_bf16 v[232:235],v[36:39],v[200:203],v[248:251]
s_nop 0
v_mfma_f32_16x16x32_bf16 v[236:239],v[36:39],v[204:207],v[252:255]
s_nop 7
s_setpc_b64 s[42:43]
L_fb1:
s_nop 7
s_nop 7
v_max3_f32 v192,v160,v161,v162
v_max3_f32 v193,v164,v165,v166
v_max3_f32 v194,v168,v169,v170
v_max3_f32 v195,v172,v173,v174
v_max3_f32 v192,v192,v163,v176
v_max3_f32 v193,v193,v167,v180
v_max3_f32 v194,v194,v171,v184
v_max3_f32 v195,v195,v175,v188
v_max3_f32 v192,v192,v177,v178
v_max3_f32 v193,v193,v181,v182
v_max3_f32 v194,v194,v185,v186
v_max3_f32 v195,v195,v189,v190
v_max_f32 v192,v192,v179
v_max_f32 v193,v193,v183
v_max_f32 v194,v194,v187
v_max_f32 v195,v195,v191
v_mov_b32 v28,v192
v_mov_b32 v29,v193
v_mov_b32 v30,v194
v_mov_b32 v31,v195
v_permlane16_swap_b32 v28,v192
v_permlane16_swap_b32 v29,v193
v_permlane16_swap_b32 v30,v194
v_permlane16_swap_b32 v31,v195
v_max_f32 v192,v192,v28
v_max_f32 v193,v193,v29
v_max_f32 v194,v194,v30
v_max_f32 v195,v195,v31
v_mov_b32 v28,v192
v_mov_b32 v29,v193
v_mov_b32 v30,v194
v_mov_b32 v31,v195
v_permlane32_swap_b32 v28,v192
v_permlane32_swap_b32 v29,v193
v_permlane32_swap_b32 v30,v194
v_permlane32_swap_b32 v31,v195
v_max_f32 v192,v192,v28
v_max_f32 v193,v193,v29
v_max_f32 v194,v194,v30
v_max_f32 v195,v195,v31
v_max_f32 v192,0,v192
v_max_f32 v193,0,v193
v_max_f32 v194,0,v194
v_max_f32 v195,0,v195
v_exp_f32 v196,-v192
v_exp_f32 v197,-v193
v_exp_f32 v198,-v194
v_exp_f32 v199,-v195
v_sub_f32 v160,v160,v192
v_sub_f32 v161,v161,v192
v_sub_f32 v162,v162,v192
v_sub_f32 v163,v163,v192
v_sub_f32 v176,v176,v192
v_sub_f32 v177,v177,v192
v_sub_f32 v178,v178,v192
v_sub_f32 v179,v179,v192
v_sub_f32 v44,v44,v192
v_sub_f32 v45,v45,v192
v_sub_f32 v46,v46,v192
v_sub_f32 v47,v47,v192
v_mul_f32 v224,v224,v196
v_sub_f32 v164,v164,v193
v_sub_f32 v165,v165,v193
v_sub_f32 v166,v166,v193
v_sub_f32 v167,v167,v193
v_sub_f32 v180,v180,v193
v_sub_f32 v181,v181,v193
v_sub_f32 v182,v182,v193
v_sub_f32 v183,v183,v193
v_sub_f32 v48,v48,v193
v_sub_f32 v49,v49,v193
v_sub_f32 v50,v50,v193
v_sub_f32 v51,v51,v193
v_mul_f32 v228,v228,v197
v_sub_f32 v168,v168,v194
v_sub_f32 v169,v169,v194
v_sub_f32 v170,v170,v194
v_sub_f32 v171,v171,v194
v_sub_f32 v184,v184,v194
v_sub_f32 v185,v185,v194
v_sub_f32 v186,v186,v194
v_sub_f32 v187,v187,v194
v_sub_f32 v52,v52,v194
v_sub_f32 v53,v53,v194
v_sub_f32 v54,v54,v194
v_sub_f32 v55,v55,v194
v_mul_f32 v232,v232,v198
v_sub_f32 v172,v172,v195
v_sub_f32 v173,v173,v195
v_sub_f32 v174,v174,v195
v_sub_f32 v175,v175,v195
v_sub_f32 v188,v188,v195
v_sub_f32 v189,v189,v195
v_sub_f32 v190,v190,v195
v_sub_f32 v191,v191,v195
v_sub_f32 v56,v56,v195
v_sub_f32 v57,v57,v195
v_sub_f32 v58,v58,v195
v_sub_f32 v59,v59,v195
v_mul_f32 v236,v236,v199
s_cmp_lg_u32 s44,0
s_cbranch_scc1 L_fb1_b
v_sub_f32 v128,v128,v192
v_sub_f32 v129,v129,v192
v_sub_f32 v130,v130,v192
v_sub_f32 v131,v131,v192
v_sub_f32 v144,v144,v192
v_sub_f32 v145,v145,v192
v_sub_f32 v146,v146,v192
v_sub_f32 v147,v147,v192
v_sub_f32 v132,v132,v193
v_sub_f32 v133,v133,v193
v_sub_f32 v134,v134,v193
v_sub_f32 v135,v135,v193
v_sub_f32 v148,v148,v193
v_sub_f32 v149,v149,v193
v_sub_f32 v150,v150,v193
v_sub_f32 v151,v151,v193
v_sub_f32 v136,v136,v194
v_sub_f32 v137,v137,v194
v_sub_f32 v138,v138,v194
v_sub_f32 v139,v139,v194
v_sub_f32 v152,v152,v194
v_sub_f32 v153,v153,v194
v_sub_f32 v154,v154,v194
v_sub_f32 v155,v155,v194
v_sub_f32 v140,v140,v195
v_sub_f32 v141,v141,v195
v_sub_f32 v142,v142,v195
v_sub_f32 v143,v143,v195
v_sub_f32 v156,v156,v195
v_sub_f32 v157,v157,v195
v_sub_f32 v158,v158,v195
v_sub_f32 v159,v159,v195
L_fb1_b:
v_accvgpr_read_b32 v200,a0
v_accvgpr_read_b32 v201,a1
v_accvgpr_read_b32 v202,a2
v_accvgpr_read_b32 v203,a3
v_mul_f32 v200,v200,v196
v_mul_f32 v201,v201,v196
v_mul_f32 v202,v202,v196
v_mul_f32 v203,v203,v196
v_accvgpr_write_b32 a0,v200
v_accvgpr_write_b32 a1,v201
v_accvgpr_write_b32 a2,v202
v_accvgpr_write_b32 a3,v203
v_accvgpr_read_b32 v204,a4
v_accvgpr_read_b32 v205,a5
v_accvgpr_read_b32 v206,a6
v_accvgpr_read_b32 v207,a7
v_mul_f32 v204,v204,v197
v_mul_f32 v205,v205,v197
v_mul_f32 v206,v206,v197
v_mul_f32 v207,v207,v197
v_accvgpr_write_b32 a4,v204
v_accvgpr_write_b32 a5,v205
v_accvgpr_write_b32 a6,v206
v_accvgpr_write_b32 a7,v207
v_accvgpr_read_b32 v200,a8
v_accvgpr_read_b32 v201,a9
v_accvgpr_read_b32 v202,a10
v_accvgpr_read_b32 v203,a11
v_mul_f32 v200,v200,v198
v_mul_f32 v201,v201,v198
v_mul_f32 v202,v202,v198
v_mul_f32 v203,v203,v198
v_accvgpr_write_b32 a8,v200
v_accvgpr_write_b32 a9,v201
v_accvgpr_write_b32 a10,v202
v_accvgpr_write_b32 a11,v203
v_accvgpr_read_b32 v204,a12
v_accvgpr_read_b32 v205,a13
v_accvgpr_read_b32 v206,a14
v_accvgpr_read_b32 v207,a15
v_mul_f32 v204,v204,v199
v_mul_f32 v205,v205,v199
v_mul_f32 v206,v206,v199
v_mul_f32 v207,v207,v199
v_accvgpr_write_b32 a12,v204
v_accvgpr_write_b32 a13,v205
v_accvgpr_write_b32 a14,v206
v_accvgpr_write_b32 a15,v207
v_accvgpr_read_b32 v200,a16
v_accvgpr_read_b32 v201,a17
v_accvgpr_read_b32 v202,a18
v_accvgpr_read_b32 v203,a19
v_mul_f32 v200,v200,v196
v_mul_f32 v201,v201,v196
v_mul_f32 v202,v202,v196
v_mul_f32 v203,v203,v196
v_accvgpr_write_b32 a16,v200
v_accvgpr_write_b32 a17,v201
v_accvgpr_write_b32 a18,v202
v_accvgpr_write_b32 a19,v203
v_accvgpr_read_b32 v204,a20
v_accvgpr_read_b32 v205,a21
v_accvgpr_read_b32 v206,a22
v_accvgpr_read_b32 v207,a23
v_mul_f32 v204,v204,v197
v_mul_f32 v205,v205,v197
v_mul_f32 v206,v206,v197
v_mul_f32 v207,v207,v197
v_accvgpr_write_b32 a20,v204
v_accvgpr_write_b32 a21,v205
v_accvgpr_write_b32 a22,v206
v_accvgpr_write_b32 a23,v207
v_accvgpr_read_b32 v200,a24
v_accvgpr_read_b32 v201,a25
v_accvgpr_read_b32 v202,a26
v_accvgpr_read_b32 v203,a27
v_mul_f32 v200,v200,v198
v_mul_f32 v201,v201,v198
v_mul_f32 v202,v202,v198
v_mul_f32 v203,v203,v198
v_accvgpr_write_b32 a24,v200
v_accvgpr_write_b32 a25,v201
v_accvgpr_write_b32 a26,v202
v_accvgpr_write_b32 a27,v203
v_accvgpr_read_b32 v204,a28
v_accvgpr_read_b32 v205,a29
v_accvgpr_read_b32 v206,a30
v_accvgpr_read_b32 v207,a31
v_mul_f32 v204,v204,v199
v_mul_f32 v205,v205,v199
v_mul_f32 v206,v206,v199
v_mul_f32 v207,v207,v199
v_accvgpr_write_b32 a28,v204
v_accvgpr_write_b32 a29,v205
v_accvgpr_write_b32 a30,v206
v_accvgpr_write_b32 a31,v207
v_accvgpr_read_b32 v200,a32
v_accvgpr_read_b32 v201,a33
v_accvgpr_read_b32 v202,a34
v_accvgpr_read_b32 v203,a35
v_mul_f32 v200,v200,v196
v_mul_f32 v201,v201,v196
v_mul_f32 v202,v202,v196
v_mul_f32 v203,v203,v196
v_accvgpr_write_b32 a32,v200
v_accvgpr_write_b32 a33,v201
v_accvgpr_write_b32 a34,v202
v_accvgpr_write_b32 a35,v203
v_accvgpr_read_b32 v204,a36
v_accvgpr_read_b32 v205,a37
v_accvgpr_read_b32 v206,a38
v_accvgpr_read_b32 v207,a39
v_mul_f32 v204,v204,v197
v_mul_f32 v205,v205,v197
v_mul_f32 v206,v206,v197
v_mul_f32 v207,v207,v197
v_accvgpr_write_b32 a36,v204
v_accvgpr_write_b32 a37,v205
v_accvgpr_write_b32 a38,v206
v_accvgpr_write_b32 a39,v207
v_accvgpr_read_b32 v200,a40
v_accvgpr_read_b32 v201,a41
v_accvgpr_read_b32 v202,a42
v_accvgpr_read_b32 v203,a43
v_mul_f32 v200,v200,v198
v_mul_f32 v201,v201,v198
v_mul_f32 v202,v202,v198
v_mul_f32 v203,v203,v198
v_accvgpr_write_b32 a40,v200
v_accvgpr_write_b32 a41,v201
v_accvgpr_write_b32 a42,v202
v_accvgpr_write_b32 a43,v203
v_accvgpr_read_b32 v204,a44
v_accvgpr_read_b32 v205,a45
v_accvgpr_read_b32 v206,a46
v_accvgpr_read_b32 v207,a47
v_mul_f32 v204,v204,v199
v_mul_f32 v205,v205,v199
v_mul_f32 v206,v206,v199
v_mul_f32 v207,v207,v199
v_accvgpr_write_b32 a44,v204
v_accvgpr_write_b32 a45,v205
v_accvgpr_write_b32 a46,v206
v_accvgpr_write_b32 a47,v207
v_accvgpr_read_b32 v200,a48
v_accvgpr_read_b32 v201,a49
v_accvgpr_read_b32 v202,a50
v_accvgpr_read_b32 v203,a51
v_mul_f32 v200,v200,v196
v_mul_f32 v201,v201,v196
v_mul_f32 v202,v202,v196
v_mul_f32 v203,v203,v196
v_accvgpr_write_b32 a48,v200
v_accvgpr_write_b32 a49,v201
v_accvgpr_write_b32 a50,v202
v_accvgpr_write_b32 a51,v203
v_accvgpr_read_b32 v204,a52
v_accvgpr_read_b32 v205,a53
v_accvgpr_read_b32 v206,a54
v_accvgpr_read_b32 v207,a55
v_mul_f32 v204,v204,v197
v_mul_f32 v205,v205,v197
v_mul_f32 v206,v206,v197
v_mul_f32 v207,v207,v197
v_accvgpr_write_b32 a52,v204
v_accvgpr_write_b32 a53,v205
v_accvgpr_write_b32 a54,v206
v_accvgpr_write_b32 a55,v207
v_accvgpr_read_b32 v200,a56
v_accvgpr_read_b32 v201,a57
v_accvgpr_read_b32 v202,a58
v_accvgpr_read_b32 v203,a59
v_mul_f32 v200,v200,v198
v_mul_f32 v201,v201,v198
v_mul_f32 v202,v202,v198
v_mul_f32 v203,v203,v198
v_accvgpr_write_b32 a56,v200
v_accvgpr_write_b32 a57,v201
v_accvgpr_write_b32 a58,v202
v_accvgpr_write_b32 a59,v203
v_accvgpr_read_b32 v204,a60
v_accvgpr_read_b32 v205,a61
v_accvgpr_read_b32 v206,a62
v_accvgpr_read_b32 v207,a63
v_mul_f32 v204,v204,v199
v_mul_f32 v205,v205,v199
v_mul_f32 v206,v206,v199
v_mul_f32 v207,v207,v199
v_accvgpr_write_b32 a60,v204
v_accvgpr_write_b32 a61,v205
v_accvgpr_write_b32 a62,v206
v_accvgpr_write_b32 a63,v207
v_accvgpr_read_b32 v200,a64
v_accvgpr_read_b32 v201,a65
v_accvgpr_read_b32 v202,a66
v_accvgpr_read_b32 v203,a67
v_mul_f32 v200,v200,v196
v_mul_f32 v201,v201,v196
v_mul_f32 v202,v202,v196
v_mul_f32 v203,v203,v196
v_accvgpr_write_b32 a64,v200
v_accvgpr_write_b32 a65,v201
v_accvgpr_write_b32 a66,v202
v_accvgpr_write_b32 a67,v203
v_accvgpr_read_b32 v204,a68
v_accvgpr_read_b32 v205,a69
v_accvgpr_read_b32 v206,a70
v_accvgpr_read_b32 v207,a71
v_mul_f32 v204,v204,v197
v_mul_f32 v205,v205,v197
v_mul_f32 v206,v206,v197
v_mul_f32 v207,v207,v197
v_accvgpr_write_b32 a68,v204
v_accvgpr_write_b32 a69,v205
v_accvgpr_write_b32 a70,v206
v_accvgpr_write_b32 a71,v207
v_accvgpr_read_b32 v200,a72
v_accvgpr_read_b32 v201,a73
v_accvgpr_read_b32 v202,a74
v_accvgpr_read_b32 v203,a75
v_mul_f32 v200,v200,v198
v_mul_f32 v201,v201,v198
v_mul_f32 v202,v202,v198
v_mul_f32 v203,v203,v198
v_accvgpr_write_b32 a72,v200
v_accvgpr_write_b32 a73,v201
v_accvgpr_write_b32 a74,v202
v_accvgpr_write_b32 a75,v203
v_accvgpr_read_b32 v204,a76
v_accvgpr_read_b32 v205,a77
v_accvgpr_read_b32 v206,a78
v_accvgpr_read_b32 v207,a79
v_mul_f32 v204,v204,v199
v_mul_f32 v205,v205,v199
v_mul_f32 v206,v206,v199
v_mul_f32 v207,v207,v199
v_accvgpr_write_b32 a76,v204
v_accvgpr_write_b32 a77,v205
v_accvgpr_write_b32 a78,v206
v_accvgpr_write_b32 a79,v207
v_accvgpr_read_b32 v200,a80
v_accvgpr_read_b32 v201,a81
v_accvgpr_read_b32 v202,a82
v_accvgpr_read_b32 v203,a83
v_mul_f32 v200,v200,v196
v_mul_f32 v201,v201,v196
v_mul_f32 v202,v202,v196
v_mul_f32 v203,v203,v196
v_accvgpr_write_b32 a80,v200
v_accvgpr_write_b32 a81,v201
v_accvgpr_write_b32 a82,v202
v_accvgpr_write_b32 a83,v203
v_accvgpr_read_b32 v204,a84
v_accvgpr_read_b32 v205,a85
v_accvgpr_read_b32 v206,a86
v_accvgpr_read_b32 v207,a87
v_mul_f32 v204,v204,v197
v_mul_f32 v205,v205,v197
v_mul_f32 v206,v206,v197
v_mul_f32 v207,v207,v197
v_accvgpr_write_b32 a84,v204
v_accvgpr_write_b32 a85,v205
v_accvgpr_write_b32 a86,v206
v_accvgpr_write_b32 a87,v207
v_accvgpr_read_b32 v200,a88
v_accvgpr_read_b32 v201,a89
v_accvgpr_read_b32 v202,a90
v_accvgpr_read_b32 v203,a91
v_mul_f32 v200,v200,v198
v_mul_f32 v201,v201,v198
v_mul_f32 v202,v202,v198
v_mul_f32 v203,v203,v198
v_accvgpr_write_b32 a88,v200
v_accvgpr_write_b32 a89,v201
v_accvgpr_write_b32 a90,v202
v_accvgpr_write_b32 a91,v203
v_accvgpr_read_b32 v204,a92
v_accvgpr_read_b32 v205,a93
v_accvgpr_read_b32 v206,a94
v_accvgpr_read_b32 v207,a95
v_mul_f32 v204,v204,v199
v_mul_f32 v205,v205,v199
v_mul_f32 v206,v206,v199
v_mul_f32 v207,v207,v199
v_accvgpr_write_b32 a92,v204
v_accvgpr_write_b32 a93,v205
v_accvgpr_write_b32 a94,v206
v_accvgpr_write_b32 a95,v207
v_accvgpr_read_b32 v200,a96
v_accvgpr_read_b32 v201,a97
v_accvgpr_read_b32 v202,a98
v_accvgpr_read_b32 v203,a99
v_mul_f32 v200,v200,v196
v_mul_f32 v201,v201,v196
v_mul_f32 v202,v202,v196
v_mul_f32 v203,v203,v196
v_accvgpr_write_b32 a96,v200
v_accvgpr_write_b32 a97,v201
v_accvgpr_write_b32 a98,v202
v_accvgpr_write_b32 a99,v203
v_accvgpr_read_b32 v204,a100
v_accvgpr_read_b32 v205,a101
v_accvgpr_read_b32 v206,a102
v_accvgpr_read_b32 v207,a103
v_mul_f32 v204,v204,v197
v_mul_f32 v205,v205,v197
v_mul_f32 v206,v206,v197
v_mul_f32 v207,v207,v197
v_accvgpr_write_b32 a100,v204
v_accvgpr_write_b32 a101,v205
v_accvgpr_write_b32 a102,v206
v_accvgpr_write_b32 a103,v207
v_accvgpr_read_b32 v200,a104
v_accvgpr_read_b32 v201,a105
v_accvgpr_read_b32 v202,a106
v_accvgpr_read_b32 v203,a107
v_mul_f32 v200,v200,v198
v_mul_f32 v201,v201,v198
v_mul_f32 v202,v202,v198
v_mul_f32 v203,v203,v198
v_accvgpr_write_b32 a104,v200
v_accvgpr_write_b32 a105,v201
v_accvgpr_write_b32 a106,v202
v_accvgpr_write_b32 a107,v203
v_accvgpr_read_b32 v204,a108
v_accvgpr_read_b32 v205,a109
v_accvgpr_read_b32 v206,a110
v_accvgpr_read_b32 v207,a111
v_mul_f32 v204,v204,v199
v_mul_f32 v205,v205,v199
v_mul_f32 v206,v206,v199
v_mul_f32 v207,v207,v199
v_accvgpr_write_b32 a108,v204
v_accvgpr_write_b32 a109,v205
v_accvgpr_write_b32 a110,v206
v_accvgpr_write_b32 a111,v207
v_accvgpr_read_b32 v200,a112
v_accvgpr_read_b32 v201,a113
v_accvgpr_read_b32 v202,a114
v_accvgpr_read_b32 v203,a115
v_mul_f32 v200,v200,v196
v_mul_f32 v201,v201,v196
v_mul_f32 v202,v202,v196
v_mul_f32 v203,v203,v196
v_accvgpr_write_b32 a112,v200
v_accvgpr_write_b32 a113,v201
v_accvgpr_write_b32 a114,v202
v_accvgpr_write_b32 a115,v203
v_accvgpr_read_b32 v204,a116
v_accvgpr_read_b32 v205,a117
v_accvgpr_read_b32 v206,a118
v_accvgpr_read_b32 v207,a119
v_mul_f32 v204,v204,v197
v_mul_f32 v205,v205,v197
v_mul_f32 v206,v206,v197
v_mul_f32 v207,v207,v197
v_accvgpr_write_b32 a116,v204
v_accvgpr_write_b32 a117,v205
v_accvgpr_write_b32 a118,v206
v_accvgpr_write_b32 a119,v207
v_accvgpr_read_b32 v200,a120
v_accvgpr_read_b32 v201,a121
v_accvgpr_read_b32 v202,a122
v_accvgpr_read_b32 v203,a123
v_mul_f32 v200,v200,v198
v_mul_f32 v201,v201,v198
v_mul_f32 v202,v202,v198
v_mul_f32 v203,v203,v198
v_accvgpr_write_b32 a120,v200
v_accvgpr_write_b32 a121,v201
v_accvgpr_write_b32 a122,v202
v_accvgpr_write_b32 a123,v203
v_accvgpr_read_b32 v204,a124
v_accvgpr_read_b32 v205,a125
v_accvgpr_read_b32 v206,a126
v_accvgpr_read_b32 v207,a127
v_mul_f32 v204,v204,v199
v_mul_f32 v205,v205,v199
v_mul_f32 v206,v206,v199
v_mul_f32 v207,v207,v199
v_accvgpr_write_b32 a124,v204
v_accvgpr_write_b32 a125,v205
v_accvgpr_write_b32 a126,v206
v_accvgpr_write_b32 a127,v207
v_exp_f32 v28,v160
v_exp_f32 v29,v161
v_exp_f32 v30,v162
CV 208,28,29
v_exp_f32 v31,v163
v_exp_f32 v32,v176
CV 209,30,31
v_exp_f32 v33,v177
v_exp_f32 v34,v178
CV 210,32,33
v_exp_f32 v35,v179
v_exp_f32 v28,v164
CV 211,34,35
v_exp_f32 v29,v165
v_exp_f32 v30,v166
CV 212,28,29
v_exp_f32 v31,v167
v_exp_f32 v32,v180
CV 213,30,31
v_exp_f32 v33,v181
v_exp_f32 v34,v182
CV 214,32,33
v_exp_f32 v35,v183
v_exp_f32 v28,v168
CV 215,34,35
v_exp_f32 v29,v169
v_exp_f32 v30,v170
CV 216,28,29
v_exp_f32 v31,v171
v_exp_f32 v32,v184
CV 217,30,31
v_mfma_f32_16x16x32_bf16 v[240:243],v[36:39],v[208:211],v[224:227]
v_exp_f32 v33,v185
v_mfma_f32_16x16x32_bf16 v[244:247],v[36:39],v[212:215],v[228:231]
v_exp_f32 v34,v186
CV 218,32,33
v_exp_f32 v35,v187
v_exp_f32 v28,v172
CV 219,34,35
v_exp_f32 v29,v173
v_exp_f32 v30,v174
CV 220,28,29
v_exp_f32 v31,v175
v_exp_f32 v32,v188
CV 221,30,31
v_exp_f32 v33,v189
v_exp_f32 v34,v190
CV 222,32,33
v_exp_f32 v35,v191
s_nop 0
CV 223,34,35
v_mfma_f32_16x16x32_bf16 v[248:251],v[36:39],v[216:219],v[232:235]
s_nop 0
v_mfma_f32_16x16x32_bf16 v[252:255],v[36:39],v[220:223],v[236:239]
s_nop 7
s_setpc_b64 s[42:43]
L_fbf:
s_nop 7
s_nop 7
v_max3_f32 v208,v128,v129,v130
v_max3_f32 v209,v132,v133,v134
v_max3_f32 v210,v136,v137,v138
v_max3_f32 v211,v140,v141,v142
v_max3_f32 v208,v208,v131,v144
v_max3_f32 v209,v209,v135,v148
v_max3_f32 v210,v210,v139,v152
v_max3_f32 v211,v211,v143,v156
v_max3_f32 v208,v208,v145,v146
v_max3_f32 v209,v209,v149,v150
v_max3_f32 v210,v210,v153,v154
v_max3_f32 v211,v211,v157,v158
v_max_f32 v208,v208,v147
v_max_f32 v209,v209,v151
v_max_f32 v210,v210,v155
v_max_f32 v211,v211,v159
v_mov_b32 v28,v208
v_mov_b32 v29,v209
v_mov_b32 v30,v210
v_mov_b32 v31,v211
v_permlane16_swap_b32 v28,v208
v_permlane16_swap_b32 v29,v209
v_permlane16_swap_b32 v30,v210
v_permlane16_swap_b32 v31,v211
v_max_f32 v208,v208,v28
v_max_f32 v209,v209,v29
v_max_f32 v210,v210,v30
v_max_f32 v211,v211,v31
v_mov_b32 v28,v208
v_mov_b32 v29,v209
v_mov_b32 v30,v210
v_mov_b32 v31,v211
v_permlane32_swap_b32 v28,v208
v_permlane32_swap_b32 v29,v209
v_permlane32_swap_b32 v30,v210
v_permlane32_swap_b32 v31,v211
v_max_f32 v208,v208,v28
v_max_f32 v209,v209,v29
v_max_f32 v210,v210,v30
v_max_f32 v211,v211,v31
v_sub_f32 v128,v128,v208
v_sub_f32 v129,v129,v208
v_sub_f32 v130,v130,v208
v_sub_f32 v131,v131,v208
v_sub_f32 v144,v144,v208
v_sub_f32 v145,v145,v208
v_sub_f32 v146,v146,v208
v_sub_f32 v147,v147,v208
v_sub_f32 v44,v44,v208
v_sub_f32 v45,v45,v208
v_sub_f32 v46,v46,v208
v_sub_f32 v47,v47,v208
v_sub_f32 v132,v132,v209
v_sub_f32 v133,v133,v209
v_sub_f32 v134,v134,v209
v_sub_f32 v135,v135,v209
v_sub_f32 v148,v148,v209
v_sub_f32 v149,v149,v209
v_sub_f32 v150,v150,v209
v_sub_f32 v151,v151,v209
v_sub_f32 v48,v48,v209
v_sub_f32 v49,v49,v209
v_sub_f32 v50,v50,v209
v_sub_f32 v51,v51,v209
v_sub_f32 v136,v136,v210
v_sub_f32 v137,v137,v210
v_sub_f32 v138,v138,v210
v_sub_f32 v139,v139,v210
v_sub_f32 v152,v152,v210
v_sub_f32 v153,v153,v210
v_sub_f32 v154,v154,v210
v_sub_f32 v155,v155,v210
v_sub_f32 v52,v52,v210
v_sub_f32 v53,v53,v210
v_sub_f32 v54,v54,v210
v_sub_f32 v55,v55,v210
v_sub_f32 v140,v140,v211
v_sub_f32 v141,v141,v211
v_sub_f32 v142,v142,v211
v_sub_f32 v143,v143,v211
v_sub_f32 v156,v156,v211
v_sub_f32 v157,v157,v211
v_sub_f32 v158,v158,v211
v_sub_f32 v159,v159,v211
v_sub_f32 v56,v56,v211
v_sub_f32 v57,v57,v211
v_sub_f32 v58,v58,v211
v_sub_f32 v59,v59,v211
v_sub_f32 v160,v160,v208
v_sub_f32 v161,v161,v208
v_sub_f32 v162,v162,v208
v_sub_f32 v163,v163,v208
v_sub_f32 v176,v176,v208
v_sub_f32 v177,v177,v208
v_sub_f32 v178,v178,v208
v_sub_f32 v179,v179,v208
v_sub_f32 v164,v164,v209
v_sub_f32 v165,v165,v209
v_sub_f32 v166,v166,v209
v_sub_f32 v167,v167,v209
v_sub_f32 v180,v180,v209
v_sub_f32 v181,v181,v209
v_sub_f32 v182,v182,v209
v_sub_f32 v183,v183,v209
v_sub_f32 v168,v168,v210
v_sub_f32 v169,v169,v210
v_sub_f32 v170,v170,v210
v_sub_f32 v171,v171,v210
v_sub_f32 v184,v184,v210
v_sub_f32 v185,v185,v210
v_sub_f32 v186,v186,v210
v_sub_f32 v187,v187,v210
v_sub_f32 v172,v172,v211
v_sub_f32 v173,v173,v211
v_sub_f32 v174,v174,v211
v_sub_f32 v175,v175,v211
v_sub_f32 v188,v188,v211
v_sub_f32 v189,v189,v211
v_sub_f32 v190,v190,v211
v_sub_f32 v191,v191,v211
v_exp_f32 v28,v128
v_exp_f32 v29,v129
v_exp_f32 v30,v130
CV 192,28,29
v_exp_f32 v31,v131
v_exp_f32 v32,v144
CV 193,30,31
v_exp_f32 v33,v145
v_exp_f32 v34,v146
CV 194,32,33
v_exp_f32 v35,v147
v_exp_f32 v28,v132
CV 195,34,35
v_exp_f32 v29,v133
v_exp_f32 v30,v134
CV 196,28,29
v_exp_f32 v31,v135
v_exp_f32 v32,v148
CV 197,30,31
v_exp_f32 v33,v149
v_exp_f32 v34,v150
CV 198,32,33
v_exp_f32 v35,v151
v_exp_f32 v28,v136
CV 199,34,35
v_exp_f32 v29,v137
v_exp_f32 v30,v138
CV 200,28,29
v_exp_f32 v31,v139
v_exp_f32 v32,v152
CV 201,30,31
v_mfma_f32_16x16x32_bf16 v[224:227],v[36:39],v[192:195],0
v_exp_f32 v33,v153
v_mfma_f32_16x16x32_bf16 v[228:231],v[36:39],v[196:199],0
v_exp_f32 v34,v154
CV 202,32,33
v_exp_f32 v35,v155
v_exp_f32 v28,v140
CV 203,34,35
v_exp_f32 v29,v141
v_exp_f32 v30,v142
CV 204,28,29
v_exp_f32 v31,v143
v_exp_f32 v32,v156
CV 205,30,31
v_exp_f32 v33,v157
v_exp_f32 v34,v158
CV 206,32,33
v_exp_f32 v35,v159
s_nop 0
CV 207,34,35
v_mfma_f32_16x16x32_bf16 v[232:235],v[36:39],v[200:203],0
s_nop 0
v_mfma_f32_16x16x32_bf16 v[236:239],v[36:39],v[204:207],0
s_nop 7
s_setpc_b64 s[42:43]
L_spin_c:
s_mov_b32 s35,0x40000
L_spin2_c:
s_sleep 1
buffer_load_dword v62,v3,s[24:27],0 offen sc1
s_sub_u32 s35,s35,1
s_cbranch_scc1 L_back_c
s_waitcnt vmcnt(0)
v_cmp_gt_u32 vcc,s44,v62
s_nop 1
s_cbranch_vccnz L_spin2_c
s_branch L_back_c
L_spin_f1:
s_mov_b32 s35,0x40000
L_spin2_f1:
s_sleep 1
buffer_load_dword v62,v3,s[24:27],0 offen sc1
s_sub_u32 s35,s35,1
s_cbranch_scc1 L_back_f1
s_waitcnt vmcnt(0)
v_cmp_ne_u32 vcc,1,v62
s_nop 1
s_cbranch_vccnz L_spin2_f1
s_branch L_back_f1
L_spin_f2:
s_mov_b32 s35,0x40000
L_spin2_f2:
s_sleep 1
buffer_load_dword v62,v3,s[24:27],0 offen offset:16 sc1
s_sub_u32 s35,s35,1
s_cbranch_scc1 L_back_f2
s_waitcnt vmcnt(0)
v_cmp_ne_u32 vcc,1,v62
s_nop 1
s_cbranch_vccnz L_spin2_f2
s_branch L_back_f2
L_spin_d:
s_mov_b32 s35,0x40000
L_spin2_d:
s_sleep 1
buffer_load_dword v62,v41,s[24:27],0 offen offset:64 sc1
s_sub_u32 s35,s35,1
s_cbranch_scc1 L_back_d
s_waitcnt vmcnt(0)
v_cmp_eq_u32 vcc,0,v62
s_nop 1
s_cbranch_vccnz L_spin2_d
s_branch L_back_d
L_spin_f3:
s_mov_b32 s35,0x40000
L_spin2_f3:
s_sleep 1
buffer_load_dword v62,v3,s[24:27],0 offen offset:16 sc1
s_sub_u32 s35,s35,1
s_cbranch_scc1 L_back_f3
s_waitcnt vmcnt(0)
v_cmp_ne_u32 vcc,1,v62
s_nop 1
s_cbranch_vccnz L_spin2_f3
s_branch L_back_f3
L_spin_x:
s_mov_b32 s35,0x40000
L_spin2_x:
s_sleep 1
buffer_load_dword v62,v41,s[24:27],s49 offen offset:32 sc1
s_sub_u32 s35,s35,1
s_cbranch_scc1 L_back_x
s_waitcnt vmcnt(0)
v_cmp_ne_u32 vcc,1,v62
s_nop 1
s_cbranch_vccnz L_spin2_x
s_branch L_back_x
L_fin:
v_cmp_ne_u32 vcc,1,v62
s_nop 0
s_cbranch_vccnz L_spin_f1
L_back_f1:
v_add_u32 v16,s33,v60
s_and_b32 s50,s2,1
s_lshl_b32 s50,s50,10
v_add_u32 v27,s50,v60
v_xor_b32 v17,0x400,v27
buffer_load_dword v43,v41,s[24:27],0 offen offset:48 sc1
s_waitcnt lgkmcnt(7)
MV 160,64,128,44
s_waitcnt vmcnt(17) lgkmcnt(0)
s_barrier
v_exp_f32 v34,v154
MV 160,68,144,160
TR 96,8,0
CV 202,32,33
MV 160,72,160,160
v_exp_f32 v35,v155
MV 160,76,176,160
s_add_u32 m0,s33,114688
TR 98,8,4096
v_mov_b32 v42,1
MV 176,92,176,44
buffer_load_dwordx4 v18,s[8:11],s37 offen nt lds
v_exp_f32 v28,v140
MV 176,88,160,176
TR 100,9,0
CV 203,34,35
MV 176,84,144,176
v_exp_f32 v29,v141
MV 176,80,128,176
TR 102,9,4096
MV 180,80,132,48
v_exp_f32 v30,v142
MV 180,84,148,180
TR 104,10,0
CV 204,28,29
MV 180,88,164,180
v_exp_f32 v31,v143
MV 180,92,180,180
buffer_load_dwordx4 v19,s[8:11],s37 offen offset:1024 nt lds
MV 164,76,180,48
s_add_u32 s37,s37,8192
v_exp_f32 v32,v156
MV 164,72,164,164
TR 106,10,4096
CV 205,30,31
MV 164,68,148,164
v_exp_f32 v33,v157
MV 164,64,132,164
TR 108,11,0
MV 168,64,136,52
v_exp_f32 v34,v158
MV 168,68,152,168
TR 110,11,4096
CV 206,32,33
MV 168,72,168,168
s_mov_b32 s36,0
v_exp_f32 v35,v159
MV 168,76,184,168
s_add_u32 m0,s33,0
TR 112,12,0
MV 184,92,184,52
buffer_load_dwordx4 v16,s[16:19],s36 offen offset:0 sc1 lds
v_max_f32 v40,v224,v228
MV 184,88,168,184
TR 114,12,4096
CV 207,34,35
MV 184,84,152,184
TR 116,13,0
MV 184,80,136,184
TR 118,13,4096
v_mfma_f32_16x16x32_bf16 v[232:235],v[36:39],v[200:203],v[248:251]
v_exp_f32 v28,v160
v_mfma_f32_16x16x32_bf16 v[236:239],v[36:39],v[204:207],v[252:255]
TR 120,14,0
MV 188,80,140,56
v_exp_f32 v29,v161
MV 188,84,156,188
buffer_load_dwordx4 v16,s[16:19],s36 offen offset:1024 sc1 lds
MV 188,88,172,188
v_exp_f32 v30,v162
MV 188,92,188,188
CV 208,28,29
v_max3_f32 v40,v40,v232,v236
MV 172,76,188,56
v_exp_f32 v31,v163
MV 172,72,172,172
buffer_store_dword v42,v63,s[88:91],0 offen offset:48 sc1
v_cmp_lt_f32 vcc,s40,v40
MV 172,68,156,172
s_cbranch_vccnz L_st_p56
L_bk_p56:
v_exp_f32 v32,v176
MV 172,64,140,172
s_waitcnt lgkmcnt(11)
TR 122,14,4096
CV 209,30,31
MA 0,96,192
v_exp_f32 v33,v177
MA 4,96,196
TR 124,15,0
MA 8,96,200
v_exp_f32 v34,v178
MA 12,96,204
s_waitcnt lgkmcnt(11)
TR 126,15,4096
CV 210,32,33
MA 28,100,204
v_exp_f32 v35,v179
MA 24,100,200
RD 64,4,16384
MA 20,100,196
v_exp_f32 v28,v164
MA 16,100,192
s_mov_b32 s36,131072
RD 68,5,16384
CV 211,34,35
s_waitcnt lgkmcnt(12)
MA 32,104,192
s_add_u32 m0,s33,131072
v_exp_f32 v29,v165
MA 36,104,196
buffer_load_dwordx4 v16,s[16:19],s36 offen offset:0 sc1 lds
MA 40,104,200
v_exp_f32 v30,v166
MA 44,104,204
s_waitcnt lgkmcnt(10)
RD 72,6,16384
CV 212,28,29
MA 60,108,204
v_exp_f32 v31,v167
MA 56,108,200
RD 76,7,16384
MA 52,108,196
v_exp_f32 v32,v180
MA 48,108,192
s_waitcnt lgkmcnt(10)
RD 80,4,20480
CV 213,30,31
MA 64,112,192
v_exp_f32 v33,v181
MA 68,112,196
RD 84,5,20480
MA 72,112,200
v_exp_f32 v34,v182
MA 76,112,204
s_waitcnt lgkmcnt(10)
RD 88,6,20480
CV 214,32,33
MA 92,116,204
v_exp_f32 v35,v183
MA 88,116,200
RD 92,7,20480
MA 84,116,196
v_exp_f32 v28,v168
MA 80,116,192
s_waitcnt lgkmcnt(10)
buffer_load_dwordx4 v16,s[16:19],s36 offen offset:1024 sc1 lds
CV 215,34,35
MA 96,120,192
v_exp_f32 v29,v169
MA 100,120,196
MA 104,120,200
v_exp_f32 v30,v170
MA 108,120,204
s_waitcnt lgkmcnt(8)
CV 216,28,29
MA 124,124,204
s_mov_b32 s45,0
v_exp_f32 v31,v171
MA 120,124,200
buffer_load_dwordx4 a[192:195],v17,s[12:15],s45 offen sc1
MA 116,124,196
v_exp_f32 v32,v184
MA 112,124,192
CV 217,30,31
v_mfma_f32_16x16x32_bf16 v[240:243],v[36:39],v[208:211],v[224:227]
v_exp_f32 v33,v185
v_mfma_f32_16x16x32_bf16 v[244:247],v[36:39],v[212:215],v[228:231]
s_waitcnt lgkmcnt(7)
buffer_load_dwordx4 a[196:199],v27,s[12:15],s45 offen sc1
MV 128,64,128,44
s_waitcnt lgkmcnt(6)
v_exp_f32 v34,v186
MV 128,68,144,128
s_waitcnt lgkmcnt(5)
TR 96,8,8192
CV 218,32,33
MV 128,72,160,128
s_waitcnt lgkmcnt(5)
v_exp_f32 v35,v187
MV 128,76,176,128
s_add_u32 m0,s33,122880
TR 98,8,12288
v_mov_b32 v42,2
s_waitcnt lgkmcnt(2)
MV 144,92,176,44
buffer_load_dwordx4 v18,s[8:11],s37 offen nt lds
v_exp_f32 v28,v172
MV 144,88,160,144
TR 100,9,8192
CV 219,34,35
MV 144,84,144,144
v_exp_f32 v29,v173
MV 144,80,128,144
TR 102,9,12288
MV 148,80,132,48
v_exp_f32 v30,v174
MV 148,84,148,148
TR 104,10,8192
CV 220,28,29
MV 148,88,164,148
v_exp_f32 v31,v175
MV 148,92,180,148
buffer_load_dwordx4 v19,s[8:11],s37 offen offset:1024 nt lds
MV 132,76,180,48
s_add_u32 s37,s37,8192
v_exp_f32 v32,v188
MV 132,72,164,132
TR 106,10,12288
CV 221,30,31
MV 132,68,148,132
v_exp_f32 v33,v189
MV 132,64,132,132
TR 108,11,8192
MV 136,64,136,52
v_exp_f32 v34,v190
MV 136,68,152,136
TR 110,11,12288
CV 222,32,33
MV 136,72,168,136
s_mov_b32 s36,8192
v_exp_f32 v35,v191
MV 136,76,184,136
s_add_u32 m0,s33,8192
TR 112,12,8192
MV 152,92,184,52
buffer_load_dwordx4 v16,s[16:19],s36 offen offset:0 sc1 lds
v_max_f32 v40,v240,v244
MV 152,88,168,152
TR 114,12,12288
CV 223,34,35
MV 152,84,152,152
TR 116,13,8192
MV 152,80,136,152
TR 118,13,12288
v_mfma_f32_16x16x32_bf16 v[248:251],v[36:39],v[216:219],v[232:235]
v_exp_f32 v28,v128
v_mfma_f32_16x16x32_bf16 v[252:255],v[36:39],v[220:223],v[236:239]
TR 120,14,8192
MV 156,80,140,56
v_exp_f32 v29,v129
MV 156,84,156,156
buffer_load_dwordx4 v16,s[16:19],s36 offen offset:1024 sc1 lds
MV 156,88,172,156
v_exp_f32 v30,v130
MV 156,92,188,156
CV 192,28,29
v_max3_f32 v40,v40,v248,v252
MV 140,76,188,56
v_exp_f32 v31,v131
MV 140,72,172,140
buffer_store_dword v42,v63,s[88:91],0 offen offset:48 sc1
v_cmp_lt_f32 vcc,s40,v40
MV 140,68,156,140
s_cbranch_vccnz L_st_p57
L_bk_p57:
v_exp_f32 v32,v144
MV 140,64,140,140
s_waitcnt lgkmcnt(11)
TR 122,14,12288
CV 193,30,31
MA 0,96,208
v_exp_f32 v33,v145
MA 4,96,212
TR 124,15,8192
MA 8,96,216
v_exp_f32 v34,v146
MA 12,96,220
s_waitcnt lgkmcnt(11)
TR 126,15,12288
CV 194,32,33
MA 28,100,220
v_exp_f32 v35,v147
MA 24,100,216
RD 64,4,24576
MA 20,100,212
v_exp_f32 v28,v132
MA 16,100,208
s_mov_b32 s36,139264
RD 68,5,24576
CV 195,34,35
s_waitcnt lgkmcnt(12)
MA 32,104,208
s_add_u32 m0,s33,139264
v_exp_f32 v29,v133
MA 36,104,212
buffer_load_dwordx4 v16,s[16:19],s36 offen offset:0 sc1 lds
MA 40,104,216
v_exp_f32 v30,v134
MA 44,104,220
s_waitcnt lgkmcnt(10)
RD 72,6,24576
CV 196,28,29
MA 60,108,220
v_exp_f32 v31,v135
MA 56,108,216
RD 76,7,24576
MA 52,108,212
v_exp_f32 v32,v148
MA 48,108,208
s_waitcnt lgkmcnt(10)
RD 80,4,28672
CV 197,30,31
MA 64,112,208
v_exp_f32 v33,v149
MA 68,112,212
RD 84,5,28672
MA 72,112,216
v_exp_f32 v34,v150
MA 76,112,220
s_waitcnt lgkmcnt(10)
RD 88,6,28672
CV 198,32,33
MA 92,116,220
v_exp_f32 v35,v151
MA 88,116,216
RD 92,7,28672
MA 84,116,212
v_exp_f32 v28,v136
MA 80,116,208
s_waitcnt lgkmcnt(10)
buffer_load_dwordx4 v16,s[16:19],s36 offen offset:1024 sc1 lds
CV 199,34,35
MA 96,120,208
v_exp_f32 v29,v137
MA 100,120,212
MA 104,120,216
v_exp_f32 v30,v138
MA 108,120,220
s_waitcnt lgkmcnt(8)
CV 200,28,29
MA 124,124,220
s_mov_b32 s45,4096
v_exp_f32 v31,v139
MA 120,124,216
buffer_load_dwordx4 a[200:203],v17,s[12:15],s45 offen sc1
MA 116,124,212
v_exp_f32 v32,v152
MA 112,124,208
CV 201,30,31
v_mfma_f32_16x16x32_bf16 v[224:227],v[36:39],v[192:195],v[240:243]
v_exp_f32 v33,v153
v_mfma_f32_16x16x32_bf16 v[228:231],v[36:39],v[196:199],v[244:247]
s_waitcnt lgkmcnt(7)
buffer_load_dwordx4 a[204:207],v27,s[12:15],s45 offen sc1
MV 160,64,128,44
s_waitcnt vmcnt(27) lgkmcnt(0)
s_barrier
v_exp_f32 v34,v154
MV 160,68,144,160
TR 96,8,16384
CV 202,32,33
MV 160,72,160,160
s_mov_b32 s36,16384
v_exp_f32 v35,v155
MV 160,76,176,160
s_add_u32 m0,s33,16384
TR 98,8,20480
v_mov_b32 v42,3
MV 176,92,176,44
buffer_load_dwordx4 v16,s[16:19],s36 offen offset:0 sc1 lds
v_exp_f32 v28,v140
MV 176,88,160,176
TR 100,9,16384
CV 203,34,35
MV 176,84,144,176
v_exp_f32 v29,v141
MV 176,80,128,176
TR 102,9,20480
MV 180,80,132,48
v_exp_f32 v30,v142
MV 180,84,148,180
TR 104,10,16384
CV 204,28,29
MV 180,88,164,180
v_exp_f32 v31,v143
MV 180,92,180,180
buffer_load_dwordx4 v16,s[16:19],s36 offen offset:1024 sc1 lds
MV 164,76,180,48
v_exp_f32 v32,v156
MV 164,72,164,164
TR 106,10,20480
CV 205,30,31
MV 164,68,148,164
v_exp_f32 v33,v157
MV 164,64,132,164
TR 108,11,16384
MV 168,64,136,52
v_exp_f32 v34,v158
MV 168,68,152,168
TR 110,11,20480
CV 206,32,33
MV 168,72,168,168
v_exp_f32 v35,v159
MV 168,76,184,168
s_mov_b32 s45,8192
TR 112,12,16384
MV 184,92,184,52
buffer_load_dwordx4 a[208:211],v17,s[12:15],s45 offen sc1
v_max_f32 v40,v224,v228
MV 184,88,168,184
TR 114,12,20480
CV 207,34,35
MV 184,84,152,184
TR 116,13,16384
MV 184,80,136,184
TR 118,13,20480
v_mfma_f32_16x16x32_bf16 v[232:235],v[36:39],v[200:203],v[248:251]
v_exp_f32 v28,v160
v_mfma_f32_16x16x32_bf16 v[236:239],v[36:39],v[204:207],v[252:255]
TR 120,14,16384
MV 188,80,140,56
v_exp_f32 v29,v161
MV 188,84,156,188
buffer_load_dwordx4 a[212:215],v27,s[12:15],s45 offen sc1
MV 188,88,172,188
v_exp_f32 v30,v162
MV 188,92,188,188
CV 208,28,29
v_max3_f32 v40,v40,v232,v236
MV 172,76,188,56
v_exp_f32 v31,v163
MV 172,72,172,172
buffer_store_dword v42,v63,s[88:91],0 offen offset:48 sc1
v_cmp_lt_f32 vcc,s40,v40
MV 172,68,156,172
s_cbranch_vccnz L_st_p58
L_bk_p58:
v_exp_f32 v32,v176
MV 172,64,140,172
s_waitcnt lgkmcnt(11)
TR 122,14,20480
CV 209,30,31
MA 0,96,192
v_exp_f32 v33,v177
MA 4,96,196
TR 124,15,16384
MA 8,96,200
v_exp_f32 v34,v178
MA 12,96,204
s_waitcnt lgkmcnt(11)
TR 126,15,20480
CV 210,32,33
MA 28,100,204
v_exp_f32 v35,v179
MA 24,100,200
RD 64,4,32768
MA 20,100,196
v_exp_f32 v28,v164
MA 16,100,192
s_mov_b32 s36,65536
RD 68,5,32768
CV 211,34,35
s_waitcnt lgkmcnt(12)
MA 32,104,192
s_add_u32 m0,s33,65536
v_exp_f32 v29,v165
MA 36,104,196
buffer_load_dwordx4 v16,s[16:19],s36 offen offset:0 sc1 lds
MA 40,104,200
v_exp_f32 v30,v166
MA 44,104,204
s_waitcnt lgkmcnt(10)
RD 72,6,32768
CV 212,28,29
MA 60,108,204
v_exp_f32 v31,v167
MA 56,108,200
RD 76,7,32768
MA 52,108,196
v_exp_f32 v32,v180
MA 48,108,192
s_waitcnt lgkmcnt(10)
RD 80,4,36864
CV 213,30,31
MA 64,112,192
v_exp_f32 v33,v181
MA 68,112,196
RD 84,5,36864
MA 72,112,200
v_exp_f32 v34,v182
MA 76,112,204
s_waitcnt lgkmcnt(10)
RD 88,6,36864
CV 214,32,33
MA 92,116,204
v_exp_f32 v35,v183
MA 88,116,200
RD 92,7,36864
MA 84,116,196
v_exp_f32 v28,v168
MA 80,116,192
s_waitcnt lgkmcnt(10)
buffer_load_dwordx4 v16,s[16:19],s36 offen offset:1024 sc1 lds
CV 215,34,35
MA 96,120,192
v_exp_f32 v29,v169
MA 100,120,196
MA 104,120,200
v_exp_f32 v30,v170
MA 108,120,204
s_waitcnt lgkmcnt(8)
CV 216,28,29
MA 124,124,204
s_mov_b32 s45,12288
v_exp_f32 v31,v171
MA 120,124,200
buffer_load_dwordx4 a[216:219],v17,s[12:15],s45 offen sc1
MA 116,124,196
v_exp_f32 v32,v184
MA 112,124,192
CV 217,30,31
v_mfma_f32_16x16x32_bf16 v[240:243],v[36:39],v[208:211],v[224:227]
v_exp_f32 v33,v185
v_mfma_f32_16x16x32_bf16 v[244:247],v[36:39],v[212:215],v[228:231]
s_waitcnt lgkmcnt(7)
buffer_load_dwordx4 a[220:223],v27,s[12:15],s45 offen sc1
MV 128,64,128,44
s_waitcnt lgkmcnt(6)
v_exp_f32 v34,v186
MV 128,68,144,128
s_waitcnt lgkmcnt(5)
TR 96,8,24576
CV 218,32,33
MV 128,72,160,128
s_mov_b32 s36,24576
v_exp_f32 v35,v187
s_waitcnt lgkmcnt(5)
MV 128,76,176,128
s_add_u32 m0,s33,24576
TR 98,8,28672
v_mov_b32 v42,4
s_waitcnt lgkmcnt(2)
MV 144,92,176,44
buffer_load_dwordx4 v16,s[16:19],s36 offen offset:0 sc1 lds
v_exp_f32 v28,v172
MV 144,88,160,144
TR 100,9,24576
CV 219,34,35
MV 144,84,144,144
v_exp_f32 v29,v173
MV 144,80,128,144
TR 102,9,28672
MV 148,80,132,48
v_exp_f32 v30,v174
MV 148,84,148,148
TR 104,10,24576
CV 220,28,29
MV 148,88,164,148
v_exp_f32 v31,v175
MV 148,92,180,148
buffer_load_dwordx4 v16,s[16:19],s36 offen offset:1024 sc1 lds
MV 132,76,180,48
v_exp_f32 v32,v188
MV 132,72,164,132
TR 106,10,28672
CV 221,30,31
MV 132,68,148,132
v_exp_f32 v33,v189
MV 132,64,132,132
TR 108,11,24576
MV 136,64,136,52
v_exp_f32 v34,v190
MV 136,68,152,136
TR 110,11,28672
CV 222,32,33
MV 136,72,168,136
v_exp_f32 v35,v191
MV 136,76,184,136
s_mov_b32 s45,32768
TR 112,12,24576
MV 152,92,184,52
buffer_load_dwordx4 a[224:227],v17,s[12:15],s45 offen sc1
v_max_f32 v40,v240,v244
MV 152,88,168,152
TR 114,12,28672
CV 223,34,35
MV 152,84,152,152
TR 116,13,24576
MV 152,80,136,152
TR 118,13,28672
v_mfma_f32_16x16x32_bf16 v[248:251],v[36:39],v[216:219],v[232:235]
v_exp_f32 v28,v128
v_mfma_f32_16x16x32_bf16 v[252:255],v[36:39],v[220:223],v[236:239]
TR 120,14,24576
MV 156,80,140,56
v_exp_f32 v29,v129
MV 156,84,156,156
buffer_load_dwordx4 a[228:231],v27,s[12:15],s45 offen sc1
MV 156,88,172,156
v_exp_f32 v30,v130
MV 156,92,188,156
CV 192,28,29
v_max3_f32 v40,v40,v248,v252
MV 140,76,188,56
v_exp_f32 v31,v131
MV 140,72,172,140
buffer_store_dword v42,v63,s[88:91],0 offen offset:48 sc1
v_cmp_lt_f32 vcc,s40,v40
MV 140,68,156,140
s_cbranch_vccnz L_st_p59
L_bk_p59:
v_exp_f32 v32,v144
MV 140,64,140,140
s_waitcnt lgkmcnt(11)
TR 122,14,28672
CV 193,30,31
MA 0,96,208
v_exp_f32 v33,v145
MA 4,96,212
TR 124,15,24576
MA 8,96,216
v_exp_f32 v34,v146
MA 12,96,220
s_waitcnt lgkmcnt(11)
TR 126,15,28672
CV 194,32,33
MA 28,100,220
v_exp_f32 v35,v147
MA 24,100,216
RD 64,4,40960
MA 20,100,212
v_exp_f32 v28,v132
MA 16,100,208
s_mov_b32 s36,73728
RD 68,5,40960
CV 195,34,35
s_waitcnt lgkmcnt(12)
MA 32,104,208
s_add_u32 m0,s33,73728
v_exp_f32 v29,v133
MA 36,104,212
buffer_load_dwordx4 v16,s[16:19],s36 offen offset:0 sc1 lds
MA 40,104,216
v_exp_f32 v30,v134
MA 44,104,220
s_waitcnt lgkmcnt(10)
RD 72,6,40960
CV 196,28,29
MA 60,108,220
v_exp_f32 v31,v135
MA 56,108,216
RD 76,7,40960
MA 52,108,212
v_exp_f32 v32,v148
MA 48,108,208
s_waitcnt lgkmcnt(10)
RD 80,4,45056
CV 197,30,31
MA 64,112,208
v_exp_f32 v33,v149
MA 68,112,212
RD 84,5,45056
MA 72,112,216
v_exp_f32 v34,v150
MA 76,112,220
s_waitcnt lgkmcnt(10)
RD 88,6,45056
CV 198,32,33
MA 92,116,220
v_exp_f32 v35,v151
MA 88,116,216
RD 92,7,45056
MA 84,116,212
v_exp_f32 v28,v136
MA 80,116,208
s_waitcnt lgkmcnt(10)
buffer_load_dwordx4 v16,s[16:19],s36 offen offset:1024 sc1 lds
CV 199,34,35
MA 96,120,208
v_exp_f32 v29,v137
MA 100,120,212
MA 104,120,216
v_exp_f32 v30,v138
MA 108,120,220
s_waitcnt lgkmcnt(8)
CV 200,28,29
MA 124,124,220
s_mov_b32 s45,36864
v_exp_f32 v31,v139
MA 120,124,216
buffer_load_dwordx4 a[232:235],v17,s[12:15],s45 offen sc1
MA 116,124,212
v_exp_f32 v32,v152
MA 112,124,208
CV 201,30,31
v_mfma_f32_16x16x32_bf16 v[224:227],v[36:39],v[192:195],v[240:243]
v_exp_f32 v33,v153
v_mfma_f32_16x16x32_bf16 v[228:231],v[36:39],v[196:199],v[244:247]
s_waitcnt lgkmcnt(7)
buffer_load_dwordx4 a[236:239],v27,s[12:15],s45 offen sc1
MV 160,64,128,44
s_waitcnt vmcnt(37) lgkmcnt(0)
s_barrier
v_exp_f32 v34,v154
MV 160,68,144,160
TR 96,8,32768
CV 202,32,33
MV 160,72,160,160
s_mov_b32 s36,32768
v_exp_f32 v35,v155
MV 160,76,176,160
s_add_u32 m0,s33,32768
TR 98,8,36864
v_mov_b32 v42,5
MV 176,92,176,44
buffer_load_dwordx4 v16,s[16:19],s36 offen offset:0 sc1 lds
v_exp_f32 v28,v140
MV 176,88,160,176
TR 100,9,32768
CV 203,34,35
MV 176,84,144,176
v_exp_f32 v29,v141
MV 176,80,128,176
TR 102,9,36864
MV 180,80,132,48
v_exp_f32 v30,v142
MV 180,84,148,180
TR 104,10,32768
CV 204,28,29
MV 180,88,164,180
v_exp_f32 v31,v143
MV 180,92,180,180
buffer_load_dwordx4 v16,s[16:19],s36 offen offset:1024 sc1 lds
MV 164,76,180,48
v_exp_f32 v32,v156
MV 164,72,164,164
TR 106,10,36864
CV 205,30,31
MV 164,68,148,164
v_exp_f32 v33,v157
MV 164,64,132,164
TR 108,11,32768
MV 168,64,136,52
v_exp_f32 v34,v158
MV 168,68,152,168
TR 110,11,36864
CV 206,32,33
MV 168,72,168,168
v_exp_f32 v35,v159
MV 168,76,184,168
s_mov_b32 s45,40960
TR 112,12,32768
MV 184,92,184,52
buffer_load_dwordx4 a[240:243],v17,s[12:15],s45 offen sc1
v_max_f32 v40,v224,v228
MV 184,88,168,184
TR 114,12,36864
CV 207,34,35
MV 184,84,152,184
TR 116,13,32768
MV 184,80,136,184
TR 118,13,36864
v_mfma_f32_16x16x32_bf16 v[232:235],v[36:39],v[200:203],v[248:251]
v_exp_f32 v28,v160
v_mfma_f32_16x16x32_bf16 v[236:239],v[36:39],v[204:207],v[252:255]
TR 120,14,32768
MV 188,80,140,56
v_exp_f32 v29,v161
MV 188,84,156,188
buffer_load_dwordx4 a[244:247],v27,s[12:15],s45 offen sc1
MV 188,88,172,188
v_exp_f32 v30,v162
MV 188,92,188,188
CV 208,28,29
v_max3_f32 v40,v40,v232,v236
MV 172,76,188,56
v_exp_f32 v31,v163
MV 172,72,172,172
buffer_store_dword v42,v63,s[88:91],0 offen offset:48 sc1
v_cmp_lt_f32 vcc,s40,v40
MV 172,68,156,172
s_cbranch_vccnz L_st_p60
L_bk_p60:
v_exp_f32 v32,v176
MV 172,64,140,172
s_waitcnt lgkmcnt(11)
TR 122,14,36864
CV 209,30,31
MA 0,96,192
v_exp_f32 v33,v177
MA 4,96,196
TR 124,15,32768
MA 8,96,200
v_exp_f32 v34,v178
MA 12,96,204
s_waitcnt lgkmcnt(11)
TR 126,15,36864
CV 210,32,33
MA 28,100,204
v_exp_f32 v35,v179
MA 24,100,200
RD 64,4,49152
MA 20,100,196
v_exp_f32 v28,v164
MA 16,100,192
s_mov_b32 s36,81920
RD 68,5,49152
CV 211,34,35
s_waitcnt lgkmcnt(12)
MA 32,104,192
s_add_u32 m0,s33,81920
v_exp_f32 v29,v165
MA 36,104,196
buffer_load_dwordx4 v16,s[16:19],s36 offen offset:0 sc1 lds
MA 40,104,200
v_exp_f32 v30,v166
MA 44,104,204
s_waitcnt lgkmcnt(10)
RD 72,6,49152
CV 212,28,29
MA 60,108,204
v_exp_f32 v31,v167
MA 56,108,200
RD 76,7,49152
MA 52,108,196
v_exp_f32 v32,v180
MA 48,108,192
s_waitcnt lgkmcnt(10)
RD 80,4,53248
CV 213,30,31
MA 64,112,192
v_exp_f32 v33,v181
MA 68,112,196
RD 84,5,53248
MA 72,112,200
v_exp_f32 v34,v182
MA 76,112,204
s_waitcnt lgkmcnt(10)
RD 88,6,53248
CV 214,32,33
MA 92,116,204
v_exp_f32 v35,v183
MA 88,116,200
RD 92,7,53248
MA 84,116,196
v_exp_f32 v28,v168
MA 80,116,192
s_waitcnt lgkmcnt(10)
buffer_load_dwordx4 v16,s[16:19],s36 offen offset:1024 sc1 lds
CV 215,34,35
MA 96,120,192
v_exp_f32 v29,v169
MA 100,120,196
MA 104,120,200
v_exp_f32 v30,v170
MA 108,120,204
s_waitcnt lgkmcnt(8)
CV 216,28,29
MA 124,124,204
s_mov_b32 s45,45056
v_exp_f32 v31,v171
MA 120,124,200
buffer_load_dwordx4 a[248:251],v17,s[12:15],s45 offen sc1
MA 116,124,196
v_exp_f32 v32,v184
MA 112,124,192
CV 217,30,31
v_mfma_f32_16x16x32_bf16 v[240:243],v[36:39],v[208:211],v[224:227]
v_exp_f32 v33,v185
v_mfma_f32_16x16x32_bf16 v[244:247],v[36:39],v[212:215],v[228:231]
s_waitcnt lgkmcnt(7)
buffer_load_dwordx4 a[252:255],v27,s[12:15],s45 offen sc1
MV 128,64,128,44
s_waitcnt lgkmcnt(6)
v_exp_f32 v34,v186
MV 128,68,144,128
s_waitcnt lgkmcnt(5)
TR 96,8,40960
CV 218,32,33
MV 128,72,160,128
s_waitcnt lgkmcnt(5)
v_exp_f32 v35,v187
MV 128,76,176,128
s_waitcnt lgkmcnt(1)
TR 98,8,45056
v_mov_b32 v42,6
MV 144,92,176,44
v_exp_f32 v28,v172
MV 144,88,160,144
TR 100,9,40960
CV 219,34,35
MV 144,84,144,144
v_exp_f32 v29,v173
MV 144,80,128,144
TR 102,9,45056
MV 148,80,132,48
v_exp_f32 v30,v174
MV 148,84,148,148
s_mov_b32 s36,40960
TR 104,10,40960
CV 220,28,29
MV 148,88,164,148
s_add_u32 m0,s33,40960
v_exp_f32 v31,v175
MV 148,92,180,148
buffer_load_dwordx4 v16,s[16:19],s36 offen offset:0 sc1 lds
MV 132,76,180,48
v_exp_f32 v32,v188
MV 132,72,164,132
TR 106,10,45056
CV 221,30,31
MV 132,68,148,132
v_exp_f32 v33,v189
MV 132,64,132,132
TR 108,11,40960
MV 136,64,136,52
v_exp_f32 v34,v190
MV 136,68,152,136
TR 110,11,45056
CV 222,32,33
MV 136,72,168,136
v_exp_f32 v35,v191
MV 136,76,184,136
TR 112,12,40960
MV 152,92,184,52
v_max_f32 v40,v240,v244
MV 152,88,168,152
TR 114,12,45056
CV 223,34,35
MV 152,84,152,152
TR 116,13,40960
MV 152,80,136,152
TR 118,13,45056
v_mfma_f32_16x16x32_bf16 v[248:251],v[36:39],v[216:219],v[232:235]
v_exp_f32 v28,v128
v_mfma_f32_16x16x32_bf16 v[252:255],v[36:39],v[220:223],v[236:239]
TR 120,14,40960
MV 156,80,140,56
v_exp_f32 v29,v129
MV 156,84,156,156
buffer_load_dwordx4 v16,s[16:19],s36 offen offset:1024 sc1 lds
MV 156,88,172,156
v_exp_f32 v30,v130
MV 156,92,188,156
CV 192,28,29
v_max3_f32 v40,v40,v248,v252
MV 140,76,188,56
v_exp_f32 v31,v131
MV 140,72,172,140
buffer_store_dword v42,v63,s[88:91],0 offen offset:48 sc1
v_cmp_lt_f32 vcc,s40,v40
MV 140,68,156,140
s_cbranch_vccnz L_st_p61
L_bk_p61:
v_exp_f32 v32,v144
MV 140,64,140,140
s_waitcnt lgkmcnt(11)
TR 122,14,45056
CV 193,30,31
MA 0,96,208
v_exp_f32 v33,v145
MA 4,96,212
TR 124,15,40960
s_waitcnt vmcnt(48)
v_mad_u32_u24 v43,v43,5,2
MA 8,96,216
v_exp_f32 v34,v146
MA 12,96,220
s_waitcnt lgkmcnt(11)
TR 126,15,45056
CV 194,32,33
MA 28,100,220
v_exp_f32 v35,v147
MA 24,100,216
RD 64,4,57344
v_lshrrev_b32 v43,3,v43
MA 20,100,212
v_exp_f32 v28,v132
MA 16,100,208
s_mov_b32 s36,90112
RD 68,5,57344
CV 195,34,35
s_waitcnt lgkmcnt(12)
MA 32,104,208
s_add_u32 m0,s33,90112
v_exp_f32 v29,v133
MA 36,104,212
buffer_load_dwordx4 v16,s[16:19],s36 offen offset:0 sc1 lds
MA 40,104,216
v_exp_f32 v30,v134
MA 44,104,220
s_waitcnt lgkmcnt(10)
RD 72,6,57344
CV 196,28,29
MA 60,108,220
v_exp_f32 v31,v135
MA 56,108,216
RD 76,7,57344
v_min_u32 v43,4,v43
MA 52,108,212
v_exp_f32 v32,v148
MA 48,108,208
s_waitcnt lgkmcnt(10)
RD 80,4,61440
CV 197,30,31
MA 64,112,208
v_exp_f32 v33,v149
MA 68,112,212
RD 84,5,61440
v_add_u32 v42,1,v43
MA 72,112,216
v_exp_f32 v34,v150
MA 76,112,220
s_waitcnt lgkmcnt(10)
RD 88,6,61440
CV 198,32,33
MA 92,116,220
v_exp_f32 v35,v151
MA 88,116,216
RD 92,7,61440
v_lshlrev_b32 v62,2,v1
MA 84,116,212
v_exp_f32 v28,v136
MA 80,116,208
s_waitcnt lgkmcnt(10)
CV 199,34,35
v_add_u32 v62,163824,v62
MA 96,120,208
v_exp_f32 v29,v137
MA 100,120,212
buffer_load_dwordx4 v16,s[16:19],s36 offen offset:1024 sc1 lds
MA 104,120,216
v_exp_f32 v30,v138
MA 108,120,220
s_waitcnt lgkmcnt(8)
ds_write_b32 v62,v43
CV 200,28,29
MA 124,124,220
v_exp_f32 v31,v139
MA 120,124,216
buffer_store_dword v42,v63,s[88:91],0 offen offset:64 sc1
MA 116,124,212
v_exp_f32 v32,v152
MA 112,124,208
CV 201,30,31
v_mfma_f32_16x16x32_bf16 v[224:227],v[36:39],v[192:195],v[240:243]
v_exp_f32 v33,v153
v_mfma_f32_16x16x32_bf16 v[228:231],v[36:39],v[196:199],v[244:247]
s_waitcnt lgkmcnt(8)
MV 160,64,128,44
s_waitcnt vmcnt(40) lgkmcnt(0)
s_barrier
v_exp_f32 v34,v154
MV 160,68,144,160
TR 96,8,49152
CV 202,32,33
MV 160,72,160,160
s_mov_b32 s36,49152
v_exp_f32 v35,v155
MV 160,76,176,160
s_add_u32 m0,s33,49152
TR 98,8,53248
v_mov_b32 v42,7
MV 176,92,176,44
buffer_load_dwordx4 v16,s[16:19],s36 offen offset:0 sc1 lds
v_exp_f32 v28,v140
MV 176,88,160,176
TR 100,9,49152
CV 203,34,35
MV 176,84,144,176
v_exp_f32 v29,v141
MV 176,80,128,176
TR 102,9,53248
MV 180,80,132,48
v_exp_f32 v30,v142
MV 180,84,148,180
TR 104,10,49152
CV 204,28,29
MV 180,88,164,180
v_exp_f32 v31,v143
MV 180,92,180,180
buffer_load_dwordx4 v16,s[16:19],s36 offen offset:1024 sc1 lds
MV 164,76,180,48
v_exp_f32 v32,v156
MV 164,72,164,164
TR 106,10,53248
CV 205,30,31
MV 164,68,148,164
v_exp_f32 v33,v157
MV 164,64,132,164
TR 108,11,49152
MV 168,64,136,52
v_exp_f32 v34,v158
MV 168,68,152,168
TR 110,11,53248
CV 206,32,33
MV 168,72,168,168
s_mov_b32 s36,57344
v_exp_f32 v35,v159
MV 168,76,184,168
s_add_u32 m0,s33,57344
TR 112,12,49152
MV 184,92,184,52
buffer_load_dwordx4 v16,s[16:19],s36 offen offset:0 sc1 lds
v_max_f32 v40,v224,v228
MV 184,88,168,184
TR 114,12,53248
CV 207,34,35
MV 184,84,152,184
TR 116,13,49152
MV 184,80,136,184
TR 118,13,53248
v_mfma_f32_16x16x32_bf16 v[232:235],v[36:39],v[200:203],v[248:251]
v_exp_f32 v28,v160
v_mfma_f32_16x16x32_bf16 v[236:239],v[36:39],v[204:207],v[252:255]
TR 120,14,49152
MV 188,80,140,56
v_exp_f32 v29,v161
MV 188,84,156,188
buffer_load_dwordx4 v16,s[16:19],s36 offen offset:1024 sc1 lds
MV 188,88,172,188
v_exp_f32 v30,v162
MV 188,92,188,188
CV 208,28,29
v_max3_f32 v40,v40,v232,v236
MV 172,76,188,56
v_exp_f32 v31,v163
MV 172,72,172,172
buffer_store_dword v42,v63,s[88:91],0 offen offset:48 sc1
v_cmp_lt_f32 vcc,s40,v40
MV 172,68,156,172
s_cbranch_vccnz L_st_p62
L_bk_p62:
v_exp_f32 v32,v176
MV 172,64,140,172
s_waitcnt lgkmcnt(11)
TR 122,14,53248
CV 209,30,31
MA 0,96,192
v_exp_f32 v33,v177
MA 4,96,196
TR 124,15,49152
MA 8,96,200
v_exp_f32 v34,v178
MA 12,96,204
s_mov_b32 s36,98304
TR 126,15,53248
CV 210,32,33
s_waitcnt lgkmcnt(12)
MA 28,100,204
s_add_u32 m0,s33,98304
v_exp_f32 v35,v179
MA 24,100,200
buffer_load_dwordx4 v16,s[16:19],s36 offen offset:0 sc1 lds
MA 20,100,196
v_exp_f32 v28,v164
MA 16,100,192
s_waitcnt lgkmcnt(10)
CV 211,34,35
MA 32,104,192
v_exp_f32 v29,v165
MA 36,104,196
buffer_load_dwordx4 v16,s[16:19],s36 offen offset:1024 sc1 lds
MA 40,104,200
v_exp_f32 v30,v166
MA 44,104,204
s_mov_b32 s36,106496
CV 212,28,29
s_waitcnt lgkmcnt(8)
MA 60,108,204
s_add_u32 m0,s33,106496
v_exp_f32 v31,v167
MA 56,108,200
buffer_load_dwordx4 v16,s[16:19],s36 offen offset:0 sc1 lds
MA 52,108,196
v_exp_f32 v32,v180
MA 48,108,192
s_waitcnt lgkmcnt(6)
CV 213,30,31
MA 64,112,192
v_exp_f32 v33,v181
MA 68,112,196
buffer_load_dwordx4 v16,s[16:19],s36 offen offset:1024 sc1 lds
MA 72,112,200
v_exp_f32 v34,v182
MA 76,112,204
s_waitcnt lgkmcnt(4)
CV 214,32,33
MA 92,116,204
s_mov_b32 s45,65536
v_exp_f32 v35,v183
MA 88,116,200
buffer_load_dwordx4 a[128:131],v17,s[12:15],s45 offen sc1
MA 84,116,196
v_exp_f32 v28,v168
MA 80,116,192
s_waitcnt lgkmcnt(2)
CV 215,34,35
MA 96,120,192
v_exp_f32 v29,v169
MA 100,120,196
buffer_load_dwordx4 a[132:135],v27,s[12:15],s45 offen sc1
MA 104,120,200
v_exp_f32 v30,v170
MA 108,120,204
s_waitcnt lgkmcnt(0)
CV 216,28,29
MA 124,124,204
s_mov_b32 s45,69632
v_exp_f32 v31,v171
MA 120,124,200
buffer_load_dwordx4 a[136:139],v17,s[12:15],s45 offen sc1
MA 116,124,196
v_exp_f32 v32,v184
MA 112,124,192
CV 217,30,31
v_mfma_f32_16x16x32_bf16 v[240:243],v[36:39],v[208:211],v[224:227]
v_exp_f32 v33,v185
v_mfma_f32_16x16x32_bf16 v[244:247],v[36:39],v[212:215],v[228:231]
buffer_load_dwordx4 a[140:143],v27,s[12:15],s45 offen sc1
TR 96,8,57344
TR 98,8,61440
TR 100,9,57344
TR 102,9,61440
TR 104,10,57344
TR 106,10,61440
TR 108,11,57344
TR 110,11,61440
TR 112,12,57344
TR 114,12,61440
TR 116,13,57344
TR 118,13,61440
TR 120,14,57344
TR 122,14,61440
TR 124,15,57344
TR 126,15,61440
v_exp_f32 v34,v186
CV 218,32,33
s_mov_b32 s45,73728
v_exp_f32 v35,v187
v_exp_f32 v28,v172
buffer_load_dwordx4 a[144:147],v17,s[12:15],s45 offen sc1
CV 219,34,35
v_exp_f32 v29,v173
buffer_load_dwordx4 a[148:151],v27,s[12:15],s45 offen sc1
v_exp_f32 v30,v174
CV 220,28,29
s_mov_b32 s45,77824
v_exp_f32 v31,v175
v_exp_f32 v32,v188
buffer_load_dwordx4 a[152:155],v17,s[12:15],s45 offen sc1
CV 221,30,31
v_exp_f32 v33,v189
buffer_load_dwordx4 a[156:159],v27,s[12:15],s45 offen sc1
v_exp_f32 v34,v190
CV 222,32,33
s_mov_b32 s45,98304
v_exp_f32 v35,v191
s_nop 0
CV 223,34,35
buffer_load_dwordx4 a[160:163],v17,s[12:15],s45 offen sc1
v_mfma_f32_16x16x32_bf16 v[248:251],v[36:39],v[216:219],v[232:235]
v_mfma_f32_16x16x32_bf16 v[252:255],v[36:39],v[220:223],v[236:239]
buffer_load_dwordx4 a[164:167],v27,s[12:15],s45 offen sc1
v_mov_b32 v4,v60
v_add_u32 v5,0x10000,v60
v_add_u32 v6,0x20000,v60
s_mul_i32 s41,s32,9216
v_mov_b32 v42,163824
v_max_f32 v40,v240,v244
s_nop 0
v_max3_f32 v40,v40,v248,v252
v_cmp_lt_f32 vcc,s40,v40
s_nop 0
s_cbranch_vccnz L_st_fin31
L_bk_fin31:
s_waitcnt lgkmcnt(14)
MA 0,96,208
s_waitcnt vmcnt(32) lgkmcnt(0)
s_barrier
v_rcp_f32 v20,v240
MA 4,96,212
s_mov_b32 s36,114688
RD 128,4,0
v_rcp_f32 v22,v244
MA 8,96,216
s_add_u32 m0,s33,114688
ds_read_b32 v43,v42
v_rcp_f32 v24,v248
MA 12,96,220
buffer_load_dwordx4 v16,s[16:19],s36 offen offset:0 sc1 lds
MA 16,100,208
RD 132,4,9216
v_rcp_f32 v26,v252
MA 20,100,212
MA 24,100,216
buffer_load_dwordx4 v16,s[16:19],s36 offen offset:1024 sc1 lds
MA 28,100,220
RD 136,4,18432
MA 32,104,208
v_accvgpr_read_b32 v232,a0
v_accvgpr_read_b32 v233,a1
v_accvgpr_read_b32 v234,a2
MA 36,104,212
s_mov_b32 s36,122880
RD 140,4,27648
v_accvgpr_read_b32 v235,a3
v_accvgpr_read_b32 v236,a16
MA 40,104,216
s_add_u32 m0,s33,122880
v_accvgpr_read_b32 v237,a17
v_accvgpr_read_b32 v238,a18
v_accvgpr_read_b32 v239,a19
MA 44,104,220
buffer_load_dwordx4 v16,s[16:19],s36 offen offset:0 sc1 lds
MA 48,108,208
v_mul_f32 v232,v20,v232
v_mul_f32 v233,v20,v233
v_mul_f32 v234,v20,v234
MA 52,108,212
RD 144,4,1024
v_mul_f32 v235,v20,v235
v_mul_f32 v236,v20,v236
MA 56,108,216
v_mul_f32 v237,v20,v237
v_mul_f32 v238,v20,v238
v_mul_f32 v239,v20,v239
MA 60,108,220
buffer_load_dwordx4 v16,s[16:19],s36 offen offset:1024 sc1 lds
MA 64,112,208
RD 148,4,10240
CV 240,232,233
CV 241,234,235
MA 68,112,212
CV 242,236,237
CV 243,238,239
v_accvgpr_read_b32 v244,a4
MA 72,112,216
RD 152,4,19456
v_accvgpr_read_b32 v245,a5
v_accvgpr_read_b32 v246,a6
MA 76,112,220
s_mov_b32 s45,102400
v_accvgpr_read_b32 v247,a7
v_accvgpr_read_b32 v248,a20
v_accvgpr_read_b32 v249,a21
MA 80,116,208
buffer_load_dwordx4 a[168:171],v17,s[12:15],s45 offen sc1
MA 84,116,212
RD 156,4,28672
v_accvgpr_read_b32 v250,a22
v_accvgpr_read_b32 v251,a23
MA 88,116,216
buffer_store_dwordx4 v[240:243],v60,s[20:23],s96 offen offset:0 sc1
MA 92,116,220
buffer_load_dwordx4 a[172:175],v27,s[12:15],s45 offen sc1
MA 96,120,208
RD 160,4,2048
v_mul_f32 v244,v22,v244
v_mul_f32 v245,v22,v245
MA 100,120,212
v_mul_f32 v246,v22,v246
v_mul_f32 v247,v22,v247
v_mul_f32 v248,v22,v248
MA 104,120,216
s_mov_b32 s45,106496
RD 164,4,11264
v_mul_f32 v249,v22,v249
v_mul_f32 v250,v22,v250
MA 108,120,220
buffer_load_dwordx4 a[176:179],v17,s[12:15],s45 offen sc1
MA 112,124,208
v_mul_f32 v251,v22,v251
CV 252,244,245
CV 253,246,247
MA 116,124,212
CV 254,248,249
CV 255,250,251
v_accvgpr_read_b32 v232,a8
MA 120,124,216
RD 168,4,20480
v_accvgpr_read_b32 v233,a9
v_accvgpr_read_b32 v234,a10
MA 124,124,220
buffer_load_dwordx4 a[180:183],v27,s[12:15],s45 offen sc1
RD 172,4,29696
v_accvgpr_read_b32 v235,a11
v_accvgpr_read_b32 v236,a24
v_accvgpr_read_b32 v237,a25
v_accvgpr_read_b32 v238,a26
v_accvgpr_read_b32 v239,a27
s_waitcnt lgkmcnt(12)
v_mfma_f32_16x16x32_bf16 v[64:67],v[128:131],a[192:195],0
s_waitcnt lgkmcnt(10)
RD 176,4,3072
buffer_store_dwordx4 v[252:255],v60,s[20:23],s96 offen offset:1024 sc1
v_mul_f32 v232,v24,v232
v_mul_f32 v233,v24,v233
MV 64,132,200,64
s_waitcnt lgkmcnt(10)
RD 180,4,12288
v_mul_f32 v234,v24,v234
v_mul_f32 v235,v24,v235
v_mul_f32 v236,v24,v236
MV 64,136,208,64
s_waitcnt lgkmcnt(10)
RD 184,4,21504
v_mul_f32 v237,v24,v237
v_mul_f32 v238,v24,v238
v_mul_f32 v239,v24,v239
MV 64,140,216,64
RD 188,4,30720
CV 240,232,233
CV 241,234,235
CV 242,236,237
v_mfma_f32_16x16x32_bf16 v[68:71],v[140:143],a[220:223],0
CV 243,238,239
v_accvgpr_read_b32 v244,a12
v_accvgpr_read_b32 v245,a13
v_accvgpr_read_b32 v246,a14
MV 68,136,212,68
v_accvgpr_read_b32 v247,a15
v_accvgpr_read_b32 v248,a28
v_accvgpr_read_b32 v249,a29
v_accvgpr_read_b32 v250,a30
MV 68,132,204,68
v_accvgpr_read_b32 v251,a31
MV 68,128,196,68
s_waitcnt lgkmcnt(11)
buffer_store_dwordx4 v[240:243],v60,s[20:23],s96 offen offset:2048 sc1
v_mul_f32 v244,v26,v244
v_mul_f32 v245,v26,v245
v_mul_f32 v246,v26,v246
v_mfma_f32_16x16x32_bf16 v[76:79],v[144:147],a[196:199],0
s_waitcnt lgkmcnt(10)
RD 128,4,4096
v_mul_f32 v247,v26,v247
v_mul_f32 v248,v26,v248
v_mul_f32 v249,v26,v249
MV 76,148,204,76
s_waitcnt lgkmcnt(10)
RD 132,4,13312
v_mul_f32 v250,v26,v250
v_mul_f32 v251,v26,v251
CV 252,244,245
MV 76,152,212,76
s_waitcnt lgkmcnt(10)
RD 136,4,22528
CV 253,246,247
CV 254,248,249
CV 255,250,251
MV 76,156,220,76
RD 140,4,31744
v_accvgpr_read_b32 v232,a32
v_accvgpr_read_b32 v233,a33
v_accvgpr_read_b32 v234,a34
v_mfma_f32_16x16x32_bf16 v[72:75],v[156:159],a[216:219],0
v_accvgpr_read_b32 v235,a35
v_accvgpr_read_b32 v236,a48
v_accvgpr_read_b32 v237,a49
v_accvgpr_read_b32 v238,a50
MV 72,152,208,72
v_accvgpr_read_b32 v239,a51
MV 72,148,200,72
buffer_store_dwordx4 v[252:255],v60,s[20:23],s96 offen offset:3072 sc1
s_add_u32 s96,s96,4096
v_mul_f32 v232,v20,v232
v_mul_f32 v233,v20,v233
v_mul_f32 v234,v20,v234
MV 72,144,192,72
s_waitcnt lgkmcnt(11)
v_mul_f32 v235,v20,v235
v_mul_f32 v236,v20,v236
v_mul_f32 v237,v20,v237
v_mul_f32 v238,v20,v238
v_mfma_f32_16x16x32_bf16 v[80:83],v[160:163],a[192:195],0
s_waitcnt lgkmcnt(10)
RD 144,4,5120
v_mul_f32 v239,v20,v239
CV 240,232,233
CV 241,234,235
MV 80,164,200,80
s_waitcnt lgkmcnt(10)
RD 148,4,14336
CV 242,236,237
CV 243,238,239
v_accvgpr_read_b32 v244,a36
MV 80,168,208,80
s_waitcnt lgkmcnt(10)
RD 152,4,23552
v_accvgpr_read_b32 v245,a37
v_accvgpr_read_b32 v246,a38
v_accvgpr_read_b32 v247,a39
MV 80,172,216,80
RD 156,4,32768
v_accvgpr_read_b32 v248,a52
v_accvgpr_read_b32 v249,a53
v_accvgpr_read_b32 v250,a54
v_mfma_f32_16x16x32_bf16 v[84:87],v[172:175],a[220:223],0
v_accvgpr_read_b32 v251,a55
MV 84,168,212,84
buffer_store_dwordx4 v[240:243],v60,s[20:23],s96 offen offset:0 sc1
v_mul_f32 v244,v22,v244
v_mul_f32 v245,v22,v245
v_mul_f32 v246,v22,v246
MV 84,164,204,84
v_mul_f32 v247,v22,v247
v_mul_f32 v248,v22,v248
v_mul_f32 v249,v22,v249
v_mul_f32 v250,v22,v250
MV 84,160,196,84
s_waitcnt lgkmcnt(11)
v_mul_f32 v251,v22,v251
CV 252,244,245
CV 253,246,247
CV 254,248,249
v_mfma_f32_16x16x32_bf16 v[92:95],v[176:179],a[196:199],0
s_waitcnt lgkmcnt(10)
RD 160,4,6144
CV 255,250,251
v_accvgpr_read_b32 v232,a40
v_accvgpr_read_b32 v233,a41
MV 92,180,204,92
s_waitcnt lgkmcnt(10)
RD 164,4,15360
v_accvgpr_read_b32 v234,a42
v_accvgpr_read_b32 v235,a43
v_accvgpr_read_b32 v236,a56
MV 92,184,212,92
s_waitcnt lgkmcnt(10)
RD 168,4,24576
v_accvgpr_read_b32 v237,a57
v_accvgpr_read_b32 v238,a58
v_accvgpr_read_b32 v239,a59
MV 92,188,220,92
RD 172,4,33792
buffer_store_dwordx4 v[252:255],v60,s[20:23],s96 offen offset:1024 sc1
v_mul_f32 v232,v24,v232
v_mul_f32 v233,v24,v233
v_mfma_f32_16x16x32_bf16 v[88:91],v[188:191],a[216:219],0
v_mul_f32 v234,v24,v234
v_mul_f32 v235,v24,v235
v_mul_f32 v236,v24,v236
v_mul_f32 v237,v24,v237
MV 88,184,208,88
v_mul_f32 v238,v24,v238
v_mul_f32 v239,v24,v239
CV 240,232,233
CV 241,234,235
MV 88,180,200,88
CV 242,236,237
CV 243,238,239
v_accvgpr_read_b32 v244,a44
v_accvgpr_read_b32 v245,a45
MV 88,176,192,88
s_waitcnt lgkmcnt(11)
v_accvgpr_read_b32 v246,a46
v_accvgpr_read_b32 v247,a47
v_accvgpr_read_b32 v248,a60
v_accvgpr_read_b32 v249,a61
v_mfma_f32_16x16x32_bf16 v[96:99],v[128:131],a[192:195],0
s_waitcnt lgkmcnt(10)
RD 176,4,7168
v_accvgpr_read_b32 v250,a62
v_accvgpr_read_b32 v251,a63
MV 96,132,200,96
s_waitcnt lgkmcnt(10)
RD 180,4,16384
buffer_store_dwordx4 v[240:243],v60,s[20:23],s96 offen offset:2048 sc1
v_mul_f32 v244,v26,v244
v_mul_f32 v245,v26,v245
MV 96,136,208,96
s_waitcnt lgkmcnt(10)
RD 184,4,25600
v_mul_f32 v246,v26,v246
v_mul_f32 v247,v26,v247
v_mul_f32 v248,v26,v248
MV 96,140,216,96
RD 188,4,34816
v_mul_f32 v249,v26,v249
v_mul_f32 v250,v26,v250
v_mul_f32 v251,v26,v251
v_mfma_f32_16x16x32_bf16 v[100:103],v[140:143],a[220:223],0
CV 252,244,245
CV 253,246,247
CV 254,248,249
CV 255,250,251
MV 100,136,212,100
v_accvgpr_read_b32 v232,a64
v_accvgpr_read_b32 v233,a65
v_accvgpr_read_b32 v234,a66
v_accvgpr_read_b32 v235,a67
MV 100,132,204,100
v_accvgpr_read_b32 v236,a80
v_accvgpr_read_b32 v237,a81
v_accvgpr_read_b32 v238,a82
v_accvgpr_read_b32 v239,a83
MV 100,128,196,100
s_waitcnt lgkmcnt(11)
buffer_store_dwordx4 v[252:255],v60,s[20:23],s96 offen offset:3072 sc1
s_add_u32 s96,s96,4096
v_mul_f32 v232,v20,v232
v_mul_f32 v233,v20,v233
v_mul_f32 v234,v20,v234
v_mfma_f32_16x16x32_bf16 v[108:111],v[144:147],a[196:199],0
s_waitcnt lgkmcnt(10)
RD 128,4,8192
v_mul_f32 v235,v20,v235
v_mul_f32 v236,v20,v236
v_mul_f32 v237,v20,v237
MV 108,148,204,108
s_waitcnt lgkmcnt(10)
RD 132,4,17408
v_mul_f32 v238,v20,v238
v_mul_f32 v239,v20,v239
CV 240,232,233
MV 108,152,212,108
s_waitcnt lgkmcnt(10)
RD 136,4,26624
CV 241,234,235
CV 242,236,237
CV 243,238,239
MV 108,156,220,108
RD 140,4,35840
v_accvgpr_read_b32 v244,a68
v_accvgpr_read_b32 v245,a69
v_accvgpr_read_b32 v246,a70
v_mfma_f32_16x16x32_bf16 v[104:107],v[156:159],a[216:219],0
v_accvgpr_read_b32 v247,a71
v_accvgpr_read_b32 v248,a84
v_accvgpr_read_b32 v249,a85
v_accvgpr_read_b32 v250,a86
MV 104,152,208,104
v_accvgpr_read_b32 v251,a87
MV 104,148,200,104
buffer_store_dwordx4 v[240:243],v60,s[20:23],s96 offen offset:0 sc1
v_mul_f32 v244,v22,v244
v_mul_f32 v245,v22,v245
v_mul_f32 v246,v22,v246
MV 104,144,192,104
s_waitcnt lgkmcnt(11)
v_mul_f32 v247,v22,v247
v_mul_f32 v248,v22,v248
v_mul_f32 v249,v22,v249
v_mul_f32 v250,v22,v250
v_mfma_f32_16x16x32_bf16 v[112:115],v[160:163],a[192:195],0
s_waitcnt lgkmcnt(10)
v_mul_f32 v251,v22,v251
CV 252,244,245
CV 253,246,247
CV 254,248,249
MV 112,164,200,112
s_waitcnt lgkmcnt(9)
CV 255,250,251
v_accvgpr_read_b32 v232,a72
v_accvgpr_read_b32 v233,a73
v_accvgpr_read_b32 v234,a74
MV 112,168,208,112
s_waitcnt lgkmcnt(8)
v_accvgpr_read_b32 v235,a75
v_accvgpr_read_b32 v236,a88
v_accvgpr_read_b32 v237,a89
v_accvgpr_read_b32 v238,a90
MV 112,172,216,112
v_accvgpr_read_b32 v239,a91
v_mfma_f32_16x16x32_bf16 v[116:119],v[172:175],a[220:223],0
s_waitcnt vmcnt(32) lgkmcnt(0)
s_barrier
RD 144,4,36864
buffer_store_dwordx4 v[252:255],v60,s[20:23],s96 offen offset:1024 sc1
v_mul_f32 v232,v24,v232
v_mul_f32 v233,v24,v233
MV 116,168,212,116
RD 148,4,46080
v_mul_f32 v234,v24,v234
v_mul_f32 v235,v24,v235
v_mul_f32 v236,v24,v236
MV 116,164,204,116
RD 152,4,55296
v_mul_f32 v237,v24,v237
v_mul_f32 v238,v24,v238
v_mul_f32 v239,v24,v239
MV 116,160,196,116
RD 156,4,64512
CV 240,232,233
CV 241,234,235
CV 242,236,237
v_mfma_f32_16x16x32_bf16 v[124:127],v[176:179],a[196:199],0
RD 160,4,37888
CV 243,238,239
v_accvgpr_read_b32 v244,a76
v_accvgpr_read_b32 v245,a77
MV 124,180,204,124
RD 164,4,47104
v_accvgpr_read_b32 v246,a78
v_accvgpr_read_b32 v247,a79
v_accvgpr_read_b32 v248,a92
MV 124,184,212,124
RD 168,4,56320
v_accvgpr_read_b32 v249,a93
v_accvgpr_read_b32 v250,a94
v_accvgpr_read_b32 v251,a95
MV 124,188,220,124
RD 172,5,0
buffer_store_dwordx4 v[240:243],v60,s[20:23],s96 offen offset:2048 sc1
v_mul_f32 v244,v26,v244
v_mul_f32 v245,v26,v245
v_mfma_f32_16x16x32_bf16 v[120:123],v[188:191],a[216:219],0
v_mul_f32 v246,v26,v246
v_mul_f32 v247,v26,v247
v_mul_f32 v248,v26,v248
v_mul_f32 v249,v26,v249
MV 120,184,208,120
v_mul_f32 v250,v26,v250
v_mul_f32 v251,v26,v251
CV 252,244,245
CV 253,246,247
MV 120,180,200,120
CV 254,248,249
CV 255,250,251
v_accvgpr_read_b32 v232,a96
v_accvgpr_read_b32 v233,a97
MV 120,176,192,120
v_accvgpr_read_b32 v234,a98
v_accvgpr_read_b32 v235,a99
v_accvgpr_read_b32 v236,a112
v_accvgpr_read_b32 v237,a113
v_mfma_f32_16x16x32_bf16 v[200:203],v[128:131],a[192:195],0
RD 176,4,38912
v_accvgpr_read_b32 v238,a114
v_accvgpr_read_b32 v239,a115
MV 200,132,200,200
RD 180,4,48128
buffer_store_dwordx4 v[252:255],v60,s[20:23],s96 offen offset:3072 sc1
s_add_u32 s96,s96,4096
v_mul_f32 v232,v20,v232
v_mul_f32 v233,v20,v233
MV 200,136,208,200
RD 184,4,57344
v_mul_f32 v234,v20,v234
v_mul_f32 v235,v20,v235
v_mul_f32 v236,v20,v236
MV 200,140,216,200
RD 188,5,1024
v_mul_f32 v237,v20,v237
v_mul_f32 v238,v20,v238
v_mul_f32 v239,v20,v239
v_mfma_f32_16x16x32_bf16 v[204:207],v[140:143],a[220:223],0
CV 240,232,233
CV 241,234,235
CV 242,236,237
CV 243,238,239
MV 204,136,212,204
v_accvgpr_read_b32 v244,a100
v_accvgpr_read_b32 v245,a101
v_accvgpr_read_b32 v246,a102
v_accvgpr_read_b32 v247,a103
MV 204,132,204,204
v_accvgpr_read_b32 v248,a116
v_accvgpr_read_b32 v249,a117
v_accvgpr_read_b32 v250,a118
v_accvgpr_read_b32 v251,a119
MV 204,128,196,204
s_waitcnt lgkmcnt(11)
buffer_store_dwordx4 v[240:243],v60,s[20:23],s96 offen offset:0 sc1
v_mul_f32 v244,v22,v244
v_mul_f32 v245,v22,v245
v_mul_f32 v246,v22,v246
MV 64,144,224,64
s_waitcnt lgkmcnt(10)
RD 128,4,39936
v_mul_f32 v247,v22,v247
v_mul_f32 v248,v22,v248
v_mul_f32 v249,v22,v249
MV 64,148,232,64
s_waitcnt lgkmcnt(10)
RD 132,4,49152
v_mul_f32 v250,v22,v250
v_mul_f32 v251,v22,v251
CV 252,244,245
MV 64,152,240,64
s_waitcnt lgkmcnt(10)
RD 136,4,58368
CV 253,246,247
CV 254,248,249
CV 255,250,251
MV 64,156,248,64
RD 140,5,2048
v_accvgpr_read_b32 v232,a104
v_accvgpr_read_b32 v233,a105
v_accvgpr_read_b32 v234,a106
MV 68,156,252,68
v_accvgpr_read_b32 v235,a107
v_accvgpr_read_b32 v236,a120
v_accvgpr_read_b32 v237,a121
v_accvgpr_read_b32 v238,a122
MV 68,152,244,68
v_accvgpr_read_b32 v239,a123
MV 68,148,236,68
buffer_store_dwordx4 v[252:255],v60,s[20:23],s96 offen offset:1024 sc1
v_mul_f32 v232,v24,v232
v_mul_f32 v233,v24,v233
v_mul_f32 v234,v24,v234
MV 68,144,228,68
s_waitcnt lgkmcnt(11)
v_mul_f32 v235,v24,v235
v_mul_f32 v236,v24,v236
v_mul_f32 v237,v24,v237
v_mul_f32 v238,v24,v238
MV 76,160,228,76
s_waitcnt lgkmcnt(10)
RD 144,4,40960
v_mul_f32 v239,v24,v239
CV 240,232,233
CV 241,234,235
MV 76,164,236,76
s_waitcnt lgkmcnt(10)
RD 148,4,50176
CV 242,236,237
CV 243,238,239
v_accvgpr_read_b32 v244,a108
MV 76,168,244,76
s_waitcnt lgkmcnt(10)
RD 152,4,59392
v_accvgpr_read_b32 v245,a109
v_accvgpr_read_b32 v246,a110
v_accvgpr_read_b32 v247,a111
MV 76,172,252,76
RD 156,5,3072
v_accvgpr_read_b32 v248,a124
v_accvgpr_read_b32 v249,a125
v_accvgpr_read_b32 v250,a126
MV 72,172,248,72
v_accvgpr_read_b32 v251,a127
MV 72,168,240,72
buffer_store_dwordx4 v[240:243],v60,s[20:23],s96 offen offset:2048 sc1
v_mul_f32 v244,v26,v244
v_mul_f32 v245,v26,v245
v_mul_f32 v246,v26,v246
MV 72,164,232,72
v_mul_f32 v247,v26,v247
v_mul_f32 v248,v26,v248
v_mul_f32 v249,v26,v249
v_mul_f32 v250,v26,v250
MV 72,160,224,72
s_waitcnt lgkmcnt(11)
v_mul_f32 v251,v26,v251
CV 252,244,245
CV 253,246,247
CV 254,248,249
MV 80,176,224,80
s_waitcnt lgkmcnt(10)
RD 160,4,41984
CV 255,250,251
MV 80,180,232,80
s_waitcnt lgkmcnt(10)
RD 164,4,51200
buffer_store_dwordx4 v[252:255],v60,s[20:23],s96 offen offset:3072 sc1
s_add_u32 s96,s96,4096
MV 80,184,240,80
s_waitcnt lgkmcnt(10)
RD 168,4,60416
MV 80,188,248,80
RD 172,5,4096
MV 84,188,252,84
MV 84,184,244,84
MV 84,180,236,84
MV 84,176,228,84
s_waitcnt lgkmcnt(11)
MV 92,128,228,92
s_waitcnt lgkmcnt(10)
RD 176,4,43008
MV 92,132,236,92
s_waitcnt lgkmcnt(10)
RD 180,4,52224
MV 92,136,244,92
s_waitcnt lgkmcnt(10)
RD 184,4,61440
MV 92,140,252,92
RD 188,5,5120
MV 88,140,248,88
MV 88,136,240,88
MV 88,132,232,88
MV 88,128,224,88
s_waitcnt lgkmcnt(11)
MV 96,144,224,96
s_waitcnt lgkmcnt(10)
RD 128,4,44032
MV 96,148,232,96
s_waitcnt lgkmcnt(10)
RD 132,4,53248
MV 96,152,240,96
s_waitcnt lgkmcnt(10)
RD 136,4,62464
MV 96,156,248,96
RD 140,5,6144
MV 100,156,252,100
MV 100,152,244,100
s_add_u32 s36,s41,147456
MV 100,148,236,100
s_add_u32 m0,s41,0
MV 100,144,228,100
s_waitcnt lgkmcnt(11)
buffer_load_dwordx4 v60,s[16:19],s36 offen offset:0 sc1 lds
MV 108,160,228,108
s_waitcnt lgkmcnt(10)
RD 144,4,45056
MV 108,164,236,108
s_waitcnt lgkmcnt(10)
RD 148,4,54272
MV 108,168,244,108
s_waitcnt lgkmcnt(10)
RD 152,4,63488
MV 108,172,252,108
RD 156,5,7168
MV 104,172,248,104
buffer_load_dwordx4 v60,s[16:19],s36 offen offset:1024 sc1 lds
MV 104,168,240,104
MV 104,164,232,104
MV 104,160,224,104
s_waitcnt lgkmcnt(11)
MV 112,176,224,112
s_waitcnt lgkmcnt(10)
buffer_load_dwordx4 v60,s[16:19],s36 offen offset:2048 sc1 lds
MV 112,180,232,112
s_waitcnt lgkmcnt(9)
MV 112,184,240,112
s_waitcnt lgkmcnt(8)
MV 112,188,248,112
buffer_load_dwordx4 v60,s[16:19],s36 offen offset:3072 sc1 lds
MV 116,188,252,116
s_waitcnt vmcnt(38) lgkmcnt(0)
s_barrier
RD 160,5,8192
MV 116,184,244,116
RD 164,5,17408
MV 116,180,236,116
RD 168,5,26624
MV 116,176,228,116
RD 172,5,35840
MV 124,128,228,124
s_mov_b32 s45,110592
RD 176,5,9216
MV 124,132,236,124
buffer_load_dwordx4 a[184:187],v17,s[12:15],s45 offen sc1
MV 124,136,244,124
RD 180,5,18432
MV 124,140,252,124
RD 184,5,27648
MV 120,140,248,120
RD 188,5,36864
MV 120,136,240,120
MV 120,132,232,120
buffer_load_dwordx4 a[188:191],v27,s[12:15],s45 offen sc1
MV 120,128,224,120
MV 200,144,224,200
s_add_u32 s36,s41,151552
RD 128,5,10240
MV 200,148,232,200
s_add_u32 m0,s41,4096
RD 132,5,19456
MV 200,152,240,200
buffer_load_dwordx4 v60,s[16:19],s36 offen offset:0 sc1 lds
MV 200,156,248,200
RD 136,5,28672
MV 204,156,252,204
RD 140,5,37888
MV 204,152,244,204
buffer_load_dwordx4 v60,s[16:19],s36 offen offset:1024 sc1 lds
MV 204,148,236,204
MV 204,144,228,204
s_waitcnt vmcnt(41) lgkmcnt(11)
MV 64,160,128,64
s_waitcnt vmcnt(39) lgkmcnt(10)
RD 144,5,11264
MV 64,164,136,64
s_waitcnt vmcnt(37) lgkmcnt(10)
RD 148,5,20480
MV 64,168,144,64
s_waitcnt vmcnt(35) lgkmcnt(10)
RD 152,5,29696
MV 64,172,152,64
s_waitcnt vmcnt(34)
buffer_load_dwordx4 v60,s[16:19],s36 offen offset:2048 sc1 lds
MV 68,172,156,68
RD 156,5,38912
MV 68,168,148,68
MV 68,164,140,68
MV 68,160,132,68
s_mov_b32 s45,131072
s_waitcnt lgkmcnt(11)
MV 76,176,132,76
s_waitcnt lgkmcnt(10)
buffer_load_dwordx4 a[192:195],v17,s[12:15],s45 offen sc1
MV 76,180,140,76
s_waitcnt lgkmcnt(9)
RD 160,5,12288
MV 76,184,148,76
s_waitcnt lgkmcnt(9)
RD 164,5,21504
MV 76,188,156,76
RD 168,5,30720
MV 72,188,152,72
buffer_load_dwordx4 a[196:199],v27,s[12:15],s45 offen sc1
MV 72,184,144,72
RD 172,5,39936
MV 72,180,136,72
MV 72,176,128,72
s_waitcnt lgkmcnt(11)
buffer_load_dwordx4 v60,s[16:19],s36 offen offset:3072 sc1 lds
MV 80,128,128,80
s_waitcnt lgkmcnt(10)
RD 176,5,13312
MV 80,132,136,80
s_waitcnt lgkmcnt(10)
RD 180,5,22528
MV 80,136,144,80
s_waitcnt lgkmcnt(10)
RD 184,5,31744
MV 80,140,152,80
s_add_u32 s36,s41,155648
RD 188,5,40960
MV 84,140,156,84
s_add_u32 m0,s41,8192
MV 84,136,148,84
buffer_load_dwordx4 v60,s[16:19],s36 offen offset:0 sc1 lds
MV 84,132,140,84
MV 84,128,132,84
s_waitcnt lgkmcnt(11)
MV 92,144,132,92
s_waitcnt lgkmcnt(10)
RD 128,5,14336
MV 92,148,140,92
s_mov_b32 s45,135168
RD 132,5,23552
s_waitcnt lgkmcnt(11)
MV 92,152,148,92
s_waitcnt lgkmcnt(10)
buffer_load_dwordx4 a[200:203],v17,s[12:15],s45 offen sc1
MV 92,156,156,92
RD 136,5,32768
MV 88,156,152,88
RD 140,5,41984
MV 88,152,144,88
MV 88,148,136,88
buffer_load_dwordx4 a[204:207],v27,s[12:15],s45 offen sc1
MV 88,144,128,88
s_add_u32 s36,s41,184320
s_waitcnt lgkmcnt(11)
MV 96,160,128,96
s_add_u32 m0,s41,36864
RD 144,5,15360
s_waitcnt lgkmcnt(11)
MV 96,164,136,96
s_waitcnt lgkmcnt(10)
buffer_load_dwordx4 v60,s[16:19],s36 offen offset:0 sc1 lds
MV 96,168,144,96
s_waitcnt lgkmcnt(9)
RD 148,5,24576
MV 96,172,152,96
RD 152,5,33792
MV 100,172,156,100
RD 156,5,43008
MV 100,168,148,100
MV 100,164,140,100
MV 100,160,132,100
s_waitcnt lgkmcnt(11)
buffer_load_dwordx4 v60,s[16:19],s36 offen offset:1024 sc1 lds
MV 108,176,132,108
s_waitcnt lgkmcnt(10)
RD 160,5,16384
MV 108,180,140,108
s_waitcnt lgkmcnt(10)
RD 164,5,25600
MV 108,184,148,108
s_waitcnt lgkmcnt(10)
RD 168,5,34816
MV 108,188,156,108
s_mov_b32 s45,139264
RD 172,5,44032
MV 104,188,152,104
buffer_load_dwordx4 a[208:211],v17,s[12:15],s45 offen sc1
MV 104,184,144,104
MV 104,180,136,104
MV 104,176,128,104
s_waitcnt lgkmcnt(11)
MV 112,128,128,112
s_waitcnt lgkmcnt(10)
buffer_load_dwordx4 a[212:215],v27,s[12:15],s45 offen sc1
MV 112,132,136,112
s_waitcnt lgkmcnt(9)
MV 112,136,144,112
s_waitcnt lgkmcnt(8)
MV 112,140,152,112
buffer_load_dwordx4 v60,s[16:19],s36 offen offset:2048 sc1 lds
MV 116,140,156,116
s_waitcnt vmcnt(40) lgkmcnt(0)
s_barrier
s_waitcnt vmcnt(20)
RD 176,5,45056
MV 116,136,148,116
RD 180,5,54272
buffer_store_dword v61,v63,s[88:91],0 offen offset:16 sc1
MV 116,132,140,116
RD 184,5,63488
MV 116,128,132,116
RD 188,6,7168
MV 124,144,132,124
RD 128,5,46080
MV 124,148,140,124
buffer_load_dwordx4 v60,s[16:19],s36 offen offset:3072 sc1 lds
MV 124,152,148,124
RD 132,5,55296
MV 124,156,156,124
RD 136,5,64512
MV 120,156,152,120
RD 140,6,8192
MV 120,152,144,120
s_mov_b32 s45,143360
MV 120,148,136,120
buffer_load_dwordx4 a[216:219],v17,s[12:15],s45 offen sc1
MV 120,144,128,120
MV 200,160,128,200
RD 144,5,47104
MV 200,164,136,200
RD 148,5,56320
MV 200,168,144,200
buffer_load_dwordx4 a[220:223],v27,s[12:15],s45 offen sc1
MV 200,172,152,200
s_add_u32 s36,s41,188416
RD 152,6,0
MV 204,172,156,204
s_add_u32 m0,s41,40960
RD 156,6,9216
MV 204,168,148,204
buffer_load_dwordx4 v60,s[16:19],s36 offen offset:0 sc1 lds
MV 204,164,140,204
MV 204,160,132,204
s_waitcnt lgkmcnt(11)
MV 64,176,160,64
s_waitcnt lgkmcnt(10)
RD 160,5,48128
MV 64,180,168,64
s_waitcnt lgkmcnt(10)
RD 164,5,57344
MV 64,184,176,64
s_waitcnt vmcnt(20) lgkmcnt(10)
RD 168,6,1024
MV 64,188,184,64
s_waitcnt vmcnt(19)
buffer_load_dwordx4 v60,s[16:19],s36 offen offset:1024 sc1 lds
MV 68,188,188,68
RD 172,6,10240
MV 68,184,180,68
MV 68,180,172,68
MV 68,176,164,68
s_waitcnt lgkmcnt(11)
MV 76,128,164,76
s_waitcnt lgkmcnt(10)
buffer_load_dwordx4 v60,s[16:19],s36 offen offset:2048 sc1 lds
MV 76,132,172,76
s_waitcnt lgkmcnt(9)
RD 176,5,49152
MV 76,136,180,76
s_waitcnt lgkmcnt(9)
RD 180,5,58368
MV 76,140,188,76
s_mov_b32 s45,163840
RD 184,6,2048
MV 72,140,184,72
buffer_load_dwordx4 a[224:227],v17,s[12:15],s45 offen sc1
MV 72,136,176,72
RD 188,6,11264
MV 72,132,168,72
MV 72,128,160,72
s_waitcnt lgkmcnt(11)
buffer_load_dwordx4 a[228:231],v27,s[12:15],s45 offen sc1
MV 80,144,160,80
s_waitcnt lgkmcnt(10)
RD 128,5,50176
MV 80,148,168,80
s_waitcnt lgkmcnt(10)
RD 132,5,59392
MV 80,152,176,80
s_waitcnt lgkmcnt(10)
RD 136,6,3072
MV 80,156,184,80
RD 140,6,12288
MV 84,156,188,84
MV 84,152,180,84
buffer_load_dwordx4 v60,s[16:19],s36 offen offset:3072 sc1 lds
MV 84,148,172,84
MV 84,144,164,84
s_waitcnt lgkmcnt(11)
MV 92,160,164,92
s_add_u32 s36,s41,192512
RD 144,5,51200
s_waitcnt lgkmcnt(11)
MV 92,164,172,92
s_add_u32 m0,s41,45056
RD 148,5,60416
s_waitcnt lgkmcnt(11)
MV 92,168,180,92
s_waitcnt lgkmcnt(10)
buffer_load_dwordx4 v60,s[16:19],s36 offen offset:0 sc1 lds
MV 92,172,188,92
RD 152,6,4096
MV 88,172,184,88
RD 156,6,13312
MV 88,168,176,88
s_mov_b32 s45,167936
MV 88,164,168,88
buffer_load_dwordx4 a[232:235],v17,s[12:15],s45 offen sc1
MV 88,160,160,88
s_waitcnt lgkmcnt(11)
MV 96,176,160,96
s_waitcnt lgkmcnt(10)
RD 160,5,52224
MV 96,180,168,96
s_waitcnt lgkmcnt(10)
buffer_load_dwordx4 a[236:239],v27,s[12:15],s45 offen sc1
MV 96,184,176,96
s_waitcnt lgkmcnt(9)
RD 164,5,61440
MV 96,188,184,96
RD 168,6,5120
MV 100,188,188,100
RD 172,6,14336
MV 100,184,180,100
s_add_u32 s36,s41,221184
MV 100,180,172,100
s_add_u32 m0,s41,73728
MV 100,176,164,100
s_waitcnt lgkmcnt(11)
buffer_load_dwordx4 v60,s[16:19],s36 offen offset:0 sc1 lds
MV 108,128,164,108
s_waitcnt lgkmcnt(10)
RD 176,5,53248
MV 108,132,172,108
s_waitcnt lgkmcnt(10)
RD 180,5,62464
MV 108,136,180,108
s_waitcnt lgkmcnt(10)
RD 184,6,6144
MV 108,140,188,108
RD 188,6,15360
MV 104,140,184,104
MV 104,136,176,104
buffer_load_dwordx4 v60,s[16:19],s36 offen offset:1024 sc1 lds
MV 104,132,168,104
MV 104,128,160,104
s_waitcnt lgkmcnt(11)
MV 112,144,160,112
s_waitcnt lgkmcnt(10)
MV 112,148,168,112
s_waitcnt lgkmcnt(9)
MV 112,152,176,112
s_mov_b32 s45,172032
s_waitcnt lgkmcnt(8)
MV 112,156,184,112
buffer_load_dwordx4 a[240:243],v17,s[12:15],s45 offen sc1
MV 116,156,188,116
s_waitcnt vmcnt(23) lgkmcnt(0)
s_barrier
RD 128,4,0
MV 116,152,180,116
RD 132,4,9216
MV 116,148,172,116
RD 136,4,18432
MV 116,144,164,116
RD 140,4,27648
MV 124,160,164,124
RD 144,4,1024
MV 124,164,172,124
buffer_load_dwordx4 a[244:247],v27,s[12:15],s45 offen sc1
MV 124,168,180,124
RD 148,4,10240
MV 124,172,188,124
RD 152,4,19456
MV 120,172,184,120
RD 156,4,28672
MV 120,168,176,120
MV 120,164,168,120
buffer_load_dwordx4 v60,s[16:19],s36 offen offset:2048 sc1 lds
MV 120,160,160,120
MV 200,176,160,200
RD 160,4,2048
MV 200,180,168,200
RD 164,4,11264
MV 200,184,176,200
buffer_load_dwordx4 v60,s[16:19],s36 offen offset:3072 sc1 lds
MV 200,188,184,200
RD 168,4,20480
MV 204,188,188,204
s_mov_b32 s45,176128
RD 172,4,29696
MV 204,184,180,204
buffer_load_dwordx4 a[248:251],v17,s[12:15],s45 offen sc1
MV 204,180,172,204
MV 204,176,164,204
s_waitcnt lgkmcnt(11)
MV 64,128,192,64
s_waitcnt vmcnt(26) lgkmcnt(10)
RD 176,4,3072
MV 64,132,200,64
s_waitcnt vmcnt(22) lgkmcnt(10)
RD 180,4,12288
MV 64,136,208,64
s_waitcnt vmcnt(17) lgkmcnt(10)
RD 184,4,21504
MV 64,140,216,64
s_waitcnt vmcnt(16)
buffer_load_dwordx4 a[252:255],v27,s[12:15],s45 offen sc1
MV 68,140,220,68
RD 188,4,30720
MV 68,136,212,68
MV 68,132,204,68
s_add_u32 s36,s41,225280
MV 68,128,196,68
s_add_u32 m0,s41,77824
s_waitcnt lgkmcnt(11)
MV 76,144,196,76
s_waitcnt lgkmcnt(10)
buffer_load_dwordx4 v60,s[16:19],s36 offen offset:0 sc1 lds
MV 76,148,204,76
s_waitcnt lgkmcnt(9)
RD 128,4,4096
MV 76,152,212,76
s_waitcnt lgkmcnt(9)
RD 132,4,13312
MV 76,156,220,76
RD 136,4,22528
MV 72,156,216,72
buffer_load_dwordx4 v60,s[16:19],s36 offen offset:1024 sc1 lds
MV 72,152,208,72
RD 140,4,31744
MV 72,148,200,72
MV 72,144,192,72
s_waitcnt lgkmcnt(11)
buffer_load_dwordx4 v60,s[16:19],s36 offen offset:2048 sc1 lds
MV 80,160,192,80
s_waitcnt lgkmcnt(10)
RD 144,4,5120
MV 80,164,200,80
s_waitcnt lgkmcnt(10)
RD 148,4,14336
MV 80,168,208,80
s_waitcnt lgkmcnt(10)
RD 152,4,23552
MV 80,172,216,80
RD 156,4,32768
MV 84,172,220,84
s_mov_b32 s45,196608
MV 84,168,212,84
buffer_load_dwordx4 a[128:131],v17,s[12:15],s45 offen sc1
MV 84,164,204,84
MV 84,160,196,84
s_waitcnt lgkmcnt(11)
MV 92,176,196,92
s_waitcnt lgkmcnt(10)
RD 160,4,6144
MV 92,180,204,92
s_waitcnt lgkmcnt(10)
RD 164,4,15360
MV 92,184,212,92
s_waitcnt lgkmcnt(10)
buffer_load_dwordx4 a[132:135],v27,s[12:15],s45 offen sc1
MV 92,188,220,92
RD 168,4,24576
MV 88,188,216,88
RD 172,4,33792
MV 88,184,208,88
MV 88,180,200,88
buffer_load_dwordx4 v60,s[16:19],s36 offen offset:3072 sc1 lds
MV 88,176,192,88
s_add_u32 s36,s41,229376
s_waitcnt lgkmcnt(11)
MV 96,128,192,96
s_add_u32 m0,s41,81920
RD 176,4,7168
s_waitcnt lgkmcnt(11)
MV 96,132,200,96
s_waitcnt lgkmcnt(10)
buffer_load_dwordx4 v60,s[16:19],s36 offen offset:0 sc1 lds
MV 96,136,208,96
s_waitcnt lgkmcnt(9)
RD 180,4,16384
MV 96,140,216,96
RD 184,4,25600
MV 100,140,220,100
RD 188,4,34816
MV 100,136,212,100
MV 100,132,204,100
s_mov_b32 s45,200704
MV 100,128,196,100
s_waitcnt lgkmcnt(11)
buffer_load_dwordx4 a[136:139],v17,s[12:15],s45 offen sc1
MV 108,144,196,108
s_waitcnt lgkmcnt(10)
RD 128,4,8192
MV 108,148,204,108
s_waitcnt lgkmcnt(10)
RD 132,4,17408
MV 108,152,212,108
s_waitcnt lgkmcnt(10)
RD 136,4,26624
MV 108,156,220,108
RD 140,4,35840
MV 104,156,216,104
buffer_load_dwordx4 a[140:143],v27,s[12:15],s45 offen sc1
MV 104,152,208,104
MV 104,148,200,104
s_add_u32 s36,s41,258048
MV 104,144,192,104
s_add_u32 m0,s41,110592
s_waitcnt lgkmcnt(11)
MV 112,160,192,112
s_waitcnt lgkmcnt(10)
buffer_load_dwordx4 v60,s[16:19],s36 offen offset:0 sc1 lds
MV 112,164,200,112
s_waitcnt lgkmcnt(9)
MV 112,168,208,112
s_waitcnt lgkmcnt(8)
MV 112,172,216,112
buffer_load_dwordx4 v60,s[16:19],s36 offen offset:1024 sc1 lds
MV 116,172,220,116
s_waitcnt vmcnt(21) lgkmcnt(0)
s_barrier
RD 144,4,36864
MV 116,168,212,116
RD 148,4,46080
MV 116,164,204,116
RD 152,4,55296
MV 116,160,196,116
RD 156,4,64512
MV 124,176,196,124
s_mov_b32 s45,204800
RD 160,4,37888
MV 124,180,204,124
buffer_load_dwordx4 a[144:147],v17,s[12:15],s45 offen sc1
MV 124,184,212,124
RD 164,4,47104
MV 124,188,220,124
RD 168,4,56320
MV 120,188,216,120
RD 172,5,0
MV 120,184,208,120
MV 120,180,200,120
buffer_load_dwordx4 a[148:151],v27,s[12:15],s45 offen sc1
MV 120,176,192,120
MV 200,128,192,200
RD 176,4,38912
MV 200,132,200,200
RD 180,4,48128
MV 200,136,208,200
buffer_load_dwordx4 v60,s[16:19],s36 offen offset:2048 sc1 lds
MV 200,140,216,200
RD 184,4,57344
MV 204,140,220,204
RD 188,5,1024
MV 204,136,212,204
buffer_load_dwordx4 v60,s[16:19],s36 offen offset:3072 sc1 lds
MV 204,132,204,204
MV 204,128,196,204
s_waitcnt lgkmcnt(11)
MV 64,144,224,64
s_waitcnt vmcnt(24) lgkmcnt(10)
RD 128,4,39936
MV 64,148,232,64
s_waitcnt vmcnt(20) lgkmcnt(10)
RD 132,4,49152
MV 64,152,240,64
s_mov_b32 s45,208896
RD 136,4,58368
s_waitcnt vmcnt(16) lgkmcnt(11)
MV 64,156,248,64
s_waitcnt vmcnt(15)
buffer_load_dwordx4 a[152:155],v17,s[12:15],s45 offen sc1
MV 68,156,252,68
RD 140,5,2048
MV 68,152,244,68
MV 68,148,236,68
MV 68,144,228,68
s_waitcnt lgkmcnt(11)
MV 76,160,228,76
s_waitcnt lgkmcnt(10)
buffer_load_dwordx4 a[156:159],v27,s[12:15],s45 offen sc1
MV 76,164,236,76
s_waitcnt lgkmcnt(9)
RD 144,4,40960
MV 76,168,244,76
s_add_u32 s36,s41,262144
RD 148,4,50176
s_waitcnt lgkmcnt(10)
MV 76,172,252,76
s_add_u32 m0,s41,114688
RD 152,4,59392
MV 72,172,248,72
buffer_load_dwordx4 v60,s[16:19],s36 offen offset:0 sc1 lds
MV 72,168,240,72
RD 156,5,3072
MV 72,164,232,72
MV 72,160,224,72
s_waitcnt lgkmcnt(11)
buffer_load_dwordx4 v60,s[16:19],s36 offen offset:1024 sc1 lds
MV 80,176,224,80
s_waitcnt lgkmcnt(10)
RD 160,4,41984
MV 80,180,232,80
s_waitcnt lgkmcnt(10)
RD 164,4,51200
MV 80,184,240,80
s_waitcnt lgkmcnt(10)
RD 168,4,60416
MV 80,188,248,80
RD 172,5,4096
MV 84,188,252,84
MV 84,184,244,84
buffer_load_dwordx4 v60,s[16:19],s36 offen offset:2048 sc1 lds
MV 84,180,236,84
MV 84,176,228,84
s_waitcnt lgkmcnt(11)
MV 92,128,228,92
s_waitcnt lgkmcnt(10)
RD 176,4,43008
MV 92,132,236,92
s_mov_b32 s45,229376
RD 180,4,52224
s_waitcnt lgkmcnt(11)
MV 92,136,244,92
s_waitcnt lgkmcnt(10)
buffer_load_dwordx4 a[160:163],v17,s[12:15],s45 offen sc1
MV 92,140,252,92
RD 184,4,61440
MV 88,140,248,88
RD 188,5,5120
MV 88,136,240,88
MV 88,132,232,88
buffer_load_dwordx4 a[164:167],v27,s[12:15],s45 offen sc1
MV 88,128,224,88
s_waitcnt lgkmcnt(11)
MV 96,144,224,96
s_waitcnt lgkmcnt(10)
RD 128,4,44032
MV 96,148,232,96
s_waitcnt lgkmcnt(10)
buffer_load_dwordx4 v60,s[16:19],s36 offen offset:3072 sc1 lds
MV 96,152,240,96
s_waitcnt lgkmcnt(9)
RD 132,4,53248
MV 96,156,248,96
RD 136,4,62464
MV 100,156,252,100
s_add_u32 s36,s41,266240
RD 140,5,6144
MV 100,152,244,100
s_add_u32 m0,s41,118784
MV 100,148,236,100
buffer_load_dwordx4 v60,s[16:19],s36 offen offset:0 sc1 lds
MV 100,144,228,100
s_waitcnt lgkmcnt(11)
MV 108,160,228,108
s_waitcnt lgkmcnt(10)
RD 144,4,45056
MV 108,164,236,108
s_mov_b32 s45,233472
RD 148,4,54272
s_waitcnt lgkmcnt(11)
MV 108,168,244,108
s_waitcnt lgkmcnt(10)
buffer_load_dwordx4 a[168:171],v17,s[12:15],s45 offen sc1
MV 108,172,252,108
RD 152,4,63488
MV 104,172,248,104
RD 156,5,7168
MV 104,168,240,104
buffer_load_dwordx4 a[172:175],v27,s[12:15],s45 offen sc1
MV 104,164,232,104
s_add_u32 s36,s41,294912
MV 104,160,224,104
s_add_u32 m0,s41,0
s_waitcnt lgkmcnt(11)
MV 112,176,224,112
s_waitcnt lgkmcnt(10)
buffer_load_dwordx4 v60,s[16:19],s36 offen offset:0 sc1 lds
MV 112,180,232,112
s_waitcnt lgkmcnt(9)
MV 112,184,240,112
s_waitcnt lgkmcnt(8)
MV 112,188,248,112
buffer_load_dwordx4 v60,s[16:19],s36 offen offset:1024 sc1 lds
MV 116,188,252,116
s_waitcnt vmcnt(21) lgkmcnt(0)
s_barrier
RD 160,5,8192
MV 116,184,244,116
RD 164,5,17408
buffer_load_dword v62,v3,s[24:27],0 offen offset:16 sc1
MV 116,180,236,116
RD 168,5,26624
MV 116,176,228,116
RD 172,5,35840
MV 124,128,228,124
s_mov_b32 s45,237568
RD 176,5,9216
MV 124,132,236,124
buffer_load_dwordx4 a[176:179],v17,s[12:15],s45 offen sc1
MV 124,136,244,124
RD 180,5,18432
MV 124,140,252,124
RD 184,5,27648
MV 120,140,248,120
RD 188,5,36864
MV 120,136,240,120
MV 120,132,232,120
buffer_load_dwordx4 a[180:183],v27,s[12:15],s45 offen sc1
MV 120,128,224,120
MV 200,144,224,200
RD 128,5,10240
MV 200,148,232,200
RD 132,5,19456
MV 200,152,240,200
buffer_load_dwordx4 v60,s[16:19],s36 offen offset:2048 sc1 lds
MV 200,156,248,200
RD 136,5,28672
MV 204,156,252,204
RD 140,5,37888
MV 204,152,244,204
buffer_load_dwordx4 v60,s[16:19],s36 offen offset:3072 sc1 lds
MV 204,148,236,204
MV 204,144,228,204
s_waitcnt lgkmcnt(11)
MV 64,160,128,64
s_waitcnt vmcnt(25) lgkmcnt(10)
RD 144,5,11264
MV 64,164,136,64
s_waitcnt vmcnt(21) lgkmcnt(10)
RD 148,5,20480
MV 64,168,144,64
s_mov_b32 s45,241664
RD 152,5,29696
s_waitcnt vmcnt(17) lgkmcnt(11)
MV 64,172,152,64
s_waitcnt vmcnt(16)
buffer_load_dwordx4 a[184:187],v17,s[12:15],s45 offen sc1
MV 68,172,156,68
RD 156,5,38912
MV 68,168,148,68
MV 68,164,140,68
MV 68,160,132,68
s_waitcnt lgkmcnt(11)
MV 76,176,132,76
s_waitcnt lgkmcnt(10)
buffer_load_dwordx4 a[188:191],v27,s[12:15],s45 offen sc1
MV 76,180,140,76
s_waitcnt lgkmcnt(9)
RD 160,5,12288
MV 76,184,148,76
s_add_u32 s36,s41,299008
RD 164,5,21504
s_waitcnt lgkmcnt(10)
MV 76,188,156,76
s_add_u32 m0,s41,4096
RD 168,5,30720
MV 72,188,152,72
buffer_load_dwordx4 v60,s[16:19],s36 offen offset:0 sc1 lds
MV 72,184,144,72
RD 172,5,39936
MV 72,180,136,72
MV 72,176,128,72
s_waitcnt lgkmcnt(11)
buffer_load_dwordx4 v60,s[16:19],s36 offen offset:1024 sc1 lds
MV 80,128,128,80
s_waitcnt lgkmcnt(10)
RD 176,5,13312
MV 80,132,136,80
RD 180,5,22528
s_waitcnt vmcnt(8)
v_cmp_ne_u32 vcc,1,v62
s_nop 0
s_cbranch_vccnz L_spin_f2
L_back_f2:
s_waitcnt lgkmcnt(11)
MV 80,136,144,80
s_waitcnt lgkmcnt(10)
RD 184,5,31744
MV 80,140,152,80
RD 188,5,40960
MV 84,140,156,84
MV 84,136,148,84
buffer_load_dwordx4 v60,s[16:19],s36 offen offset:2048 sc1 lds
MV 84,132,140,84
MV 84,128,132,84
s_waitcnt lgkmcnt(11)
MV 92,144,132,92
s_waitcnt lgkmcnt(10)
RD 128,5,14336
MV 92,148,140,92
s_mov_b32 s45,16384
RD 132,5,23552
s_waitcnt lgkmcnt(11)
MV 92,152,148,92
s_waitcnt lgkmcnt(10)
buffer_load_dwordx4 a[192:195],v17,s[12:15],s45 offen sc1
MV 92,156,156,92
RD 136,5,32768
MV 88,156,152,88
RD 140,5,41984
MV 88,152,144,88
MV 88,148,136,88
buffer_load_dwordx4 a[196:199],v27,s[12:15],s45 offen sc1
MV 88,144,128,88
s_waitcnt lgkmcnt(11)
MV 96,160,128,96
s_waitcnt lgkmcnt(10)
RD 144,5,15360
MV 96,164,136,96
s_waitcnt lgkmcnt(10)
buffer_load_dwordx4 v60,s[16:19],s36 offen offset:3072 sc1 lds
v_readfirstlane_b32 s46,v43
MV 96,168,144,96
s_waitcnt lgkmcnt(9)
RD 148,5,24576
MV 96,172,152,96
RD 152,5,33792
MV 100,172,156,100
s_add_u32 s36,s41,303104
RD 156,5,43008
MV 100,168,148,100
s_add_u32 m0,s41,8192
MV 100,164,140,100
buffer_load_dwordx4 v60,s[16:19],s36 offen offset:0 sc1 lds
MV 100,160,132,100
s_waitcnt lgkmcnt(11)
MV 108,176,132,108
s_sub_u32 s50,16,s46
RD 160,5,16384
s_waitcnt lgkmcnt(11)
MV 108,180,140,108
s_mov_b32 s45,20480
RD 164,5,25600
s_waitcnt lgkmcnt(11)
MV 108,184,148,108
s_mul_i32 s18,s50,36864
buffer_load_dwordx4 a[200:203],v17,s[12:15],s45 offen sc1
s_waitcnt lgkmcnt(10)
MV 108,188,156,108
s_sub_u32 s50,8,s46
RD 168,5,34816
MV 104,188,152,104
RD 172,5,44032
MV 104,184,144,104
buffer_load_dwordx4 a[204:207],v27,s[12:15],s45 offen sc1
MV 104,180,136,104
s_add_u32 s36,s41,331776
MV 104,176,128,104
s_add_u32 m0,s41,36864
s_waitcnt lgkmcnt(11)
MV 112,128,128,112
s_lshl_b32 s50,s50,15
buffer_load_dwordx4 v60,s[16:19],s36 offen offset:0 sc1 lds
s_waitcnt lgkmcnt(10)
MV 112,132,136,112
s_min_u32 s14,s14,s50
s_waitcnt lgkmcnt(9)
MV 112,136,144,112
s_waitcnt lgkmcnt(8)
MV 112,140,152,112
buffer_load_dwordx4 v60,s[16:19],s36 offen offset:1024 sc1 lds
MV 116,140,156,116
s_waitcnt lgkmcnt(0)
s_barrier
RD 176,5,45056
MV 116,136,148,116
RD 180,5,54272
MV 116,132,140,116
RD 184,5,63488
MV 116,128,132,116
RD 188,6,7168
MV 124,144,132,124
s_mov_b32 s45,24576
RD 128,5,46080
MV 124,148,140,124
buffer_load_dwordx4 a[208:211],v17,s[12:15],s45 offen sc1
MV 124,152,148,124
RD 132,5,55296
MV 124,156,156,124
RD 136,5,64512
MV 120,156,152,120
RD 140,6,8192
MV 120,152,144,120
MV 120,148,136,120
buffer_load_dwordx4 a[212:215],v27,s[12:15],s45 offen sc1
MV 120,144,128,120
MV 200,160,128,200
RD 144,5,47104
MV 200,164,136,200
RD 148,5,56320
MV 200,168,144,200
buffer_load_dwordx4 v60,s[16:19],s36 offen offset:2048 sc1 lds
MV 200,172,152,200
RD 152,6,0
MV 204,172,156,204
RD 156,6,9216
MV 204,168,148,204
buffer_load_dwordx4 v60,s[16:19],s36 offen offset:3072 sc1 lds
MV 204,164,140,204
MV 204,160,132,204
s_waitcnt lgkmcnt(11)
MV 64,176,160,64
s_waitcnt lgkmcnt(10)
RD 160,5,48128
MV 64,180,168,64
s_waitcnt vmcnt(20) lgkmcnt(10)
RD 164,5,57344
MV 64,184,176,64
s_mov_b32 s45,28672
RD 168,6,1024
s_waitcnt vmcnt(16) lgkmcnt(11)
MV 64,188,184,64
s_waitcnt vmcnt(15)
buffer_load_dwordx4 a[216:219],v17,s[12:15],s45 offen sc1
MV 68,188,188,68
RD 172,6,10240
MV 68,184,180,68
MV 68,180,172,68
MV 68,176,164,68
s_waitcnt lgkmcnt(11)
MV 76,128,164,76
s_waitcnt lgkmcnt(10)
buffer_load_dwordx4 a[220:223],v27,s[12:15],s45 offen sc1
MV 76,132,172,76
s_waitcnt lgkmcnt(9)
RD 176,5,49152
MV 76,136,180,76
s_add_u32 s36,s41,335872
RD 180,5,58368
s_waitcnt lgkmcnt(10)
MV 76,140,188,76
s_add_u32 m0,s41,40960
RD 184,6,2048
MV 72,140,184,72
buffer_load_dwordx4 v60,s[16:19],s36 offen offset:0 sc1 lds
MV 72,136,176,72
RD 188,6,11264
MV 72,132,168,72
MV 72,128,160,72
s_waitcnt lgkmcnt(11)
buffer_load_dwordx4 v60,s[16:19],s36 offen offset:1024 sc1 lds
MV 80,144,160,80
s_waitcnt lgkmcnt(10)
RD 128,5,50176
MV 80,148,168,80
s_waitcnt lgkmcnt(10)
RD 132,5,59392
MV 80,152,176,80
s_waitcnt lgkmcnt(10)
RD 136,6,3072
MV 80,156,184,80
RD 140,6,12288
MV 84,156,188,84
MV 84,152,180,84
buffer_load_dwordx4 v60,s[16:19],s36 offen offset:2048 sc1 lds
MV 84,148,172,84
MV 84,144,164,84
s_waitcnt lgkmcnt(11)
MV 92,160,164,92
s_waitcnt lgkmcnt(10)
RD 144,5,51200
MV 92,164,172,92
s_mov_b32 s45,49152
RD 148,5,60416
s_waitcnt lgkmcnt(11)
MV 92,168,180,92
s_waitcnt lgkmcnt(10)
buffer_load_dwordx4 a[224:227],v17,s[12:15],s45 offen sc1
MV 92,172,188,92
RD 152,6,4096
MV 88,172,184,88
RD 156,6,13312
MV 88,168,176,88
MV 88,164,168,88
buffer_load_dwordx4 a[228:231],v27,s[12:15],s45 offen sc1
MV 88,160,160,88
s_waitcnt lgkmcnt(11)
MV 96,176,160,96
s_waitcnt lgkmcnt(10)
RD 160,5,52224
MV 96,180,168,96
s_waitcnt lgkmcnt(10)
buffer_load_dwordx4 v60,s[16:19],s36 offen offset:3072 sc1 lds
MV 96,184,176,96
s_waitcnt lgkmcnt(9)
RD 164,5,61440
MV 96,188,184,96
RD 168,6,5120
MV 100,188,188,100
s_add_u32 s36,s41,339968
RD 172,6,14336
MV 100,184,180,100
s_add_u32 m0,s41,45056
MV 100,180,172,100
buffer_load_dwordx4 v60,s[16:19],s36 offen offset:0 sc1 lds
MV 100,176,164,100
s_waitcnt lgkmcnt(11)
MV 108,128,164,108
s_waitcnt lgkmcnt(10)
RD 176,5,53248
MV 108,132,172,108
s_mov_b32 s45,53248
RD 180,5,62464
s_waitcnt lgkmcnt(11)
MV 108,136,180,108
s_waitcnt lgkmcnt(10)
buffer_load_dwordx4 a[232:235],v17,s[12:15],s45 offen sc1
MV 108,140,188,108
RD 184,6,6144
MV 104,140,184,104
RD 188,6,15360
MV 104,136,176,104
buffer_load_dwordx4 a[236:239],v27,s[12:15],s45 offen sc1
MV 104,132,168,104
s_add_u32 s36,s41,368640
MV 104,128,160,104
s_add_u32 m0,s41,73728
s_waitcnt lgkmcnt(11)
MV 112,144,160,112
s_waitcnt lgkmcnt(10)
buffer_load_dwordx4 v60,s[16:19],s36 offen offset:0 sc1 lds
MV 112,148,168,112
s_waitcnt lgkmcnt(9)
MV 112,152,176,112
s_waitcnt lgkmcnt(8)
MV 112,156,184,112
buffer_load_dwordx4 v60,s[16:19],s36 offen offset:1024 sc1 lds
MV 116,156,188,116
s_waitcnt vmcnt(21) lgkmcnt(0)
s_barrier
RD 128,4,0
MV 116,152,180,116
RD 132,4,9216
MV 116,148,172,116
RD 136,4,18432
MV 116,144,164,116
RD 140,4,27648
MV 124,160,164,124
s_mov_b32 s45,57344
RD 144,4,1024
MV 124,164,172,124
s_lshl_b32 s50,s2,2
buffer_load_dwordx4 a[240:243],v17,s[12:15],s45 offen sc1
MV 124,168,180,124
s_add_u32 s50,s50,s32
RD 148,4,10240
MV 124,172,188,124
s_mul_i32 s50,s50,9216
RD 152,4,19456
MV 120,172,184,120
RD 156,4,28672
MV 120,168,176,120
MV 120,164,168,120
buffer_load_dwordx4 a[244:247],v27,s[12:15],s45 offen sc1
MV 120,160,160,120
MV 200,176,160,200
s_add_u32 s50,s50,46137344
RD 160,4,2048
MV 200,180,168,200
s_add_u32 s20,s52,s50
s_addc_u32 s21,s53,0
RD 164,4,11264
MV 200,184,176,200
s_mov_b32 s22,9216
buffer_load_dwordx4 v60,s[16:19],s36 offen offset:2048 sc1 lds
MV 200,188,184,200
s_xor_b32 s50,s2,1
RD 168,4,20480
MV 204,188,188,204
RD 172,4,29696
MV 204,184,180,204
buffer_load_dwordx4 v60,s[16:19],s36 offen offset:3072 sc1 lds
MV 204,180,172,204
MV 204,176,164,204
s_waitcnt lgkmcnt(11)
MV 64,128,192,64
s_lshl_b32 s51,s50,2
RD 176,4,3072
s_waitcnt vmcnt(24) lgkmcnt(11)
MV 64,132,200,64
s_add_u32 s51,s51,s32
RD 180,4,12288
s_waitcnt vmcnt(20) lgkmcnt(11)
MV 64,136,208,64
s_mov_b32 s45,61440
RD 184,4,21504
s_waitcnt vmcnt(16) lgkmcnt(11)
MV 64,140,216,64
s_mul_i32 s51,s51,9216
buffer_load_dwordx4 a[248:251],v17,s[12:15],s45 offen sc1
s_waitcnt vmcnt(16)
MV 68,140,220,68
RD 188,4,30720
MV 68,136,212,68
MV 68,132,204,68
MV 68,128,196,68
s_waitcnt lgkmcnt(11)
MV 76,144,196,76
s_add_u32 s51,s51,46137344
buffer_load_dwordx4 a[252:255],v27,s[12:15],s45 offen sc1
s_waitcnt lgkmcnt(10)
MV 76,148,204,76
s_add_u32 s8,s52,s51
s_addc_u32 s9,s53,0
RD 128,4,4096
s_waitcnt lgkmcnt(10)
MV 76,152,212,76
s_add_u32 s36,s41,372736
RD 132,4,13312
s_waitcnt lgkmcnt(10)
MV 76,156,220,76
s_add_u32 m0,s41,77824
RD 136,4,22528
MV 72,156,216,72
buffer_load_dwordx4 v60,s[16:19],s36 offen offset:0 sc1 lds
MV 72,152,208,72
RD 140,4,31744
MV 72,148,200,72
MV 72,144,192,72
s_waitcnt lgkmcnt(11)
buffer_load_dwordx4 v60,s[16:19],s36 offen offset:1024 sc1 lds
MV 80,160,192,80
s_mov_b32 s10,9216
RD 144,4,5120
s_waitcnt lgkmcnt(11)
MV 80,164,200,80
s_and_b32 s50,s2,2
RD 148,4,14336
s_waitcnt lgkmcnt(11)
MV 80,168,208,80
s_lshl_b32 s50,s50,2
RD 152,4,23552
s_waitcnt lgkmcnt(11)
MV 80,172,216,80
s_lshr_b32 s51,s2,5
RD 156,4,32768
MV 84,172,220,84
MV 84,168,212,84
buffer_load_dwordx4 v60,s[16:19],s36 offen offset:2048 sc1 lds
MV 84,164,204,84
MV 84,160,196,84
s_waitcnt lgkmcnt(11)
MV 92,176,196,92
s_add_u32 s50,s50,s51
RD 160,4,6144
s_waitcnt lgkmcnt(11)
MV 92,180,204,92
s_mov_b32 s45,81920
RD 164,4,15360
s_waitcnt lgkmcnt(11)
MV 92,184,212,92
s_lshl_b32 s50,s50,2
buffer_load_dwordx4 a[128:131],v17,s[12:15],s45 offen sc1
s_waitcnt lgkmcnt(10)
MV 92,188,220,92
s_add_u32 s50,s50,s32
RD 168,4,24576
MV 88,188,216,88
RD 172,4,33792
MV 88,184,208,88
MV 88,180,200,88
buffer_load_dwordx4 a[132:135],v27,s[12:15],s45 offen sc1
MV 88,176,192,88
s_waitcnt lgkmcnt(11)
MV 96,128,192,96
s_lshl_b32 s50,s50,1
RD 176,4,7168
s_waitcnt lgkmcnt(11)
MV 96,132,200,96
s_and_b32 s51,s2,1
buffer_load_dwordx4 v60,s[16:19],s36 offen offset:3072 sc1 lds
s_waitcnt lgkmcnt(10)
MV 96,136,208,96
s_add_u32 s50,s50,s51
RD 180,4,16384
s_waitcnt lgkmcnt(10)
MV 96,140,216,96
s_mul_i32 s50,s50,36864
RD 184,4,25600
MV 100,140,220,100
s_add_u32 s36,s41,376832
RD 188,4,34816
MV 100,136,212,100
s_add_u32 m0,s41,81920
MV 100,132,204,100
buffer_load_dwordx4 v60,s[16:19],s36 offen offset:0 sc1 lds
MV 100,128,196,100
s_waitcnt lgkmcnt(11)
MV 108,144,196,108
s_bfe_u32 s51,s2,0x10002
RD 128,4,8192
s_waitcnt lgkmcnt(11)
MV 108,148,204,108
s_mov_b32 s45,86016
RD 132,4,17408
s_waitcnt lgkmcnt(11)
MV 108,152,212,108
s_mul_i32 s51,s51,1152
buffer_load_dwordx4 a[136:139],v17,s[12:15],s45 offen sc1
s_waitcnt lgkmcnt(10)
MV 108,156,220,108
s_add_u32 s50,s50,s51
RD 136,4,26624
MV 104,156,216,104
RD 140,4,35840
MV 104,152,208,104
buffer_load_dwordx4 a[140:143],v27,s[12:15],s45 offen sc1
MV 104,148,200,104
s_add_u32 s36,s41,405504
MV 104,144,192,104
s_add_u32 m0,s41,110592
s_waitcnt lgkmcnt(11)
MV 112,160,192,112
s_bfe_u32 s51,s2,0x20003
buffer_load_dwordx4 v60,s[16:19],s36 offen offset:0 sc1 lds
s_waitcnt lgkmcnt(10)
MV 112,164,200,112
s_mul_i32 s51,s51,288
s_waitcnt lgkmcnt(9)
MV 112,168,208,112
s_add_u32 s50,s50,s51
s_waitcnt lgkmcnt(8)
MV 112,172,216,112
s_add_u32 s28,s54,s50
s_addc_u32 s29,s55,0
buffer_load_dwordx4 v60,s[16:19],s36 offen offset:1024 sc1 lds
MV 116,172,220,116
s_waitcnt vmcnt(21) lgkmcnt(0)
s_barrier
RD 144,4,36864
MV 116,168,212,116
RD 148,4,46080
MV 116,164,204,116
RD 152,4,55296
MV 116,160,196,116
RD 156,4,64512
MV 124,176,196,124
s_mov_b32 s45,90112
RD 160,4,37888
MV 124,180,204,124
s_mov_b32 s30,34848
buffer_load_dwordx4 a[144:147],v17,s[12:15],s45 offen sc1
MV 124,184,212,124
RD 164,4,47104
MV 124,188,220,124
RD 168,4,56320
MV 120,188,216,120
RD 172,5,0
MV 120,184,208,120
MV 120,180,200,120
buffer_load_dwordx4 a[148:151],v27,s[12:15],s45 offen sc1
MV 120,176,192,120
MV 200,128,192,200
RD 176,4,38912
MV 200,132,200,200
RD 180,4,48128
MV 200,136,208,200
buffer_load_dwordx4 v60,s[16:19],s36 offen offset:2048 sc1 lds
MV 200,140,216,200
RD 184,4,57344
MV 204,140,220,204
RD 188,5,1024
MV 204,136,212,204
buffer_load_dwordx4 v60,s[16:19],s36 offen offset:3072 sc1 lds
MV 204,132,204,204
MV 204,128,196,204
s_waitcnt lgkmcnt(11)
MV 64,144,224,64
s_waitcnt vmcnt(24) lgkmcnt(10)
RD 128,4,39936
s_movk_i32 s35,2304
s_movk_i32 s44,4096
MV 64,148,232,64
s_waitcnt vmcnt(20) lgkmcnt(10)
RD 132,4,49152
v_lshlrev_b32 v31,13,v1
MV 64,152,240,64
s_mov_b32 s45,94208
RD 136,4,58368
v_and_b32 v29,15,v2
s_waitcnt vmcnt(16) lgkmcnt(11)
MV 64,156,248,64
s_waitcnt vmcnt(15)
buffer_load_dwordx4 a[152:155],v17,s[12:15],s45 offen sc1
v_mul_u32_u24 v29,304,v29
MV 68,156,252,68
RD 140,5,2048
v_lshrrev_b32 v30,4,v2
MV 68,152,244,68
v_lshl_add_u32 v29,v30,3,v29
MV 68,148,236,68
v_add_u32 v39,v29,v31
MV 68,144,228,68
s_waitcnt lgkmcnt(11)
v_add_u32 v37,0x1000,v60
MV 76,160,228,76
s_waitcnt lgkmcnt(10)
buffer_load_dwordx4 a[156:159],v27,s[12:15],s45 offen sc1
v_lshl_add_u32 v38,v2,3,s44
MV 76,164,236,76
s_waitcnt lgkmcnt(9)
RD 144,4,40960
v_add_u32 v28,0,v2
MV 76,168,244,76
s_add_u32 s36,s41,409600
RD 148,4,50176
v_mul_u32_u24 v29,3641,v28
s_waitcnt lgkmcnt(10)
MV 76,172,252,76
s_add_u32 m0,s41,114688
RD 152,4,59392
v_lshrrev_b32 v29,16,v29
MV 72,172,248,72
buffer_load_dwordx4 v60,s[16:19],s36 offen offset:0 sc1 lds
v_mul_u32_u24 v30,18,v29
MV 72,168,240,72
RD 156,5,3072
v_sub_u32 v30,v28,v30
MV 72,164,232,72
v_lshlrev_b32 v30,4,v30
MV 72,160,224,72
s_waitcnt lgkmcnt(11)
buffer_load_dwordx4 v60,s[16:19],s36 offen offset:1024 sc1 lds
v_mad_u32_u24 v32,v29,s35,v30
MV 80,176,224,80
s_waitcnt lgkmcnt(10)
RD 160,4,41984
v_mul_u32_u24 v29,304,v29
MV 80,180,232,80
s_waitcnt lgkmcnt(10)
RD 164,4,51200
v_add3_u32 v44,v29,v30,v31
MV 80,184,240,80
s_waitcnt lgkmcnt(10)
RD 168,4,60416
v_add_u32 v28,64,v2
MV 80,188,248,80
RD 172,5,4096
v_mul_u32_u24 v29,3641,v28
MV 84,188,252,84
v_lshrrev_b32 v29,16,v29
MV 84,184,244,84
buffer_load_dwordx4 v60,s[16:19],s36 offen offset:2048 sc1 lds
v_mul_u32_u24 v30,18,v29
MV 84,180,236,84
v_sub_u32 v30,v28,v30
MV 84,176,228,84
s_waitcnt lgkmcnt(11)
v_lshlrev_b32 v30,4,v30
MV 92,128,228,92
s_waitcnt lgkmcnt(10)
RD 176,4,43008
v_mad_u32_u24 v33,v29,s35,v30
MV 92,132,236,92
s_mov_b32 s45,114688
RD 180,4,52224
v_mul_u32_u24 v29,304,v29
s_waitcnt lgkmcnt(11)
MV 92,136,244,92
s_waitcnt lgkmcnt(10)
buffer_load_dwordx4 a[160:163],v17,s[12:15],s45 offen sc1
v_add3_u32 v45,v29,v30,v31
MV 92,140,252,92
RD 184,4,61440
MV 88,140,248,88
RD 188,5,5120
MV 88,136,240,88
MV 88,132,232,88
buffer_load_dwordx4 a[164:167],v27,s[12:15],s45 offen sc1
MV 88,128,224,88
s_waitcnt lgkmcnt(11)
MV 96,144,224,96
s_waitcnt lgkmcnt(10)
RD 128,4,44032
MV 96,148,232,96
s_waitcnt lgkmcnt(10)
buffer_load_dwordx4 v60,s[16:19],s36 offen offset:3072 sc1 lds
MV 96,152,240,96
s_waitcnt lgkmcnt(9)
RD 132,4,53248
MV 96,156,248,96
RD 136,4,62464
MV 100,156,252,100
s_add_u32 s36,s41,413696
RD 140,5,6144
v_add_u32 v28,128,v2
MV 100,152,244,100
s_add_u32 m0,s41,118784
v_mul_u32_u24 v29,3641,v28
MV 100,148,236,100
buffer_load_dwordx4 v60,s[16:19],s36 offen offset:0 sc1 lds
v_lshrrev_b32 v29,16,v29
MV 100,144,228,100
s_waitcnt lgkmcnt(11)
v_mul_u32_u24 v30,18,v29
MV 108,160,228,108
s_waitcnt lgkmcnt(10)
RD 144,4,45056
v_sub_u32 v30,v28,v30
MV 108,164,236,108
s_mov_b32 s45,118784
RD 148,4,54272
v_lshlrev_b32 v30,4,v30
s_waitcnt lgkmcnt(11)
MV 108,168,244,108
s_waitcnt lgkmcnt(10)
buffer_load_dwordx4 a[168:171],v17,s[12:15],s45 offen sc1
v_mad_u32_u24 v34,v29,s35,v30
MV 108,172,252,108
RD 152,4,63488
v_mul_u32_u24 v29,304,v29
MV 104,172,248,104
RD 156,5,7168
v_add3_u32 v46,v29,v30,v31
MV 104,168,240,104
buffer_load_dwordx4 a[172:175],v27,s[12:15],s45 offen sc1
MV 104,164,232,104
s_add_u32 s36,s41,442368
MV 104,160,224,104
s_add_u32 m0,s41,0
s_waitcnt lgkmcnt(11)
MV 112,176,224,112
s_waitcnt lgkmcnt(10)
buffer_load_dwordx4 v60,s[16:19],s36 offen offset:0 sc1 lds
MV 112,180,232,112
s_waitcnt lgkmcnt(9)
MV 112,184,240,112
s_waitcnt lgkmcnt(8)
MV 112,188,248,112
buffer_load_dwordx4 v60,s[16:19],s36 offen offset:1024 sc1 lds
MV 116,188,252,116
s_waitcnt vmcnt(21) lgkmcnt(0)
s_barrier
RD 160,5,8192
MV 116,184,244,116
RD 164,5,17408
buffer_load_dword v62,v41,s[24:27],0 offen offset:64 sc1
MV 116,180,236,116
RD 168,5,26624
v_add_u32 v28,192,v2
MV 116,176,228,116
RD 172,5,35840
v_mul_u32_u24 v29,3641,v28
MV 124,128,228,124
s_mov_b32 s45,122880
RD 176,5,9216
v_lshrrev_b32 v29,16,v29
MV 124,132,236,124
buffer_load_dwordx4 a[176:179],v17,s[12:15],s45 offen sc1
v_mul_u32_u24 v30,18,v29
MV 124,136,244,124
RD 180,5,18432
v_sub_u32 v30,v28,v30
MV 124,140,252,124
RD 184,5,27648
v_lshlrev_b32 v30,4,v30
MV 120,140,248,120
RD 188,5,36864
v_mad_u32_u24 v35,v29,s35,v30
MV 120,136,240,120
v_mul_u32_u24 v29,304,v29
MV 120,132,232,120
buffer_load_dwordx4 a[180:183],v27,s[12:15],s45 offen sc1
v_add3_u32 v47,v29,v30,v31
MV 120,128,224,120
MV 200,144,224,200
RD 128,5,10240
MV 200,148,232,200
RD 132,5,19456
MV 200,152,240,200
buffer_load_dwordx4 v60,s[16:19],s36 offen offset:2048 sc1 lds
MV 200,156,248,200
RD 136,5,28672
MV 204,156,252,204
RD 140,5,37888
MV 204,152,244,204
buffer_load_dwordx4 v60,s[16:19],s36 offen offset:3072 sc1 lds
MV 204,148,236,204
MV 204,144,228,204
s_waitcnt lgkmcnt(11)
MV 64,160,128,64
s_waitcnt vmcnt(25) lgkmcnt(10)
RD 144,5,11264
v_add_u32 v28,256,v2
MV 64,164,136,64
s_waitcnt vmcnt(21) lgkmcnt(10)
RD 148,5,20480
v_mul_u32_u24 v29,3641,v28
MV 64,168,144,64
s_mov_b32 s45,126976
RD 152,5,29696
v_lshrrev_b32 v29,16,v29
s_waitcnt vmcnt(17) lgkmcnt(11)
MV 64,172,152,64
s_waitcnt vmcnt(16)
buffer_load_dwordx4 a[184:187],v17,s[12:15],s45 offen sc1
v_mul_u32_u24 v30,18,v29
MV 68,172,156,68
RD 156,5,38912
v_sub_u32 v30,v28,v30
MV 68,168,148,68
v_lshlrev_b32 v30,4,v30
MV 68,164,140,68
v_mad_u32_u24 v36,v29,s35,v30
MV 68,160,132,68
s_waitcnt lgkmcnt(11)
v_mul_u32_u24 v29,304,v29
MV 76,176,132,76
s_waitcnt lgkmcnt(10)
buffer_load_dwordx4 a[188:191],v27,s[12:15],s45 offen sc1
v_add3_u32 v48,v29,v30,v31
MV 76,180,140,76
s_waitcnt lgkmcnt(9)
RD 160,5,12288
MV 76,184,148,76
s_add_u32 s36,s41,446464
RD 164,5,21504
s_waitcnt lgkmcnt(10)
MV 76,188,156,76
s_add_u32 m0,s41,4096
RD 168,5,30720
MV 72,188,152,72
buffer_load_dwordx4 v60,s[16:19],s36 offen offset:0 sc1 lds
MV 72,184,144,72
RD 172,5,39936
MV 72,180,136,72
MV 72,176,128,72
s_waitcnt lgkmcnt(11)
buffer_load_dwordx4 v60,s[16:19],s36 offen offset:1024 sc1 lds
MV 80,128,128,80
s_waitcnt lgkmcnt(10)
RD 176,5,13312
MV 80,132,136,80
s_waitcnt lgkmcnt(10)
RD 180,5,22528
MV 80,136,144,80
s_waitcnt lgkmcnt(10)
RD 184,5,31744
MV 80,140,152,80
RD 188,5,40960
MV 84,140,156,84
MV 84,136,148,84
buffer_load_dwordx4 v60,s[16:19],s36 offen offset:2048 sc1 lds
MV 84,132,140,84
MV 84,128,132,84
s_waitcnt lgkmcnt(11)
MV 92,144,132,92
s_waitcnt lgkmcnt(10)
RD 128,5,14336
MV 92,148,140,92
s_mov_b32 s45,147456
RD 132,5,23552
s_waitcnt lgkmcnt(11)
MV 92,152,148,92
s_waitcnt lgkmcnt(10)
buffer_load_dwordx4 a[192:195],v17,s[12:15],s45 offen sc1
MV 92,156,156,92
RD 136,5,32768
MV 88,156,152,88
RD 140,5,41984
MV 88,152,144,88
MV 88,148,136,88
buffer_load_dwordx4 a[196:199],v27,s[12:15],s45 offen sc1
MV 88,144,128,88
s_waitcnt lgkmcnt(11)
MV 96,160,128,96
s_waitcnt lgkmcnt(10)
RD 144,5,15360
MV 96,164,136,96
s_waitcnt lgkmcnt(10)
buffer_load_dwordx4 v60,s[16:19],s36 offen offset:3072 sc1 lds
MV 96,168,144,96
s_waitcnt lgkmcnt(9)
RD 148,5,24576
MV 96,172,152,96
RD 152,5,33792
MV 100,172,156,100
s_add_u32 s36,s41,450560
RD 156,5,43008
MV 100,168,148,100
s_add_u32 m0,s41,8192
MV 100,164,140,100
buffer_load_dwordx4 v60,s[16:19],s36 offen offset:0 sc1 lds
MV 100,160,132,100
s_waitcnt lgkmcnt(11)
MV 108,176,132,108
s_waitcnt lgkmcnt(10)
RD 160,5,16384
MV 108,180,140,108
s_mov_b32 s45,151552
RD 164,5,25600
s_waitcnt lgkmcnt(11)
MV 108,184,148,108
s_waitcnt lgkmcnt(10)
buffer_load_dwordx4 a[200:203],v17,s[12:15],s45 offen sc1
MV 108,188,156,108
RD 168,5,34816
MV 104,188,152,104
RD 172,5,44032
MV 104,184,144,104
buffer_load_dwordx4 a[204:207],v27,s[12:15],s45 offen sc1
MV 104,180,136,104
s_add_u32 s36,s41,479232
MV 104,176,128,104
s_add_u32 m0,s41,36864
s_waitcnt lgkmcnt(11)
MV 112,128,128,112
s_waitcnt lgkmcnt(10)
buffer_load_dwordx4 v60,s[16:19],s36 offen offset:0 sc1 lds
MV 112,132,136,112
s_waitcnt lgkmcnt(9)
MV 112,136,144,112
s_waitcnt lgkmcnt(8)
MV 112,140,152,112
buffer_load_dwordx4 v60,s[16:19],s36 offen offset:1024 sc1 lds
MV 116,140,156,116
s_waitcnt vmcnt(22) lgkmcnt(0)
s_barrier
RD 176,5,45056
MV 116,136,148,116
RD 180,5,54272
MV 116,132,140,116
RD 184,5,63488
MV 116,128,132,116
RD 188,6,7168
MV 124,144,132,124
s_mov_b32 s45,155648
RD 128,5,46080
MV 124,148,140,124
buffer_load_dwordx4 a[208:211],v17,s[12:15],s45 offen sc1
MV 124,152,148,124
RD 132,5,55296
MV 124,156,156,124
RD 136,5,64512
MV 120,156,152,120
RD 140,6,8192
MV 120,152,144,120
MV 120,148,136,120
buffer_load_dwordx4 a[212:215],v27,s[12:15],s45 offen sc1
MV 120,144,128,120
MV 200,160,128,200
RD 144,5,47104
MV 200,164,136,200
RD 148,5,56320
MV 200,168,144,200
buffer_load_dwordx4 v60,s[16:19],s36 offen offset:2048 sc1 lds
MV 200,172,152,200
RD 152,6,0
MV 204,172,156,204
RD 156,6,9216
MV 204,168,148,204
buffer_load_dwordx4 v60,s[16:19],s36 offen offset:3072 sc1 lds
s_waitcnt vmcnt(21)
v_cmp_eq_u32 vcc,0,v62
s_nop 0
s_cbranch_vccnz L_spin_d
L_back_d:
MV 204,164,140,204
v_readfirstlane_b32 s47,v62
v_xor_b32 v3,128,v3
MV 204,160,132,204
s_waitcnt lgkmcnt(11)
MV 64,176,160,64
s_sub_u32 s47,s47,1
RD 160,5,48128
s_waitcnt lgkmcnt(11)
MV 64,180,168,64
s_min_u32 s47,s47,4
RD 164,5,57344
s_waitcnt vmcnt(20) lgkmcnt(11)
MV 64,184,176,64
s_mov_b32 s45,159744
RD 168,6,1024
s_waitcnt vmcnt(16) lgkmcnt(11)
MV 64,188,184,64
s_bitcmp1_b32 s2,0
s_cselect_b32 s50,0,1179648
buffer_load_dwordx4 a[216:219],v17,s[12:15],s45 offen sc1
s_waitcnt vmcnt(16)
MV 68,188,188,68
RD 172,6,10240
MV 68,184,180,68
MV 68,180,172,68
MV 68,176,164,68
s_waitcnt lgkmcnt(11)
MV 76,128,164,76
s_mul_i32 s6,s47,36864
buffer_load_dwordx4 a[220:223],v27,s[12:15],s45 offen sc1
s_waitcnt lgkmcnt(10)
MV 76,132,172,76
s_add_u32 s4,s16,s50
s_addc_u32 s5,s17,0
RD 176,5,49152
s_waitcnt lgkmcnt(10)
MV 76,136,180,76
s_add_u32 s36,s41,483328
RD 180,5,58368
s_waitcnt lgkmcnt(10)
MV 76,140,188,76
s_add_u32 m0,s41,40960
RD 184,6,2048
MV 72,140,184,72
buffer_load_dwordx4 v60,s[16:19],s36 offen offset:0 sc1 lds
MV 72,136,176,72
RD 188,6,11264
MV 72,132,168,72
MV 72,128,160,72
s_waitcnt lgkmcnt(11)
buffer_load_dwordx4 v60,s[16:19],s36 offen offset:1024 sc1 lds
MV 80,144,160,80
s_sub_u32 s4,s4,s6
s_subb_u32 s5,s5,0
RD 128,5,50176
s_waitcnt lgkmcnt(11)
MV 80,148,168,80
s_bitcmp1_b32 s2,0
s_cselect_b32 s50,0,524288
RD 132,5,59392
s_waitcnt lgkmcnt(11)
MV 80,152,176,80
s_add_u32 s50,s50,16384
RD 136,6,3072
s_waitcnt lgkmcnt(11)
MV 80,156,184,80
s_lshl_b32 s51,s47,15
RD 140,6,12288
MV 84,156,188,84
MV 84,152,180,84
buffer_load_dwordx4 v60,s[16:19],s36 offen offset:2048 sc1 lds
MV 84,148,172,84
MV 84,144,164,84
s_waitcnt lgkmcnt(11)
MV 92,160,164,92
s_add_u32 s92,s12,s50
s_addc_u32 s93,s13,0
RD 144,5,51200
s_waitcnt lgkmcnt(11)
MV 92,164,172,92
s_mov_b32 s45,180224
RD 148,5,60416
s_waitcnt lgkmcnt(11)
MV 92,168,180,92
s_sub_u32 s92,s92,s51
s_subb_u32 s93,s93,0
buffer_load_dwordx4 a[224:227],v17,s[12:15],s45 offen sc1
s_waitcnt lgkmcnt(10)
MV 92,172,188,92
s_max_u32 s51,s51,18432
RD 152,6,4096
MV 88,172,184,88
RD 156,6,13312
MV 88,168,176,88
MV 88,164,168,88
buffer_load_dwordx4 a[228:231],v27,s[12:15],s45 offen sc1
MV 88,160,160,88
s_waitcnt lgkmcnt(11)
MV 96,176,160,96
s_sub_u32 s94,s51,18432
RD 160,5,52224
s_waitcnt lgkmcnt(11)
MV 96,180,168,96
s_mov_b32 s95,0x20000
buffer_load_dwordx4 v60,s[16:19],s36 offen offset:3072 sc1 lds
s_waitcnt lgkmcnt(10)
MV 96,184,176,96
s_cmp_eq_u32 s47,0
s_cselect_b32 s50,s46,0
RD 164,5,61440
s_waitcnt lgkmcnt(10)
MV 96,188,184,96
s_add_u32 s47,s47,4
RD 168,6,5120
MV 100,188,188,100
s_add_u32 s36,s41,487424
RD 172,6,14336
MV 100,184,180,100
s_add_u32 m0,s41,45056
MV 100,180,172,100
buffer_load_dwordx4 v60,s[16:19],s36 offen offset:0 sc1 lds
MV 100,176,164,100
s_waitcnt lgkmcnt(11)
MV 108,128,164,108
s_sub_u32 s47,s47,s50
RD 176,5,53248
s_waitcnt lgkmcnt(11)
MV 108,132,172,108
s_mov_b32 s45,184320
RD 180,5,62464
s_waitcnt lgkmcnt(11)
MV 108,136,180,108
s_waitcnt lgkmcnt(10)
buffer_load_dwordx4 a[232:235],v17,s[12:15],s45 offen sc1
MV 108,140,188,108
RD 184,6,6144
MV 104,140,184,104
RD 188,6,15360
MV 104,136,176,104
buffer_load_dwordx4 a[236:239],v27,s[12:15],s45 offen sc1
MV 104,132,168,104
s_add_u32 s36,s41,516096
MV 104,128,160,104
s_add_u32 m0,s41,73728
s_waitcnt lgkmcnt(11)
MV 112,144,160,112
s_waitcnt lgkmcnt(10)
buffer_load_dwordx4 v60,s[16:19],s36 offen offset:0 sc1 lds
MV 112,148,168,112
s_waitcnt lgkmcnt(9)
MV 112,152,176,112
s_waitcnt lgkmcnt(8)
MV 112,156,184,112
buffer_load_dwordx4 v60,s[16:19],s36 offen offset:1024 sc1 lds
MV 116,156,188,116
s_waitcnt vmcnt(21) lgkmcnt(0)
s_barrier
RD 128,4,0
MV 116,152,180,116
RD 132,4,9216
MV 116,148,172,116
RD 136,4,18432
MV 116,144,164,116
RD 140,4,27648
MV 124,160,164,124
s_mov_b32 s45,188416
RD 144,4,1024
MV 124,164,172,124
buffer_load_dwordx4 a[240:243],v17,s[12:15],s45 offen sc1
MV 124,168,180,124
RD 148,4,10240
MV 124,172,188,124
RD 152,4,19456
MV 120,172,184,120
RD 156,4,28672
MV 120,168,176,120
MV 120,164,168,120
buffer_load_dwordx4 a[244:247],v27,s[12:15],s45 offen sc1
MV 120,160,160,120
MV 200,176,160,200
RD 160,4,2048
MV 200,180,168,200
RD 164,4,11264
MV 200,184,176,200
buffer_load_dwordx4 v60,s[16:19],s36 offen offset:2048 sc1 lds
MV 200,188,184,200
RD 168,4,20480
MV 204,188,188,204
RD 172,4,29696
MV 204,184,180,204
buffer_load_dwordx4 v60,s[16:19],s36 offen offset:3072 sc1 lds
MV 204,180,172,204
MV 204,176,164,204
s_sub_u32 s47,s47,1
s_cbranch_scc1 L_xchg
s_waitcnt lgkmcnt(11)
MV 64,128,192,64
s_waitcnt vmcnt(24) lgkmcnt(10)
RD 176,4,3072
MV 64,132,200,64
s_waitcnt vmcnt(20) lgkmcnt(10)
RD 180,4,12288
MV 64,136,208,64
s_mov_b32 s45,192512
RD 184,4,21504
s_waitcnt vmcnt(16) lgkmcnt(11)
MV 64,140,216,64
s_waitcnt vmcnt(15)
buffer_load_dwordx4 a[248:251],v17,s[12:15],s45 offen sc1
MV 68,140,220,68
RD 188,4,30720
MV 68,136,212,68
MV 68,132,204,68
MV 68,128,196,68
s_waitcnt lgkmcnt(11)
MV 76,144,196,76
s_waitcnt lgkmcnt(10)
buffer_load_dwordx4 a[252:255],v27,s[12:15],s45 offen sc1
MV 76,148,204,76
s_waitcnt lgkmcnt(9)
RD 128,4,4096
MV 76,152,212,76
s_add_u32 s36,s41,520192
RD 132,4,13312
s_waitcnt lgkmcnt(10)
MV 76,156,220,76
s_add_u32 m0,s41,77824
RD 136,4,22528
MV 72,156,216,72
buffer_load_dwordx4 v60,s[16:19],s36 offen offset:0 sc1 lds
MV 72,152,208,72
RD 140,4,31744
MV 72,148,200,72
MV 72,144,192,72
s_waitcnt lgkmcnt(11)
buffer_load_dwordx4 v60,s[16:19],s36 offen offset:1024 sc1 lds
MV 80,160,192,80
s_waitcnt lgkmcnt(10)
RD 144,4,5120
MV 80,164,200,80
s_waitcnt lgkmcnt(10)
RD 148,4,14336
MV 80,168,208,80
s_waitcnt lgkmcnt(10)
RD 152,4,23552
MV 80,172,216,80
RD 156,4,32768
MV 84,172,220,84
MV 84,168,212,84
buffer_load_dwordx4 v60,s[16:19],s36 offen offset:2048 sc1 lds
MV 84,164,204,84
MV 84,160,196,84
s_waitcnt lgkmcnt(11)
MV 92,176,196,92
s_waitcnt lgkmcnt(10)
RD 160,4,6144
MV 92,180,204,92
s_mov_b32 s45,212992
RD 164,4,15360
s_waitcnt lgkmcnt(11)
MV 92,184,212,92
s_waitcnt lgkmcnt(10)
buffer_load_dwordx4 a[128:131],v17,s[12:15],s45 offen sc1
MV 92,188,220,92
RD 168,4,24576
MV 88,188,216,88
RD 172,4,33792
MV 88,184,208,88
MV 88,180,200,88
buffer_load_dwordx4 a[132:135],v27,s[12:15],s45 offen sc1
MV 88,176,192,88
s_waitcnt lgkmcnt(11)
MV 96,128,192,96
s_waitcnt lgkmcnt(10)
RD 176,4,7168
MV 96,132,200,96
s_waitcnt lgkmcnt(10)
buffer_load_dwordx4 v60,s[16:19],s36 offen offset:3072 sc1 lds
MV 96,136,208,96
s_waitcnt lgkmcnt(9)
RD 180,4,16384
MV 96,140,216,96
RD 184,4,25600
MV 100,140,220,100
s_add_u32 s36,s41,524288
RD 188,4,34816
MV 100,136,212,100
s_add_u32 m0,s41,81920
MV 100,132,204,100
buffer_load_dwordx4 v60,s[16:19],s36 offen offset:0 sc1 lds
MV 100,128,196,100
s_waitcnt lgkmcnt(11)
MV 108,144,196,108
s_waitcnt lgkmcnt(10)
RD 128,4,8192
MV 108,148,204,108
s_mov_b32 s45,217088
RD 132,4,17408
s_waitcnt lgkmcnt(11)
MV 108,152,212,108
s_waitcnt lgkmcnt(10)
buffer_load_dwordx4 a[136:139],v17,s[12:15],s45 offen sc1
MV 108,156,220,108
RD 136,4,26624
MV 104,156,216,104
RD 140,4,35840
MV 104,152,208,104
buffer_load_dwordx4 a[140:143],v27,s[12:15],s45 offen sc1
MV 104,148,200,104
s_add_u32 s36,s41,552960
MV 104,144,192,104
s_add_u32 m0,s41,110592
s_waitcnt lgkmcnt(11)
MV 112,160,192,112
s_waitcnt lgkmcnt(10)
buffer_load_dwordx4 v60,s[16:19],s36 offen offset:0 sc1 lds
MV 112,164,200,112
s_waitcnt lgkmcnt(9)
MV 112,168,208,112
s_waitcnt lgkmcnt(8)
MV 112,172,216,112
buffer_load_dwordx4 v60,s[16:19],s36 offen offset:1024 sc1 lds
MV 116,172,220,116
s_waitcnt vmcnt(21) lgkmcnt(0)
s_barrier
RD 144,4,36864
MV 116,168,212,116
RD 148,4,46080
MV 116,164,204,116
RD 152,4,55296
MV 116,160,196,116
RD 156,4,64512
MV 124,176,196,124
s_mov_b32 s45,221184
RD 160,4,37888
MV 124,180,204,124
buffer_load_dwordx4 a[144:147],v17,s[12:15],s45 offen sc1
MV 124,184,212,124
RD 164,4,47104
MV 124,188,220,124
RD 168,4,56320
MV 120,188,216,120
RD 172,5,0
MV 120,184,208,120
MV 120,180,200,120
buffer_load_dwordx4 a[148:151],v27,s[12:15],s45 offen sc1
MV 120,176,192,120
MV 200,128,192,200
RD 176,4,38912
MV 200,132,200,200
RD 180,4,48128
MV 200,136,208,200
buffer_load_dwordx4 v60,s[16:19],s36 offen offset:2048 sc1 lds
MV 200,140,216,200
RD 184,4,57344
MV 204,140,220,204
RD 188,5,1024
MV 204,136,212,204
buffer_load_dwordx4 v60,s[16:19],s36 offen offset:3072 sc1 lds
MV 204,132,204,204
MV 204,128,196,204
s_sub_u32 s47,s47,1
s_cbranch_scc1 L_xchg
s_waitcnt lgkmcnt(11)
MV 64,144,224,64
s_waitcnt vmcnt(24) lgkmcnt(10)
RD 128,4,39936
MV 64,148,232,64
s_waitcnt vmcnt(20) lgkmcnt(10)
RD 132,4,49152
MV 64,152,240,64
s_mov_b32 s45,225280
RD 136,4,58368
s_waitcnt vmcnt(16) lgkmcnt(11)
MV 64,156,248,64
s_waitcnt vmcnt(15)
buffer_load_dwordx4 a[152:155],v17,s[12:15],s45 offen sc1
MV 68,156,252,68
RD 140,5,2048
MV 68,152,244,68
MV 68,148,236,68
MV 68,144,228,68
s_waitcnt lgkmcnt(11)
MV 76,160,228,76
s_waitcnt lgkmcnt(10)
buffer_load_dwordx4 a[156:159],v27,s[12:15],s45 offen sc1
MV 76,164,236,76
s_waitcnt lgkmcnt(9)
RD 144,4,40960
MV 76,168,244,76
s_add_u32 s36,s41,557056
RD 148,4,50176
s_waitcnt lgkmcnt(10)
MV 76,172,252,76
s_add_u32 m0,s41,114688
RD 152,4,59392
MV 72,172,248,72
buffer_load_dwordx4 v60,s[16:19],s36 offen offset:0 sc1 lds
MV 72,168,240,72
RD 156,5,3072
MV 72,164,232,72
MV 72,160,224,72
s_waitcnt lgkmcnt(11)
buffer_load_dwordx4 v60,s[16:19],s36 offen offset:1024 sc1 lds
MV 80,176,224,80
s_waitcnt lgkmcnt(10)
RD 160,4,41984
MV 80,180,232,80
s_waitcnt lgkmcnt(10)
RD 164,4,51200
buffer_load_dword v62,v3,s[24:27],0 offen offset:16 sc1
MV 80,184,240,80
s_waitcnt lgkmcnt(10)
RD 168,4,60416
MV 80,188,248,80
RD 172,5,4096
MV 84,188,252,84
MV 84,184,244,84
buffer_load_dwordx4 v60,s[16:19],s36 offen offset:2048 sc1 lds
MV 84,180,236,84
MV 84,176,228,84
s_waitcnt lgkmcnt(11)
MV 92,128,228,92
s_waitcnt lgkmcnt(10)
RD 176,4,43008
MV 92,132,236,92
s_mov_b32 s45,245760
RD 180,4,52224
s_waitcnt lgkmcnt(11)
MV 92,136,244,92
s_waitcnt lgkmcnt(10)
buffer_load_dwordx4 a[160:163],v17,s[12:15],s45 offen sc1
MV 92,140,252,92
RD 184,4,61440
MV 88,140,248,88
RD 188,5,5120
MV 88,136,240,88
MV 88,132,232,88
buffer_load_dwordx4 a[164:167],v27,s[12:15],s45 offen sc1
MV 88,128,224,88
s_waitcnt lgkmcnt(11)
MV 96,144,224,96
s_waitcnt lgkmcnt(10)
RD 128,4,44032
MV 96,148,232,96
s_waitcnt lgkmcnt(10)
buffer_load_dwordx4 v60,s[16:19],s36 offen offset:3072 sc1 lds
MV 96,152,240,96
s_waitcnt lgkmcnt(9)
RD 132,4,53248
MV 96,156,248,96
RD 136,4,62464
MV 100,156,252,100
s_add_u32 s36,s41,561152
RD 140,5,6144
MV 100,152,244,100
s_add_u32 m0,s41,118784
MV 100,148,236,100
buffer_load_dwordx4 v60,s[16:19],s36 offen offset:0 sc1 lds
MV 100,144,228,100
s_waitcnt lgkmcnt(11)
MV 108,160,228,108
s_waitcnt lgkmcnt(10)
RD 144,4,45056
MV 108,164,236,108
s_mov_b32 s45,249856
RD 148,4,54272
s_waitcnt lgkmcnt(11)
MV 108,168,244,108
s_waitcnt lgkmcnt(10)
buffer_load_dwordx4 a[168:171],v17,s[12:15],s45 offen sc1
MV 108,172,252,108
RD 152,4,63488
MV 104,172,248,104
RD 156,5,7168
MV 104,168,240,104
buffer_load_dwordx4 a[172:175],v27,s[12:15],s45 offen sc1
MV 104,164,232,104
s_add_u32 s36,s41,0
MV 104,160,224,104
s_add_u32 m0,s41,0
s_waitcnt lgkmcnt(11)
MV 112,176,224,112
s_waitcnt lgkmcnt(10)
buffer_load_dwordx4 v60,s[4:7],s36 offen offset:0 sc1 lds
MV 112,180,232,112
s_waitcnt lgkmcnt(9)
MV 112,184,240,112
s_waitcnt lgkmcnt(8)
MV 112,188,248,112
buffer_load_dwordx4 v60,s[4:7],s36 offen offset:1024 sc1 lds
MV 116,188,252,116
s_waitcnt vmcnt(22) lgkmcnt(0)
s_barrier
RD 160,5,8192
MV 116,184,244,116
RD 164,5,17408
MV 116,180,236,116
RD 168,5,26624
MV 116,176,228,116
RD 172,5,35840
MV 124,128,228,124
s_mov_b32 s45,253952
RD 176,5,9216
MV 124,132,236,124
buffer_load_dwordx4 a[176:179],v17,s[12:15],s45 offen sc1
MV 124,136,244,124
RD 180,5,18432
MV 124,140,252,124
RD 184,5,27648
MV 120,140,248,120
RD 188,5,36864
MV 120,136,240,120
MV 120,132,232,120
buffer_load_dwordx4 a[180:183],v27,s[12:15],s45 offen sc1
MV 120,128,224,120
MV 200,144,224,200
RD 128,5,10240
MV 200,148,232,200
RD 132,5,19456
MV 200,152,240,200
buffer_load_dwordx4 v60,s[4:7],s36 offen offset:2048 sc1 lds
MV 200,156,248,200
RD 136,5,28672
MV 204,156,252,204
RD 140,5,37888
MV 204,152,244,204
buffer_load_dwordx4 v60,s[4:7],s36 offen offset:3072 sc1 lds
MV 204,148,236,204
MV 204,144,228,204
s_sub_u32 s47,s47,1
s_cbranch_scc1 L_xchg
s_waitcnt lgkmcnt(11)
MV 64,160,128,64
s_waitcnt vmcnt(25) lgkmcnt(10)
RD 144,5,11264
MV 64,164,136,64
s_waitcnt vmcnt(21) lgkmcnt(10)
RD 148,5,20480
MV 64,168,144,64
s_mov_b32 s45,258048
RD 152,5,29696
s_waitcnt vmcnt(17) lgkmcnt(11)
MV 64,172,152,64
s_waitcnt vmcnt(16)
buffer_load_dwordx4 a[184:187],v17,s[12:15],s45 offen sc1
MV 68,172,156,68
RD 156,5,38912
MV 68,168,148,68
MV 68,164,140,68
MV 68,160,132,68
s_waitcnt lgkmcnt(11)
MV 76,176,132,76
s_waitcnt lgkmcnt(10)
buffer_load_dwordx4 a[188:191],v27,s[12:15],s45 offen sc1
MV 76,180,140,76
s_waitcnt lgkmcnt(9)
RD 160,5,12288
MV 76,184,148,76
s_add_u32 s36,s41,4096
RD 164,5,21504
s_waitcnt lgkmcnt(10)
MV 76,188,156,76
s_add_u32 m0,s41,4096
RD 168,5,30720
MV 72,188,152,72
buffer_load_dwordx4 v60,s[4:7],s36 offen offset:0 sc1 lds
MV 72,184,144,72
RD 172,5,39936
MV 72,180,136,72
MV 72,176,128,72
s_waitcnt lgkmcnt(11)
buffer_load_dwordx4 v60,s[4:7],s36 offen offset:1024 sc1 lds
MV 80,128,128,80
s_waitcnt lgkmcnt(10)
RD 176,5,13312
MV 80,132,136,80
RD 180,5,22528
s_waitcnt vmcnt(17)
v_cmp_ne_u32 vcc,1,v62
s_nop 0
s_cbranch_vccnz L_spin_f3
L_back_f3:
s_waitcnt lgkmcnt(11)
MV 80,136,144,80
s_waitcnt lgkmcnt(10)
RD 184,5,31744
MV 80,140,152,80
RD 188,5,40960
MV 84,140,156,84
MV 84,136,148,84
buffer_load_dwordx4 v60,s[4:7],s36 offen offset:2048 sc1 lds
MV 84,132,140,84
MV 84,128,132,84
s_waitcnt lgkmcnt(11)
MV 92,144,132,92
s_waitcnt lgkmcnt(10)
RD 128,5,14336
MV 92,148,140,92
s_mov_b32 s45,0
RD 132,5,23552
s_waitcnt lgkmcnt(11)
MV 92,152,148,92
s_waitcnt lgkmcnt(10)
buffer_load_dwordx4 a[192:195],v17,s[92:95],s45 offen sc1
MV 92,156,156,92
RD 136,5,32768
MV 88,156,152,88
RD 140,5,41984
MV 88,152,144,88
MV 88,148,136,88
buffer_load_dwordx4 a[196:199],v27,s[92:95],s45 offen sc1
MV 88,144,128,88
s_waitcnt lgkmcnt(11)
MV 96,160,128,96
s_waitcnt lgkmcnt(10)
RD 144,5,15360
MV 96,164,136,96
s_waitcnt lgkmcnt(10)
buffer_load_dwordx4 v60,s[4:7],s36 offen offset:3072 sc1 lds
MV 96,168,144,96
s_waitcnt lgkmcnt(9)
RD 148,5,24576
MV 96,172,152,96
RD 152,5,33792
MV 100,172,156,100
s_add_u32 s36,s41,8192
RD 156,5,43008
MV 100,168,148,100
s_add_u32 m0,s41,8192
MV 100,164,140,100
buffer_load_dwordx4 v60,s[4:7],s36 offen offset:0 sc1 lds
MV 100,160,132,100
s_waitcnt lgkmcnt(11)
MV 108,176,132,108
s_waitcnt lgkmcnt(10)
RD 160,5,16384
MV 108,180,140,108
s_mov_b32 s45,4096
RD 164,5,25600
s_waitcnt lgkmcnt(11)
MV 108,184,148,108
s_waitcnt lgkmcnt(10)
buffer_load_dwordx4 a[200:203],v17,s[92:95],s45 offen sc1
MV 108,188,156,108
RD 168,5,34816
MV 104,188,152,104
RD 172,5,44032
MV 104,184,144,104
buffer_load_dwordx4 a[204:207],v27,s[92:95],s45 offen sc1
MV 104,180,136,104
s_add_u32 s36,s41,36864
MV 104,176,128,104
s_add_u32 m0,s41,36864
s_waitcnt lgkmcnt(11)
MV 112,128,128,112
s_waitcnt lgkmcnt(10)
buffer_load_dwordx4 v60,s[4:7],s36 offen offset:0 sc1 lds
MV 112,132,136,112
s_waitcnt lgkmcnt(9)
MV 112,136,144,112
s_waitcnt lgkmcnt(8)
MV 112,140,152,112
buffer_load_dwordx4 v60,s[4:7],s36 offen offset:1024 sc1 lds
MV 116,140,156,116
s_waitcnt vmcnt(21) lgkmcnt(0)
s_barrier
RD 176,5,45056
MV 116,136,148,116
RD 180,5,54272
MV 116,132,140,116
RD 184,5,63488
MV 116,128,132,116
RD 188,6,7168
MV 124,144,132,124
s_mov_b32 s45,8192
RD 128,5,46080
MV 124,148,140,124
buffer_load_dwordx4 a[208:211],v17,s[92:95],s45 offen sc1
MV 124,152,148,124
RD 132,5,55296
MV 124,156,156,124
RD 136,5,64512
MV 120,156,152,120
RD 140,6,8192
MV 120,152,144,120
MV 120,148,136,120
buffer_load_dwordx4 a[212:215],v27,s[92:95],s45 offen sc1
MV 120,144,128,120
MV 200,160,128,200
RD 144,5,47104
MV 200,164,136,200
RD 148,5,56320
MV 200,168,144,200
buffer_load_dwordx4 v60,s[4:7],s36 offen offset:2048 sc1 lds
MV 200,172,152,200
RD 152,6,0
MV 204,172,156,204
RD 156,6,9216
MV 204,168,148,204
buffer_load_dwordx4 v60,s[4:7],s36 offen offset:3072 sc1 lds
MV 204,164,140,204
MV 204,160,132,204
s_sub_u32 s47,s47,1
s_cbranch_scc1 L_xchg
s_waitcnt lgkmcnt(11)
MV 64,176,160,64
s_waitcnt vmcnt(24) lgkmcnt(10)
RD 160,5,48128
MV 64,180,168,64
s_waitcnt vmcnt(20) lgkmcnt(10)
RD 164,5,57344
MV 64,184,176,64
s_mov_b32 s45,12288
RD 168,6,1024
s_waitcnt vmcnt(16) lgkmcnt(11)
MV 64,188,184,64
s_waitcnt vmcnt(15)
buffer_load_dwordx4 a[216:219],v17,s[92:95],s45 offen sc1
MV 68,188,188,68
RD 172,6,10240
MV 68,184,180,68
MV 68,180,172,68
MV 68,176,164,68
s_waitcnt lgkmcnt(11)
MV 76,128,164,76
s_waitcnt lgkmcnt(10)
buffer_load_dwordx4 a[220:223],v27,s[92:95],s45 offen sc1
MV 76,132,172,76
s_waitcnt lgkmcnt(9)
RD 176,5,49152
MV 76,136,180,76
s_add_u32 s36,s41,40960
RD 180,5,58368
s_waitcnt lgkmcnt(10)
MV 76,140,188,76
s_add_u32 m0,s41,40960
RD 184,6,2048
MV 72,140,184,72
buffer_load_dwordx4 v60,s[4:7],s36 offen offset:0 sc1 lds
MV 72,136,176,72
RD 188,6,11264
MV 72,132,168,72
MV 72,128,160,72
s_waitcnt lgkmcnt(11)
buffer_load_dwordx4 v60,s[4:7],s36 offen offset:1024 sc1 lds
MV 80,144,160,80
s_waitcnt lgkmcnt(10)
RD 128,5,50176
MV 80,148,168,80
s_waitcnt lgkmcnt(10)
RD 132,5,59392
MV 80,152,176,80
s_waitcnt lgkmcnt(10)
RD 136,6,3072
MV 80,156,184,80
RD 140,6,12288
MV 84,156,188,84
MV 84,152,180,84
buffer_load_dwordx4 v60,s[4:7],s36 offen offset:2048 sc1 lds
MV 84,148,172,84
MV 84,144,164,84
s_waitcnt lgkmcnt(11)
MV 92,160,164,92
s_waitcnt lgkmcnt(10)
RD 144,5,51200
MV 92,164,172,92
s_mov_b32 s45,32768
RD 148,5,60416
s_waitcnt lgkmcnt(11)
MV 92,168,180,92
s_waitcnt lgkmcnt(10)
buffer_load_dwordx4 a[224:227],v17,s[92:95],s45 offen sc1
MV 92,172,188,92
RD 152,6,4096
MV 88,172,184,88
RD 156,6,13312
MV 88,168,176,88
MV 88,164,168,88
buffer_load_dwordx4 a[228:231],v27,s[92:95],s45 offen sc1
MV 88,160,160,88
s_waitcnt lgkmcnt(11)
MV 96,176,160,96
s_waitcnt lgkmcnt(10)
RD 160,5,52224
MV 96,180,168,96
s_waitcnt lgkmcnt(10)
buffer_load_dwordx4 v60,s[4:7],s36 offen offset:3072 sc1 lds
MV 96,184,176,96
s_waitcnt lgkmcnt(9)
RD 164,5,61440
MV 96,188,184,96
RD 168,6,5120
MV 100,188,188,100
s_add_u32 s36,s41,45056
RD 172,6,14336
MV 100,184,180,100
s_add_u32 m0,s41,45056
MV 100,180,172,100
buffer_load_dwordx4 v60,s[4:7],s36 offen offset:0 sc1 lds
MV 100,176,164,100
s_waitcnt lgkmcnt(11)
MV 108,128,164,108
s_waitcnt lgkmcnt(10)
RD 176,5,53248
MV 108,132,172,108
s_mov_b32 s45,36864
RD 180,5,62464
s_waitcnt lgkmcnt(11)
MV 108,136,180,108
s_waitcnt lgkmcnt(10)
buffer_load_dwordx4 a[232:235],v17,s[92:95],s45 offen sc1
MV 108,140,188,108
RD 184,6,6144
MV 104,140,184,104
RD 188,6,15360
MV 104,136,176,104
buffer_load_dwordx4 a[236:239],v27,s[92:95],s45 offen sc1
MV 104,132,168,104
s_add_u32 s36,s41,73728
MV 104,128,160,104
s_add_u32 m0,s41,73728
s_waitcnt lgkmcnt(11)
MV 112,144,160,112
s_waitcnt lgkmcnt(10)
buffer_load_dwordx4 v60,s[4:7],s36 offen offset:0 sc1 lds
MV 112,148,168,112
s_waitcnt lgkmcnt(9)
MV 112,152,176,112
s_waitcnt lgkmcnt(8)
MV 112,156,184,112
buffer_load_dwordx4 v60,s[4:7],s36 offen offset:1024 sc1 lds
MV 116,156,188,116
s_waitcnt vmcnt(21) lgkmcnt(0)
s_barrier
RD 128,4,0
MV 116,152,180,116
RD 132,4,9216
MV 116,148,172,116
RD 136,4,18432
MV 116,144,164,116
RD 140,4,27648
MV 124,160,164,124
s_mov_b32 s45,40960
RD 144,4,1024
MV 124,164,172,124
buffer_load_dwordx4 a[240:243],v17,s[92:95],s45 offen sc1
MV 124,168,180,124
RD 148,4,10240
MV 124,172,188,124
RD 152,4,19456
MV 120,172,184,120
RD 156,4,28672
MV 120,168,176,120
MV 120,164,168,120
buffer_load_dwordx4 a[244:247],v27,s[92:95],s45 offen sc1
MV 120,160,160,120
MV 200,176,160,200
RD 160,4,2048
MV 200,180,168,200
RD 164,4,11264
MV 200,184,176,200
buffer_load_dwordx4 v60,s[4:7],s36 offen offset:2048 sc1 lds
MV 200,188,184,200
RD 168,4,20480
MV 204,188,188,204
RD 172,4,29696
MV 204,184,180,204
buffer_load_dwordx4 v60,s[4:7],s36 offen offset:3072 sc1 lds
MV 204,180,172,204
MV 204,176,164,204
s_sub_u32 s47,s47,1
s_cbranch_scc1 L_xchg
s_waitcnt lgkmcnt(11)
MV 64,128,192,64
s_waitcnt vmcnt(24) lgkmcnt(10)
RD 176,4,3072
MV 64,132,200,64
s_waitcnt vmcnt(20) lgkmcnt(10)
RD 180,4,12288
MV 64,136,208,64
s_mov_b32 s45,45056
RD 184,4,21504
s_waitcnt vmcnt(16) lgkmcnt(11)
MV 64,140,216,64
s_waitcnt vmcnt(15)
buffer_load_dwordx4 a[248:251],v17,s[92:95],s45 offen sc1
MV 68,140,220,68
RD 188,4,30720
MV 68,136,212,68
MV 68,132,204,68
MV 68,128,196,68
s_waitcnt lgkmcnt(11)
MV 76,144,196,76
s_waitcnt lgkmcnt(10)
buffer_load_dwordx4 a[252:255],v27,s[92:95],s45 offen sc1
MV 76,148,204,76
s_waitcnt lgkmcnt(9)
RD 128,4,4096
MV 76,152,212,76
s_add_u32 s36,s41,77824
RD 132,4,13312
s_waitcnt lgkmcnt(10)
MV 76,156,220,76
s_add_u32 m0,s41,77824
RD 136,4,22528
MV 72,156,216,72
buffer_load_dwordx4 v60,s[4:7],s36 offen offset:0 sc1 lds
MV 72,152,208,72
RD 140,4,31744
MV 72,148,200,72
MV 72,144,192,72
s_waitcnt lgkmcnt(11)
buffer_load_dwordx4 v60,s[4:7],s36 offen offset:1024 sc1 lds
MV 80,160,192,80
s_waitcnt lgkmcnt(10)
RD 144,4,5120
MV 80,164,200,80
s_waitcnt lgkmcnt(10)
RD 148,4,14336
MV 80,168,208,80
s_waitcnt lgkmcnt(10)
RD 152,4,23552
MV 80,172,216,80
RD 156,4,32768
MV 84,172,220,84
MV 84,168,212,84
buffer_load_dwordx4 v60,s[4:7],s36 offen offset:2048 sc1 lds
MV 84,164,204,84
MV 84,160,196,84
s_waitcnt lgkmcnt(11)
MV 92,176,196,92
s_waitcnt lgkmcnt(10)
RD 160,4,6144
MV 92,180,204,92
s_mov_b32 s45,65536
RD 164,4,15360
s_waitcnt lgkmcnt(11)
MV 92,184,212,92
s_waitcnt lgkmcnt(10)
buffer_load_dwordx4 a[128:131],v17,s[92:95],s45 offen sc1
MV 92,188,220,92
RD 168,4,24576
MV 88,188,216,88
RD 172,4,33792
MV 88,184,208,88
MV 88,180,200,88
buffer_load_dwordx4 a[132:135],v27,s[92:95],s45 offen sc1
MV 88,176,192,88
s_waitcnt lgkmcnt(11)
MV 96,128,192,96
s_waitcnt lgkmcnt(10)
RD 176,4,7168
MV 96,132,200,96
s_waitcnt lgkmcnt(10)
buffer_load_dwordx4 v60,s[4:7],s36 offen offset:3072 sc1 lds
MV 96,136,208,96
s_waitcnt lgkmcnt(9)
RD 180,4,16384
MV 96,140,216,96
RD 184,4,25600
MV 100,140,220,100
s_add_u32 s36,s41,81920
RD 188,4,34816
MV 100,136,212,100
s_add_u32 m0,s41,81920
MV 100,132,204,100
buffer_load_dwordx4 v60,s[4:7],s36 offen offset:0 sc1 lds
MV 100,128,196,100
s_waitcnt lgkmcnt(11)
MV 108,144,196,108
s_waitcnt lgkmcnt(10)
RD 128,4,8192
MV 108,148,204,108
s_mov_b32 s45,69632
RD 132,4,17408
s_waitcnt lgkmcnt(11)
MV 108,152,212,108
s_waitcnt lgkmcnt(10)
buffer_load_dwordx4 a[136:139],v17,s[92:95],s45 offen sc1
MV 108,156,220,108
RD 136,4,26624
MV 104,156,216,104
RD 140,4,35840
MV 104,152,208,104
buffer_load_dwordx4 a[140:143],v27,s[92:95],s45 offen sc1
MV 104,148,200,104
s_add_u32 s36,s41,110592
MV 104,144,192,104
s_add_u32 m0,s41,110592
s_waitcnt lgkmcnt(11)
MV 112,160,192,112
s_waitcnt lgkmcnt(10)
buffer_load_dwordx4 v60,s[4:7],s36 offen offset:0 sc1 lds
MV 112,164,200,112
s_waitcnt lgkmcnt(9)
MV 112,168,208,112
s_waitcnt lgkmcnt(8)
MV 112,172,216,112
buffer_load_dwordx4 v60,s[4:7],s36 offen offset:1024 sc1 lds
MV 116,172,220,116
s_waitcnt vmcnt(21) lgkmcnt(0)
s_barrier
RD 144,4,36864
MV 116,168,212,116
RD 148,4,46080
MV 116,164,204,116
RD 152,4,55296
MV 116,160,196,116
RD 156,4,64512
MV 124,176,196,124
s_mov_b32 s45,73728
RD 160,4,37888
MV 124,180,204,124
buffer_load_dwordx4 a[144:147],v17,s[92:95],s45 offen sc1
MV 124,184,212,124
RD 164,4,47104
MV 124,188,220,124
RD 168,4,56320
MV 120,188,216,120
RD 172,5,0
MV 120,184,208,120
MV 120,180,200,120
buffer_load_dwordx4 a[148:151],v27,s[92:95],s45 offen sc1
MV 120,176,192,120
MV 200,128,192,200
RD 176,4,38912
MV 200,132,200,200
RD 180,4,48128
MV 200,136,208,200
buffer_load_dwordx4 v60,s[4:7],s36 offen offset:2048 sc1 lds
MV 200,140,216,200
RD 184,4,57344
MV 204,140,220,204
RD 188,5,1024
MV 204,136,212,204
buffer_load_dwordx4 v60,s[4:7],s36 offen offset:3072 sc1 lds
MV 204,132,204,204
MV 204,128,196,204
s_sub_u32 s47,s47,1
s_cbranch_scc1 L_xchg
s_waitcnt lgkmcnt(11)
MV 64,144,224,64
s_waitcnt vmcnt(24) lgkmcnt(10)
RD 128,4,39936
MV 64,148,232,64
s_waitcnt vmcnt(20) lgkmcnt(10)
RD 132,4,49152
MV 64,152,240,64
s_mov_b32 s45,77824
RD 136,4,58368
s_waitcnt vmcnt(16) lgkmcnt(11)
MV 64,156,248,64
s_waitcnt vmcnt(15)
buffer_load_dwordx4 a[152:155],v17,s[92:95],s45 offen sc1
MV 68,156,252,68
RD 140,5,2048
MV 68,152,244,68
MV 68,148,236,68
MV 68,144,228,68
s_waitcnt lgkmcnt(11)
MV 76,160,228,76
s_waitcnt lgkmcnt(10)
buffer_load_dwordx4 a[156:159],v27,s[92:95],s45 offen sc1
MV 76,164,236,76
s_waitcnt lgkmcnt(9)
RD 144,4,40960
MV 76,168,244,76
s_add_u32 s36,s41,114688
RD 148,4,50176
s_waitcnt lgkmcnt(10)
MV 76,172,252,76
s_add_u32 m0,s41,114688
RD 152,4,59392
MV 72,172,248,72
buffer_load_dwordx4 v60,s[4:7],s36 offen offset:0 sc1 lds
MV 72,168,240,72
RD 156,5,3072
MV 72,164,232,72
MV 72,160,224,72
s_waitcnt lgkmcnt(11)
buffer_load_dwordx4 v60,s[4:7],s36 offen offset:1024 sc1 lds
MV 80,176,224,80
s_waitcnt lgkmcnt(10)
RD 160,4,41984
MV 80,180,232,80
s_waitcnt lgkmcnt(10)
RD 164,4,51200
MV 80,184,240,80
s_waitcnt lgkmcnt(10)
RD 168,4,60416
MV 80,188,248,80
RD 172,5,4096
MV 84,188,252,84
MV 84,184,244,84
buffer_load_dwordx4 v60,s[4:7],s36 offen offset:2048 sc1 lds
MV 84,180,236,84
MV 84,176,228,84
s_waitcnt lgkmcnt(11)
MV 92,128,228,92
s_waitcnt lgkmcnt(10)
RD 176,4,43008
MV 92,132,236,92
s_mov_b32 s45,98304
RD 180,4,52224
s_waitcnt lgkmcnt(11)
MV 92,136,244,92
s_waitcnt lgkmcnt(10)
buffer_load_dwordx4 a[160:163],v17,s[92:95],s45 offen sc1
MV 92,140,252,92
RD 184,4,61440
MV 88,140,248,88
RD 188,5,5120
MV 88,136,240,88
MV 88,132,232,88
buffer_load_dwordx4 a[164:167],v27,s[92:95],s45 offen sc1
MV 88,128,224,88
s_waitcnt lgkmcnt(11)
MV 96,144,224,96
s_waitcnt lgkmcnt(10)
RD 128,4,44032
MV 96,148,232,96
s_waitcnt lgkmcnt(10)
buffer_load_dwordx4 v60,s[4:7],s36 offen offset:3072 sc1 lds
MV 96,152,240,96
s_waitcnt lgkmcnt(9)
RD 132,4,53248
MV 96,156,248,96
RD 136,4,62464
MV 100,156,252,100
RD 140,5,6144
MV 100,152,244,100
s_add_u32 s36,s41,118784
MV 100,148,236,100
s_add_u32 m0,s41,118784
MV 100,144,228,100
s_waitcnt lgkmcnt(11)
buffer_load_dwordx4 v60,s[4:7],s36 offen offset:0 sc1 lds
MV 108,160,228,108
s_waitcnt lgkmcnt(10)
RD 144,4,45056
MV 108,164,236,108
s_waitcnt lgkmcnt(10)
RD 148,4,54272
MV 108,168,244,108
s_waitcnt lgkmcnt(10)
RD 152,4,63488
MV 108,172,252,108
RD 156,5,7168
MV 104,172,248,104
s_mov_b32 s45,102400
MV 104,168,240,104
buffer_load_dwordx4 a[168:171],v17,s[92:95],s45 offen sc1
MV 104,164,232,104
MV 104,160,224,104
s_waitcnt lgkmcnt(11)
MV 112,176,224,112
s_waitcnt lgkmcnt(10)
MV 112,180,232,112
s_waitcnt lgkmcnt(9)
MV 112,184,240,112
s_waitcnt lgkmcnt(8)
MV 112,188,248,112
buffer_load_dwordx4 a[172:175],v27,s[92:95],s45 offen sc1
MV 116,188,252,116
s_waitcnt vmcnt(19) lgkmcnt(0)
s_barrier
RD 160,5,8192
MV 116,184,244,116
RD 164,5,17408
MV 116,180,236,116
RD 168,5,26624
MV 116,176,228,116
RD 172,5,35840
MV 124,128,228,124
RD 176,5,9216
MV 124,132,236,124
RD 180,5,18432
MV 124,136,244,124
s_mov_b32 s45,106496
RD 184,5,27648
MV 124,140,252,124
buffer_load_dwordx4 a[176:179],v17,s[92:95],s45 offen sc1
MV 120,140,248,120
RD 188,5,36864
MV 120,136,240,120
MV 120,132,232,120
MV 120,128,224,120
MV 200,144,224,200
RD 128,5,10240
MV 200,148,232,200
RD 132,5,19456
MV 200,152,240,200
RD 136,5,28672
MV 200,156,248,200
RD 140,5,37888
MV 204,156,252,204
buffer_load_dwordx4 a[180:183],v27,s[92:95],s45 offen sc1
MV 204,152,244,204
MV 204,148,236,204
MV 204,144,228,204
s_sub_u32 s47,s47,1
s_cbranch_scc1 L_xchg
s_waitcnt lgkmcnt(11)
MV 64,160,128,64
s_waitcnt vmcnt(20) lgkmcnt(10)
RD 144,5,11264
MV 64,164,136,64
s_waitcnt vmcnt(16) lgkmcnt(10)
RD 148,5,20480
MV 64,168,144,64
s_waitcnt vmcnt(12) lgkmcnt(10)
RD 152,5,29696
MV 64,172,152,64
s_waitcnt vmcnt(11)
RD 156,5,38912
MV 68,172,156,68
s_mov_b32 s45,110592
MV 68,168,148,68
buffer_load_dwordx4 a[184:187],v17,s[92:95],s45 offen sc1
MV 68,164,140,68
MV 68,160,132,68
s_waitcnt lgkmcnt(11)
MV 76,176,132,76
s_waitcnt lgkmcnt(10)
RD 160,5,12288
MV 76,180,140,76
s_waitcnt lgkmcnt(10)
RD 164,5,21504
MV 76,184,148,76
s_waitcnt lgkmcnt(10)
RD 168,5,30720
MV 76,188,156,76
RD 172,5,39936
MV 72,188,152,72
MV 72,184,144,72
MV 72,180,136,72
buffer_load_dwordx4 a[188:191],v27,s[92:95],s45 offen sc1
MV 72,176,128,72
s_waitcnt lgkmcnt(11)
MV 80,128,128,80
s_waitcnt lgkmcnt(10)
RD 176,5,13312
MV 80,132,136,80
s_waitcnt lgkmcnt(10)
RD 180,5,22528
MV 80,136,144,80
s_waitcnt lgkmcnt(10)
RD 184,5,31744
MV 80,140,152,80
RD 188,5,40960
MV 84,140,156,84
MV 84,136,148,84
MV 84,132,140,84
MV 84,128,132,84
s_waitcnt lgkmcnt(11)
MV 92,144,132,92
s_waitcnt lgkmcnt(10)
RD 128,5,14336
MV 92,148,140,92
s_waitcnt lgkmcnt(10)
RD 132,5,23552
MV 92,152,148,92
s_waitcnt lgkmcnt(10)
RD 136,5,32768
MV 92,156,156,92
RD 140,5,41984
MV 88,156,152,88
MV 88,152,144,88
MV 88,148,136,88
MV 88,144,128,88
s_waitcnt lgkmcnt(11)
MV 96,160,128,96
s_waitcnt lgkmcnt(10)
RD 144,5,15360
MV 96,164,136,96
s_waitcnt lgkmcnt(10)
RD 148,5,24576
MV 96,168,144,96
s_waitcnt lgkmcnt(10)
RD 152,5,33792
MV 96,172,152,96
RD 156,5,43008
MV 100,172,156,100
MV 100,168,148,100
MV 100,164,140,100
MV 100,160,132,100
s_waitcnt lgkmcnt(11)
MV 108,176,132,108
s_waitcnt lgkmcnt(10)
RD 160,5,16384
MV 108,180,140,108
s_waitcnt lgkmcnt(10)
RD 164,5,25600
MV 108,184,148,108
s_waitcnt lgkmcnt(10)
RD 168,5,34816
MV 108,188,156,108
RD 172,5,44032
MV 104,188,152,104
MV 104,184,144,104
MV 104,180,136,104
MV 104,176,128,104
s_waitcnt lgkmcnt(11)
MV 112,128,128,112
s_waitcnt lgkmcnt(10)
MV 112,132,136,112
s_waitcnt lgkmcnt(9)
MV 112,136,144,112
s_waitcnt lgkmcnt(8)
MV 112,140,152,112
MV 116,140,156,116
s_waitcnt vmcnt(6) lgkmcnt(0)
s_barrier
RD 176,5,45056
MV 116,136,148,116
RD 180,5,54272
MV 116,132,140,116
RD 184,5,63488
MV 116,128,132,116
RD 188,6,7168
MV 124,144,132,124
RD 128,5,46080
MV 124,148,140,124
RD 132,5,55296
MV 124,152,148,124
RD 136,5,64512
MV 124,156,156,124
RD 140,6,8192
MV 120,156,152,120
MV 120,152,144,120
MV 120,148,136,120
MV 120,144,128,120
MV 200,160,128,200
RD 144,5,47104
MV 200,164,136,200
RD 148,5,56320
MV 200,168,144,200
RD 152,6,0
MV 200,172,152,200
RD 156,6,9216
MV 204,172,156,204
MV 204,168,148,204
MV 204,164,140,204
MV 204,160,132,204
s_sub_u32 s47,s47,1
s_cbranch_scc1 L_xchg
s_waitcnt lgkmcnt(11)
MV 64,176,160,64
s_waitcnt vmcnt(5) lgkmcnt(10)
RD 160,5,48128
MV 64,180,168,64
s_waitcnt vmcnt(3) lgkmcnt(10)
RD 164,5,57344
MV 64,184,176,64
s_waitcnt vmcnt(1) lgkmcnt(10)
RD 168,6,1024
MV 64,188,184,64
s_waitcnt vmcnt(0)
RD 172,6,10240
MV 68,188,188,68
MV 68,184,180,68
MV 68,180,172,68
MV 68,176,164,68
s_waitcnt lgkmcnt(11)
MV 76,128,164,76
s_waitcnt lgkmcnt(10)
RD 176,5,49152
MV 76,132,172,76
s_waitcnt lgkmcnt(10)
RD 180,5,58368
MV 76,136,180,76
s_waitcnt lgkmcnt(10)
RD 184,6,2048
MV 76,140,188,76
RD 188,6,11264
MV 72,140,184,72
MV 72,136,176,72
MV 72,132,168,72
MV 72,128,160,72
s_waitcnt lgkmcnt(11)
MV 80,144,160,80
s_waitcnt lgkmcnt(10)
RD 128,5,50176
MV 80,148,168,80
s_waitcnt lgkmcnt(10)
RD 132,5,59392
MV 80,152,176,80
s_waitcnt lgkmcnt(10)
RD 136,6,3072
MV 80,156,184,80
RD 140,6,12288
MV 84,156,188,84
MV 84,152,180,84
MV 84,148,172,84
MV 84,144,164,84
s_waitcnt lgkmcnt(11)
MV 92,160,164,92
s_waitcnt lgkmcnt(10)
RD 144,5,51200
MV 92,164,172,92
s_waitcnt lgkmcnt(10)
RD 148,5,60416
MV 92,168,180,92
s_waitcnt lgkmcnt(10)
RD 152,6,4096
MV 92,172,188,92
RD 156,6,13312
MV 88,172,184,88
MV 88,168,176,88
MV 88,164,168,88
MV 88,160,160,88
s_waitcnt lgkmcnt(11)
MV 96,176,160,96
s_waitcnt lgkmcnt(10)
RD 160,5,52224
MV 96,180,168,96
s_waitcnt lgkmcnt(10)
RD 164,5,61440
MV 96,184,176,96
s_waitcnt lgkmcnt(10)
RD 168,6,5120
MV 96,188,184,96
RD 172,6,14336
MV 100,188,188,100
MV 100,184,180,100
MV 100,180,172,100
MV 100,176,164,100
s_waitcnt lgkmcnt(11)
MV 108,128,164,108
s_waitcnt lgkmcnt(10)
RD 176,5,53248
MV 108,132,172,108
s_waitcnt lgkmcnt(10)
RD 180,5,62464
MV 108,136,180,108
s_waitcnt lgkmcnt(10)
RD 184,6,6144
MV 108,140,188,108
RD 188,6,15360
MV 104,140,184,104
MV 104,136,176,104
MV 104,132,168,104
MV 104,128,160,104
s_waitcnt lgkmcnt(11)
MV 112,144,160,112
s_waitcnt lgkmcnt(10)
MV 112,148,168,112
s_waitcnt lgkmcnt(9)
MV 112,152,176,112
s_waitcnt lgkmcnt(8)
MV 112,156,184,112
MV 116,156,188,116
MV 116,152,180,116
MV 116,148,172,116
MV 116,144,164,116
s_waitcnt lgkmcnt(7)
MV 124,160,164,124
s_waitcnt lgkmcnt(6)
MV 124,164,172,124
s_waitcnt lgkmcnt(5)
MV 124,168,180,124
s_waitcnt lgkmcnt(4)
MV 124,172,188,124
MV 120,172,184,120
MV 120,168,176,120
MV 120,164,168,120
MV 120,160,160,120
s_waitcnt lgkmcnt(3)
MV 200,176,160,200
s_waitcnt lgkmcnt(2)
MV 200,180,168,200
s_waitcnt lgkmcnt(1)
MV 200,184,176,200
s_waitcnt lgkmcnt(0)
MV 200,188,184,200
MV 204,188,188,204
MV 204,184,180,204
MV 204,180,172,204
MV 204,176,164,204
L_xchg:
s_nop 7
CV 208,64,65
CV 209,66,67
CV 210,72,73
CV 211,74,75
buffer_store_dwordx4 v[208:211],v60,s[20:23],0 offen offset:0 sc1
CV 212,80,81
CV 213,82,83
CV 214,88,89
CV 215,90,91
buffer_store_dwordx4 v[212:215],v60,s[20:23],0 offen offset:1024 sc1
CV 216,96,97
CV 217,98,99
CV 218,104,105
CV 219,106,107
buffer_store_dwordx4 v[216:219],v60,s[20:23],0 offen offset:2048 sc1
CV 220,112,113
CV 221,114,115
CV 222,120,121
CV 223,122,123
buffer_store_dwordx4 v[220:223],v60,s[20:23],0 offen offset:3072 sc1
CV 224,200,201
CV 225,202,203
buffer_store_dwordx2 v[224:225],v38,s[20:23],0 offen sc1
s_waitcnt vmcnt(0) lgkmcnt(0)
buffer_store_dword v61,v63,s[88:91],0 offen offset:32 sc1
buffer_load_dword v62,v41,s[24:27],s49 offen offset:32 sc1
s_barrier
s_waitcnt vmcnt(0)
v_cmp_ne_u32 vcc,1,v62
s_nop 0
s_cbranch_vccnz L_spin_x
L_back_x:
s_mov_b32 s35,0xffff0000
buffer_load_dwordx4 v[228:231],v60,s[8:11],0 offen offset:0 sc1
buffer_load_dwordx4 v[232:235],v60,s[8:11],0 offen offset:1024 sc1
buffer_load_dwordx4 v[236:239],v60,s[8:11],0 offen offset:2048 sc1
buffer_load_dwordx4 v[240:243],v60,s[8:11],0 offen offset:3072 sc1
buffer_load_dwordx2 v[244:245],v38,s[8:11],0 offen sc1
s_waitcnt vmcnt(4)
v_lshlrev_b32 v128,16,v228
v_and_b32 v129,s35,v228
v_lshlrev_b32 v130,16,v229
v_and_b32 v131,s35,v229
v_pk_add_f32 v[68:69],v[68:69],v[128:129]
v_pk_add_f32 v[70:71],v[70:71],v[130:131]
CV 128,68,69
CV 129,70,71
ds_write_b64 v39,v[128:129] offset:0
v_lshlrev_b32 v132,16,v230
v_and_b32 v133,s35,v230
v_lshlrev_b32 v134,16,v231
v_and_b32 v135,s35,v231
v_pk_add_f32 v[76:77],v[76:77],v[132:133]
v_pk_add_f32 v[78:79],v[78:79],v[134:135]
CV 132,76,77
CV 133,78,79
ds_write_b64 v39,v[132:133] offset:32
s_waitcnt vmcnt(3)
v_lshlrev_b32 v136,16,v232
v_and_b32 v137,s35,v232
v_lshlrev_b32 v138,16,v233
v_and_b32 v139,s35,v233
v_pk_add_f32 v[84:85],v[84:85],v[136:137]
v_pk_add_f32 v[86:87],v[86:87],v[138:139]
CV 136,84,85
CV 137,86,87
ds_write_b64 v39,v[136:137] offset:64
v_lshlrev_b32 v140,16,v234
v_and_b32 v141,s35,v234
v_lshlrev_b32 v142,16,v235
v_and_b32 v143,s35,v235
v_pk_add_f32 v[92:93],v[92:93],v[140:141]
v_pk_add_f32 v[94:95],v[94:95],v[142:143]
CV 140,92,93
CV 141,94,95
ds_write_b64 v39,v[140:141] offset:96
s_waitcnt vmcnt(2)
v_lshlrev_b32 v144,16,v236
v_and_b32 v145,s35,v236
v_lshlrev_b32 v146,16,v237
v_and_b32 v147,s35,v237
v_pk_add_f32 v[100:101],v[100:101],v[144:145]
v_pk_add_f32 v[102:103],v[102:103],v[146:147]
CV 144,100,101
CV 145,102,103
ds_write_b64 v39,v[144:145] offset:128
v_lshlrev_b32 v148,16,v238
v_and_b32 v149,s35,v238
v_lshlrev_b32 v150,16,v239
v_and_b32 v151,s35,v239
v_pk_add_f32 v[108:109],v[108:109],v[148:149]
v_pk_add_f32 v[110:111],v[110:111],v[150:151]
CV 148,108,109
CV 149,110,111
ds_write_b64 v39,v[148:149] offset:160
s_waitcnt vmcnt(1)
v_lshlrev_b32 v152,16,v240
v_and_b32 v153,s35,v240
v_lshlrev_b32 v154,16,v241
v_and_b32 v155,s35,v241
v_pk_add_f32 v[116:117],v[116:117],v[152:153]
v_pk_add_f32 v[118:119],v[118:119],v[154:155]
CV 152,116,117
CV 153,118,119
ds_write_b64 v39,v[152:153] offset:192
v_lshlrev_b32 v156,16,v242
v_and_b32 v157,s35,v242
v_lshlrev_b32 v158,16,v243
v_and_b32 v159,s35,v243
v_pk_add_f32 v[124:125],v[124:125],v[156:157]
v_pk_add_f32 v[126:127],v[126:127],v[158:159]
CV 156,124,125
CV 157,126,127
ds_write_b64 v39,v[156:157] offset:224
s_waitcnt vmcnt(0)
v_lshlrev_b32 v160,16,v244
v_and_b32 v161,s35,v244
v_lshlrev_b32 v162,16,v245
v_and_b32 v163,s35,v245
v_pk_add_f32 v[204:205],v[204:205],v[160:161]
v_pk_add_f32 v[206:207],v[206:207],v[162:163]
CV 160,204,205
CV 161,206,207
ds_write_b64 v39,v[160:161] offset:256
ds_read_b128 v[168:171],v44
ds_read_b128 v[172:175],v45
ds_read_b128 v[176:179],v46
ds_read_b128 v[180:183],v47
ds_read_b128 v[184:187],v48
s_waitcnt lgkmcnt(4)
buffer_store_dwordx4 v[168:171],v32,s[28:31],0 offen sc1
s_waitcnt lgkmcnt(3)
buffer_store_dwordx4 v[172:175],v33,s[28:31],0 offen sc1
s_waitcnt lgkmcnt(2)
buffer_store_dwordx4 v[176:179],v34,s[28:31],0 offen sc1
s_waitcnt lgkmcnt(1)
buffer_store_dwordx4 v[180:183],v35,s[28:31],0 offen sc1
s_waitcnt lgkmcnt(0)
buffer_store_dwordx4 v[184:187],v36,s[28:31],0 offen sc1
L_end:
s_endpgm
L_code_end:
.section .rodata,"a"
.p2align 6
.amdhsa_kernel concat_heads__mha_block_cached__mha_block_cached__near_ridge_kernel
  .amdhsa_next_free_vgpr 512
  .amdhsa_next_free_sgpr 100
  .amdhsa_accum_offset 256
  .amdhsa_group_segment_fixed_size 0
  .amdhsa_kernarg_size 104
  .amdhsa_user_sgpr_count 2
  .amdhsa_user_sgpr_kernarg_segment_ptr 1
  .amdhsa_system_sgpr_workgroup_id_x 1
.end_amdhsa_kernel
```
